```python
import torch

def _softmax(x, axis=-1):
    return torch.softmax(x, dim=axis)
def _gelu(x):
    return torch.nn.functional.gelu(x, approximate="tanh")
def _silu(x):
    return torch.nn.functional.silu(x)
def _sigmoid(x):
    return torch.sigmoid(x)
def _layernorm(x, axis=-1, eps=1e-5):
    m = x.mean(dim=axis, keepdim=True)
    v = x.var(dim=axis, keepdim=True, unbiased=False)
    return (x - m) / torch.sqrt(v + eps)
def _scatter_add(tgt, idx, src, axis=0):
    return tgt.clone().index_add_(axis, idx, src)
def _segment_sum(src, seg, n):
    out = torch.zeros((n,) + src.shape[1:], dtype=src.dtype)
    return out.index_add_(0, seg, src)
def _pad(x, pw):
    flat = tuple(v for pair in reversed(pw) for v in pair)
    return torch.nn.functional.pad(x, flat)

kernel_name = 'concat_heads__ssm_conv_s5__mha_block__prompt'

def setup_inputs():

    _w = (lambda a: (lambda t: t.to(torch.bfloat16) if t.is_floating_point() else t)(torch.as_tensor(a)))
    def _A_setup():
        B, S, D = 1, 2048, 640
        P = D
        Lambda_re = -0.5 * (lambda _x: torch.exp(torch.as_tensor(_x)))((lambda *s: torch.randn(*s, dtype=torch.bfloat16) * 0.8)(P))
        Lambda_im = (lambda *s: torch.randn(*s, dtype=torch.bfloat16) * 0.8)(P) * 1.0
        B_re = (lambda *s: torch.randn(*s, dtype=torch.bfloat16) * 0.8)(P, D) * (D ** -0.5)
        B_im = (lambda *s: torch.randn(*s, dtype=torch.bfloat16) * 0.8)(P, D) * (D ** -0.5)
        C_re = (lambda *s: torch.randn(*s, dtype=torch.bfloat16) * 0.8)(D, P) * (P ** -0.5)
        C_im = (lambda *s: torch.randn(*s, dtype=torch.bfloat16) * 0.8)(D, P) * (P ** -0.5)
        log_dt = (lambda *s: torch.randn(*s, dtype=torch.bfloat16) * 0.8)(P) * 0.3 - 2.0
        Dskip = (lambda *s: torch.randn(*s, dtype=torch.bfloat16) * 0.8)(D)
        return {
            "x": _w((lambda *s: torch.randn(*s, dtype=torch.bfloat16) * 0.05)(B, S, D)),
            "Lambda_re": _w(Lambda_re),
            "Lambda_im": _w(Lambda_im),
            "B_re": _w(B_re),
            "B_im": _w(B_im),
            "C_re": _w(C_re),
            "C_im": _w(C_im),
            "log_dt": _w(log_dt),
            "Dskip": _w(Dskip),
        }
    _A_in = _A_setup()

    def _B_setup():
        B, S, D, H = 1, 2048, 640, 32
        return {
            "x": _w((lambda *s: torch.randn(*s, dtype=torch.bfloat16) * 0.2)(B, S, D)),
            "wqkv": _w((lambda *s: torch.randn(*s, dtype=torch.bfloat16) * 0.2)(D, 3 * D)),
            "wo": _w((lambda *s: torch.randn(*s, dtype=torch.bfloat16) * 0.05)(D, D)),
        }
    _B_in = _B_setup()

    return {
        "A_x": _A_in["x"],
        "A_Lambda_re": _A_in["Lambda_re"],
        "A_Lambda_im": _A_in["Lambda_im"],
        "A_B_re": _A_in["B_re"],
        "A_B_im": _A_in["B_im"],
        "A_C_re": _A_in["C_re"],
        "A_C_im": _A_in["C_im"],
        "A_log_dt": _A_in["log_dt"],
        "A_Dskip": _A_in["Dskip"],
        "B_x": _B_in["x"],
        "B_wqkv": _B_in["wqkv"],
        "B_wo": _B_in["wo"],
    }

def reference(A_x, A_Lambda_re, A_Lambda_im, A_B_re, A_B_im, A_C_re, A_C_im, A_log_dt, A_Dskip, B_x, B_wqkv, B_wo):
    def _A_ref(x, Lambda_re, Lambda_im, B_re, B_im, C_re, C_im, log_dt, Dskip):
        Bsz, L, H = x.shape
        Lam = Lambda_re + 1j * Lambda_im
        Bmat = B_re + 1j * B_im
        Cmat = C_re + 1j * C_im
        dt = torch.exp(log_dt)
        Lam_bar = torch.exp(dt * Lam)
        B_bar = ((Lam_bar - 1.0) / Lam)[:, None] * Bmat
        Bu = torch.einsum("bld,pd->blp", x + 0j, B_bar)
        h = torch.zeros_like(Bu[:, 0, :])
        hs = []
        for t in range(L):
            h = Lam_bar[None, :] * h + Bu[:, t, :]
            hs.append(h)
        hseq = torch.stack(hs, 1)
        y = 2.0 * torch.einsum("blp,dp->bld", hseq, Cmat).real + x * Dskip[None, None, :]
        return y

    def _B_ref(x, wqkv, wo):
        B, S, D = x.shape
        H = 32
        Dh = D // H
        qkv = (lambda x, *d: x.permute(*d))((x @ wqkv).reshape(B, S, 3, H, Dh), 2, 0, 3, 1, 4)
        q, k, v = qkv[0], qkv[1], qkv[2]
        scores = torch.einsum("bhqd,bhkd->bhqk", q, k) * (Dh ** -0.5)
        p = _softmax(scores, axis=-1)
        o = torch.einsum("bhqk,bhkd->bhqd", p, v)
        return (lambda x, *d: x.permute(*d))(o, 0, 2, 1, 3).reshape(B, S, D) @ wo

    a = _A_ref(A_x, A_Lambda_re, A_Lambda_im, A_B_re, A_B_im, A_C_re, A_C_im, A_log_dt, A_Dskip)
    b = _B_ref(B_x, B_wqkv, B_wo)
    return torch.concatenate([a, b], axis=-1)
```

```asm
; @launch grid=(512,1,1) block=(256,1,1) lds=81920
.amdgcn_target "amdgcn-amd-amdhsa--gfx950"
.text
.globl concat_heads__ssm_conv_s5__mha_block__prompt_kernel
.p2align 8
.type concat_heads__ssm_conv_s5__mha_block__prompt_kernel,@function
concat_heads__ssm_conv_s5__mha_block__prompt_kernel:
    s_cmp_ge_u32 s2, 512
    s_cbranch_scc1 L_end
    s_load_dwordx4 s[40:43], s[0:1], 72
    s_load_dwordx4 s[44:47], s[0:1], 104
    s_getpc_b64 s[4:5]
cpf_concat_heads__ssm_conv_s5__mha_block__prompt_kernel_14:
    s_sub_u32 s4, s4, cpf_concat_heads__ssm_conv_s5__mha_block__prompt_kernel_14-concat_heads__ssm_conv_s5__mha_block__prompt_kernel
    s_subb_u32 s5, s5, 0
    s_bfe_u32 s6, s2, 0x50003
    s_mul_i32 s6, s6, 1536
    v_and_b32 v254, 63, v0
    v_min_u32 v254, 11, v254
    v_lshlrev_b32 v254, 7, v254
    v_add_u32 v254, s6, v254
    v_min_u32 v254, L_code_end-concat_heads__ssm_conv_s5__mha_block__prompt_kernel-4, v254
    global_load_dword v255, v254, s[4:5]
    v_readfirstlane_b32 s64, v0
    s_lshr_b32 s64, s64, 6
    s_cmp_ge_u32 s2, 256
    s_cbranch_scc1 L_a
    s_cmp_ge_u32 s2, 240
    s_cbranch_scc1 L_t_nog3
    v_mbcnt_lo_u32_b32 v22, -1, 0
    v_mbcnt_hi_u32_b32 v22, -1, v22
    s_and_b32 s34, s2, 7
    s_lshr_b32 s35, s2, 3
    s_and_b32 s26, s34, 1
    s_mul_i32 s26, s26, 30
    s_add_u32 s35, s35, s26
    s_lshr_b32 s26, s35, 2
    s_and_b32 s35, s35, 3
    s_lshr_b32 s34, s34, 1
    s_lshl_b32 s25, s34, 2
    s_add_u32 s25, s25, s35
    s_add_u32 s35, s35, s26
    s_mul_i32 s34, s35, 86
    s_lshr_b32 s34, s34, 8
    s_mul_i32 s34, s34, 3
    s_sub_u32 s35, s35, s34
    s_mul_i32 s35, s35, 7
    s_lshr_b32 s35, s35, 1
    s_mul_i32 s28, s25, 163840
    s_add_u32 s29, s28, 1280
    s_lshl_b32 s27, s35, 7
    s_add_u32 s27, s27, s28
    s_lshl_b32 s31, s26, 8
    s_add_u32 s32, s31, 2457600
    s_mul_i32 s30, s35, 245760
    s_add_u32 s30, s30, s31
    s_lshl_b32 s33, s64, 12
    s_mul_i32 s34, s64, 40960
    v_lshrrev_b32 v24, 3, v22
    v_mul_u32_u24 v24, 1280, v24
    v_add_u32 v24, s34, v24
    v_lshrrev_b32 v25, 4, v22
    v_xor_b32 v25, v25, v22
    v_and_b32 v25, 7, v25
    v_lshlrev_b32 v25, 4, v25
    v_add_u32 v1, v24, v25
    v_xor_b32 v2, 64, v25
    v_add_u32 v2, v24, v2
    v_add_u32 v2, 9216, v2
    v_add_u32 v3, v24, v25
    v_add_u32 v3, 18432, v3
    v_xor_b32 v4, 64, v25
    v_add_u32 v4, v24, v4
    v_add_u32 v4, 27648, v4
    v_lshrrev_b32 v24, 4, v22
    v_lshlrev_b32 v25, 2, v24
    v_xor_b32 v25, v25, v22
    v_and_b32 v25, 15, v25
    v_lshlrev_b32 v25, 4, v25
    v_mul_u32_u24 v24, 3840, v24
    v_add_u32 v24, v24, v25
    s_mul_i32 s34, s64, 61440
    v_add_u32 v5, s34, v24
    v_add_u32 v6, 14336, v5
    v_add_u32 v7, 28672, v5
    v_add_u32 v8, 43008, v5
    s_waitcnt lgkmcnt(0)
    s_mov_b32 s8, s40
    s_mov_b32 s9, s41
    s_mov_b32 s10, 2621440
    s_mov_b32 s11, 0x00020000
    s_mov_b32 s12, s42
    s_mov_b32 s13, s43
    s_mov_b32 s14, 2457600
    s_mov_b32 s15, 0x00020000
    s_cmp_ge_u32 s26, 10
    s_cbranch_scc1 g3_v
    s_add_u32 m0, s33, 0
    s_nop 0
    buffer_load_dwordx4 v1, s[8:11], s27 offen offset:0  lds
    buffer_load_dwordx4 v2, s[8:11], s27 offen offset:1024  lds
    buffer_load_dwordx4 v3, s[8:11], s27 offen offset:2048  lds
    buffer_load_dwordx4 v4, s[8:11], s27 offen offset:3072  lds
    s_add_u32 s27, s27, 128
    s_cmp_eq_u32 s27, s29
    s_cselect_b32 s27, s28, s27
    s_add_u32 m0, s33, 16384
    s_nop 0
    buffer_load_dwordx4 v5, s[12:15], s30 offen offset:0  lds
    buffer_load_dwordx4 v6, s[12:15], s30 offen offset:1024  lds
    buffer_load_dwordx4 v7, s[12:15], s30 offen offset:2048  lds
    buffer_load_dwordx4 v8, s[12:15], s30 offen offset:3072  lds
    s_add_u32 s30, s30, 245760
    s_cmp_eq_u32 s30, s32
    s_cselect_b32 s30, s31, s30
    v_and_b32 v24, 31, v22
    s_lshr_b32 s34, s64, 1
    s_lshl_b32 s34, s34, 6
    v_add_u32 v24, s34, v24
    v_lshrrev_b32 v25, 5, v22
    v_lshrrev_b32 v26, 1, v24
    v_xor_b32 v26, v26, v25
    v_and_b32 v26, 7, v26
    v_lshlrev_b32 v26, 4, v26
    v_lshl_add_u32 v10, v24, 7, v26
    v_xor_b32 v11, 32, v10
    v_xor_b32 v12, 64, v10
    v_xor_b32 v13, 96, v10
    v_add_u32 v14, 65536, v10
    v_add_u32 v15, 65536, v11
    v_add_u32 v16, 65536, v12
    v_add_u32 v17, 65536, v13
    v_bfe_u32 v24, v22, 2, 2
    v_lshlrev_b32 v26, 3, v25
    v_add_u32 v26, v26, v24
    v_lshlrev_b32 v26, 8, v26
    s_and_b32 s34, s64, 1
    s_lshl_b32 s34, s34, 1
    v_xor_b32 v27, s34, v24
    v_lshlrev_b32 v27, 6, v27
    v_add_u32 v26, v26, v27
    v_and_b32 v27, 1, v22
    v_lshlrev_b32 v27, 1, v27
    v_bfe_u32 v28, v22, 1, 1
    v_or_b32 v27, v27, v28
    v_bfe_u32 v28, v22, 4, 1
    v_lshl_add_u32 v27, v28, 2, v27
    v_lshl_add_u32 v18, v27, 3, v26
    v_xor_b32 v19, 64, v18
    v_add_u32 v20, 65536, v18
    v_add_u32 v21, 65536, v19
    s_add_u32 m0, s33, 32768
    s_nop 0
    buffer_load_dwordx4 v1, s[8:11], s27 offen offset:0  lds
    buffer_load_dwordx4 v2, s[8:11], s27 offen offset:1024  lds
    buffer_load_dwordx4 v3, s[8:11], s27 offen offset:2048  lds
    buffer_load_dwordx4 v4, s[8:11], s27 offen offset:3072  lds
    s_add_u32 s27, s27, 128
    s_cmp_eq_u32 s27, s29
    s_cselect_b32 s27, s28, s27
    s_add_u32 m0, s33, 49152
    s_nop 0
    buffer_load_dwordx4 v5, s[12:15], s30 offen offset:0  lds
    buffer_load_dwordx4 v6, s[12:15], s30 offen offset:1024  lds
    buffer_load_dwordx4 v7, s[12:15], s30 offen offset:2048  lds
    buffer_load_dwordx4 v8, s[12:15], s30 offen offset:3072  lds
    s_add_u32 s30, s30, 245760
    s_cmp_eq_u32 s30, s32
    s_cselect_b32 s30, s31, s30
    s_waitcnt vmcnt(12)
    s_barrier
    ds_read_b128 v[128:131], v10 offset:0
    ds_read_b128 v[132:135], v10 offset:4096
    ds_read_b128 v[136:139], v11 offset:0
    ds_read_b128 v[140:143], v11 offset:4096
    ds_read_b128 v[144:147], v12 offset:0
    ds_read_b128 v[148:151], v12 offset:4096
    ds_read_b128 v[152:155], v13 offset:0
    ds_read_b128 v[156:159], v13 offset:4096
    s_waitcnt vmcnt(8) lgkmcnt(0)
    s_barrier
    ds_read_b64_tr_b16 v[160:161], v18 offset:16384
    ds_read_b64_tr_b16 v[162:163], v18 offset:17408
    ds_read_b64_tr_b16 v[164:165], v19 offset:16384
    ds_read_b64_tr_b16 v[166:167], v19 offset:17408
    ds_read_b64_tr_b16 v[168:169], v18 offset:20480
    ds_read_b64_tr_b16 v[170:171], v18 offset:21504
    ds_read_b64_tr_b16 v[172:173], v19 offset:20480
    ds_read_b64_tr_b16 v[174:175], v19 offset:21504
    ds_read_b64_tr_b16 v[176:177], v18 offset:24576
    ds_read_b64_tr_b16 v[178:179], v18 offset:25600
    ds_read_b64_tr_b16 v[180:181], v19 offset:24576
    ds_read_b64_tr_b16 v[182:183], v19 offset:25600
    ds_read_b64_tr_b16 v[184:185], v18 offset:28672
    ds_read_b64_tr_b16 v[186:187], v18 offset:29696
    ds_read_b64_tr_b16 v[188:189], v19 offset:28672
    ds_read_b64_tr_b16 v[190:191], v19 offset:29696
    s_add_u32 m0, s33, 65536
    s_nop 0
    buffer_load_dwordx4 v1, s[8:11], s27 offen offset:0  lds
    buffer_load_dwordx4 v2, s[8:11], s27 offen offset:1024  lds
    buffer_load_dwordx4 v3, s[8:11], s27 offen offset:2048  lds
    buffer_load_dwordx4 v4, s[8:11], s27 offen offset:3072  lds
    s_add_u32 s27, s27, 128
    s_cmp_eq_u32 s27, s29
    s_cselect_b32 s27, s28, s27
    s_add_u32 m0, s33, 0
    s_nop 0
    buffer_load_dwordx4 v5, s[12:15], s30 offen offset:0  lds
    buffer_load_dwordx4 v6, s[12:15], s30 offen offset:1024  lds
    buffer_load_dwordx4 v7, s[12:15], s30 offen offset:2048  lds
    buffer_load_dwordx4 v8, s[12:15], s30 offen offset:3072  lds
    s_add_u32 s30, s30, 245760
    s_cmp_eq_u32 s30, s32
    s_cselect_b32 s30, s31, s30
    s_waitcnt vmcnt(12) lgkmcnt(0)
    s_barrier
    v_mfma_f32_32x32x16_bf16 v[64:79], v[160:163], v[128:131], 0
    ds_read_b128 v[192:195], v10 offset:32768
    ds_read_b128 v[196:199], v10 offset:36864
    v_mfma_f32_32x32x16_bf16 v[80:95], v[164:167], v[128:131], 0
    ds_read_b128 v[200:203], v11 offset:32768
    ds_read_b128 v[204:207], v11 offset:36864
    v_mfma_f32_32x32x16_bf16 v[96:111], v[160:163], v[132:135], 0
    ds_read_b128 v[208:211], v12 offset:32768
    ds_read_b128 v[212:215], v12 offset:36864
    v_mfma_f32_32x32x16_bf16 v[112:127], v[164:167], v[132:135], 0
    ds_read_b128 v[216:219], v13 offset:32768
    ds_read_b128 v[220:223], v13 offset:36864
    v_mfma_f32_32x32x16_bf16 v[64:79], v[168:171], v[136:139], v[64:79]
    v_mfma_f32_32x32x16_bf16 v[80:95], v[172:175], v[136:139], v[80:95]
    v_mfma_f32_32x32x16_bf16 v[96:111], v[168:171], v[140:143], v[96:111]
    v_mfma_f32_32x32x16_bf16 v[112:127], v[172:175], v[140:143], v[112:127]
    s_add_u32 m0, s33, 16384
    s_nop 0
    buffer_load_dwordx4 v1, s[8:11], s27 offen offset:0  lds
    buffer_load_dwordx4 v2, s[8:11], s27 offen offset:1024  lds
    buffer_load_dwordx4 v3, s[8:11], s27 offen offset:2048  lds
    buffer_load_dwordx4 v4, s[8:11], s27 offen offset:3072  lds
    s_add_u32 s27, s27, 128
    s_cmp_eq_u32 s27, s29
    s_cselect_b32 s27, s28, s27
    s_waitcnt vmcnt(12) lgkmcnt(0)
    s_barrier
    v_mfma_f32_32x32x16_bf16 v[64:79], v[176:179], v[144:147], v[64:79]
    ds_read_b64_tr_b16 v[224:225], v18 offset:49152
    ds_read_b64_tr_b16 v[226:227], v18 offset:50176
    ds_read_b64_tr_b16 v[228:229], v19 offset:49152
    v_mfma_f32_32x32x16_bf16 v[80:95], v[180:183], v[144:147], v[80:95]
    ds_read_b64_tr_b16 v[230:231], v19 offset:50176
    ds_read_b64_tr_b16 v[232:233], v18 offset:53248
    ds_read_b64_tr_b16 v[234:235], v18 offset:54272
    v_mfma_f32_32x32x16_bf16 v[96:111], v[176:179], v[148:151], v[96:111]
    ds_read_b64_tr_b16 v[236:237], v19 offset:53248
    ds_read_b64_tr_b16 v[238:239], v19 offset:54272
    ds_read_b64_tr_b16 v[240:241], v18 offset:57344
    v_mfma_f32_32x32x16_bf16 v[112:127], v[180:183], v[148:151], v[112:127]
    ds_read_b64_tr_b16 v[242:243], v18 offset:58368
    ds_read_b64_tr_b16 v[244:245], v19 offset:57344
    ds_read_b64_tr_b16 v[246:247], v19 offset:58368
    v_mfma_f32_32x32x16_bf16 v[64:79], v[184:187], v[152:155], v[64:79]
    ds_read_b64_tr_b16 v[248:249], v18 offset:61440
    ds_read_b64_tr_b16 v[250:251], v18 offset:62464
    ds_read_b64_tr_b16 v[252:253], v19 offset:61440
    v_mfma_f32_32x32x16_bf16 v[80:95], v[188:191], v[152:155], v[80:95]
    ds_read_b64_tr_b16 v[254:255], v19 offset:62464
    v_mfma_f32_32x32x16_bf16 v[96:111], v[184:187], v[156:159], v[96:111]
    v_mfma_f32_32x32x16_bf16 v[112:127], v[188:191], v[156:159], v[112:127]
    s_add_u32 m0, s33, 32768
    s_nop 0
    buffer_load_dwordx4 v5, s[12:15], s30 offen offset:0  lds
    buffer_load_dwordx4 v6, s[12:15], s30 offen offset:1024  lds
    buffer_load_dwordx4 v7, s[12:15], s30 offen offset:2048  lds
    buffer_load_dwordx4 v8, s[12:15], s30 offen offset:3072  lds
    s_add_u32 s30, s30, 245760
    s_cmp_eq_u32 s30, s32
    s_cselect_b32 s30, s31, s30
    s_waitcnt vmcnt(12) lgkmcnt(0)
    s_barrier
    v_mfma_f32_32x32x16_bf16 v[64:79], v[224:227], v[192:195], v[64:79]
    ds_read_b128 v[128:131], v14 offset:0
    ds_read_b128 v[132:135], v14 offset:4096
    v_mfma_f32_32x32x16_bf16 v[80:95], v[228:231], v[192:195], v[80:95]
    ds_read_b128 v[136:139], v15 offset:0
    ds_read_b128 v[140:143], v15 offset:4096
    v_mfma_f32_32x32x16_bf16 v[96:111], v[224:227], v[196:199], v[96:111]
    ds_read_b128 v[144:147], v16 offset:0
    ds_read_b128 v[148:151], v16 offset:4096
    v_mfma_f32_32x32x16_bf16 v[112:127], v[228:231], v[196:199], v[112:127]
    ds_read_b128 v[152:155], v17 offset:0
    ds_read_b128 v[156:159], v17 offset:4096
    v_mfma_f32_32x32x16_bf16 v[64:79], v[232:235], v[200:203], v[64:79]
    v_mfma_f32_32x32x16_bf16 v[80:95], v[236:239], v[200:203], v[80:95]
    v_mfma_f32_32x32x16_bf16 v[96:111], v[232:235], v[204:207], v[96:111]
    v_mfma_f32_32x32x16_bf16 v[112:127], v[236:239], v[204:207], v[112:127]
    s_add_u32 m0, s33, 49152
    s_nop 0
    buffer_load_dwordx4 v1, s[8:11], s27 offen offset:0  lds
    buffer_load_dwordx4 v2, s[8:11], s27 offen offset:1024  lds
    buffer_load_dwordx4 v3, s[8:11], s27 offen offset:2048  lds
    buffer_load_dwordx4 v4, s[8:11], s27 offen offset:3072  lds
    s_add_u32 s27, s27, 128
    s_cmp_eq_u32 s27, s29
    s_cselect_b32 s27, s28, s27
    s_waitcnt vmcnt(12) lgkmcnt(0)
    s_barrier
    v_mfma_f32_32x32x16_bf16 v[64:79], v[240:243], v[208:211], v[64:79]
    ds_read_b64_tr_b16 v[160:161], v18 offset:0
    ds_read_b64_tr_b16 v[162:163], v18 offset:1024
    ds_read_b64_tr_b16 v[164:165], v19 offset:0
    v_mfma_f32_32x32x16_bf16 v[80:95], v[244:247], v[208:211], v[80:95]
    ds_read_b64_tr_b16 v[166:167], v19 offset:1024
    ds_read_b64_tr_b16 v[168:169], v18 offset:4096
    ds_read_b64_tr_b16 v[170:171], v18 offset:5120
    v_mfma_f32_32x32x16_bf16 v[96:111], v[240:243], v[212:215], v[96:111]
    ds_read_b64_tr_b16 v[172:173], v19 offset:4096
    ds_read_b64_tr_b16 v[174:175], v19 offset:5120
    ds_read_b64_tr_b16 v[176:177], v18 offset:8192
    v_mfma_f32_32x32x16_bf16 v[112:127], v[244:247], v[212:215], v[112:127]
    ds_read_b64_tr_b16 v[178:179], v18 offset:9216
    ds_read_b64_tr_b16 v[180:181], v19 offset:8192
    ds_read_b64_tr_b16 v[182:183], v19 offset:9216
    v_mfma_f32_32x32x16_bf16 v[64:79], v[248:251], v[216:219], v[64:79]
    ds_read_b64_tr_b16 v[184:185], v18 offset:12288
    ds_read_b64_tr_b16 v[186:187], v18 offset:13312
    ds_read_b64_tr_b16 v[188:189], v19 offset:12288
    v_mfma_f32_32x32x16_bf16 v[80:95], v[252:255], v[216:219], v[80:95]
    ds_read_b64_tr_b16 v[190:191], v19 offset:13312
    v_mfma_f32_32x32x16_bf16 v[96:111], v[248:251], v[220:223], v[96:111]
    v_mfma_f32_32x32x16_bf16 v[112:127], v[252:255], v[220:223], v[112:127]
    s_add_u32 m0, s33, 65536
    s_nop 0
    buffer_load_dwordx4 v5, s[12:15], s30 offen offset:0  lds
    buffer_load_dwordx4 v6, s[12:15], s30 offen offset:1024  lds
    buffer_load_dwordx4 v7, s[12:15], s30 offen offset:2048  lds
    buffer_load_dwordx4 v8, s[12:15], s30 offen offset:3072  lds
    s_add_u32 s30, s30, 245760
    s_cmp_eq_u32 s30, s32
    s_cselect_b32 s30, s31, s30
    s_waitcnt vmcnt(12) lgkmcnt(0)
    s_barrier
    v_mfma_f32_32x32x16_bf16 v[64:79], v[160:163], v[128:131], v[64:79]
    s_add_u32 m0, s33, 0
    s_nop 0
    ds_read_b128 v[192:195], v10 offset:16384
    ds_read_b128 v[196:199], v10 offset:20480
    buffer_load_dwordx4 v1, s[8:11], s27 offen offset:0  lds
    v_mfma_f32_32x32x16_bf16 v[80:95], v[164:167], v[128:131], v[80:95]
    ds_read_b128 v[200:203], v11 offset:16384
    ds_read_b128 v[204:207], v11 offset:20480
    buffer_load_dwordx4 v2, s[8:11], s27 offen offset:1024  lds
    v_mfma_f32_32x32x16_bf16 v[96:111], v[160:163], v[132:135], v[96:111]
    ds_read_b128 v[208:211], v12 offset:16384
    ds_read_b128 v[212:215], v12 offset:20480
    buffer_load_dwordx4 v3, s[8:11], s27 offen offset:2048  lds
    v_mfma_f32_32x32x16_bf16 v[112:127], v[164:167], v[132:135], v[112:127]
    ds_read_b128 v[216:219], v13 offset:16384
    ds_read_b128 v[220:223], v13 offset:20480
    buffer_load_dwordx4 v4, s[8:11], s27 offen offset:3072  lds
    s_add_u32 s27, s27, 128
    s_cmp_eq_u32 s27, s29
    s_cselect_b32 s27, s28, s27
    v_mfma_f32_32x32x16_bf16 v[64:79], v[168:171], v[136:139], v[64:79]
    v_mfma_f32_32x32x16_bf16 v[80:95], v[172:175], v[136:139], v[80:95]
    v_mfma_f32_32x32x16_bf16 v[96:111], v[168:171], v[140:143], v[96:111]
    v_mfma_f32_32x32x16_bf16 v[112:127], v[172:175], v[140:143], v[112:127]
    s_waitcnt vmcnt(12) lgkmcnt(0)
    s_barrier
    v_mfma_f32_32x32x16_bf16 v[64:79], v[176:179], v[144:147], v[64:79]
    s_add_u32 m0, s33, 16384
    s_nop 0
    ds_read_b64_tr_b16 v[224:225], v18 offset:32768
    ds_read_b64_tr_b16 v[226:227], v18 offset:33792
    ds_read_b64_tr_b16 v[228:229], v19 offset:32768
    buffer_load_dwordx4 v5, s[12:15], s30 offen offset:0  lds
    v_mfma_f32_32x32x16_bf16 v[80:95], v[180:183], v[144:147], v[80:95]
    ds_read_b64_tr_b16 v[230:231], v19 offset:33792
    ds_read_b64_tr_b16 v[232:233], v18 offset:36864
    ds_read_b64_tr_b16 v[234:235], v18 offset:37888
    buffer_load_dwordx4 v6, s[12:15], s30 offen offset:1024  lds
    v_mfma_f32_32x32x16_bf16 v[96:111], v[176:179], v[148:151], v[96:111]
    ds_read_b64_tr_b16 v[236:237], v19 offset:36864
    ds_read_b64_tr_b16 v[238:239], v19 offset:37888
    ds_read_b64_tr_b16 v[240:241], v18 offset:40960
    buffer_load_dwordx4 v7, s[12:15], s30 offen offset:2048  lds
    v_mfma_f32_32x32x16_bf16 v[112:127], v[180:183], v[148:151], v[112:127]
    ds_read_b64_tr_b16 v[242:243], v18 offset:41984
    ds_read_b64_tr_b16 v[244:245], v19 offset:40960
    ds_read_b64_tr_b16 v[246:247], v19 offset:41984
    buffer_load_dwordx4 v8, s[12:15], s30 offen offset:3072  lds
    s_add_u32 s30, s30, 245760
    s_cmp_eq_u32 s30, s32
    s_cselect_b32 s30, s31, s30
    v_mfma_f32_32x32x16_bf16 v[64:79], v[184:187], v[152:155], v[64:79]
    ds_read_b64_tr_b16 v[248:249], v18 offset:45056
    ds_read_b64_tr_b16 v[250:251], v18 offset:46080
    ds_read_b64_tr_b16 v[252:253], v19 offset:45056
    v_mfma_f32_32x32x16_bf16 v[80:95], v[188:191], v[152:155], v[80:95]
    ds_read_b64_tr_b16 v[254:255], v19 offset:46080
    v_mfma_f32_32x32x16_bf16 v[96:111], v[184:187], v[156:159], v[96:111]
    v_mfma_f32_32x32x16_bf16 v[112:127], v[188:191], v[156:159], v[112:127]
    s_waitcnt vmcnt(12) lgkmcnt(0)
    s_barrier
    v_mfma_f32_32x32x16_bf16 v[64:79], v[224:227], v[192:195], v[64:79]
    s_add_u32 m0, s33, 32768
    s_nop 0
    ds_read_b128 v[128:131], v10 offset:49152
    ds_read_b128 v[132:135], v10 offset:53248
    buffer_load_dwordx4 v1, s[8:11], s27 offen offset:0  lds
    v_mfma_f32_32x32x16_bf16 v[80:95], v[228:231], v[192:195], v[80:95]
    ds_read_b128 v[136:139], v11 offset:49152
    ds_read_b128 v[140:143], v11 offset:53248
    buffer_load_dwordx4 v2, s[8:11], s27 offen offset:1024  lds
    v_mfma_f32_32x32x16_bf16 v[96:111], v[224:227], v[196:199], v[96:111]
    ds_read_b128 v[144:147], v12 offset:49152
    ds_read_b128 v[148:151], v12 offset:53248
    buffer_load_dwordx4 v3, s[8:11], s27 offen offset:2048  lds
    v_mfma_f32_32x32x16_bf16 v[112:127], v[228:231], v[196:199], v[112:127]
    ds_read_b128 v[152:155], v13 offset:49152
    ds_read_b128 v[156:159], v13 offset:53248
    buffer_load_dwordx4 v4, s[8:11], s27 offen offset:3072  lds
    s_add_u32 s27, s27, 128
    s_cmp_eq_u32 s27, s29
    s_cselect_b32 s27, s28, s27
    v_mfma_f32_32x32x16_bf16 v[64:79], v[232:235], v[200:203], v[64:79]
    v_mfma_f32_32x32x16_bf16 v[80:95], v[236:239], v[200:203], v[80:95]
    v_mfma_f32_32x32x16_bf16 v[96:111], v[232:235], v[204:207], v[96:111]
    v_mfma_f32_32x32x16_bf16 v[112:127], v[236:239], v[204:207], v[112:127]
    s_waitcnt vmcnt(12) lgkmcnt(0)
    s_barrier
    v_mfma_f32_32x32x16_bf16 v[64:79], v[240:243], v[208:211], v[64:79]
    s_add_u32 m0, s33, 49152
    s_nop 0
    ds_read_b64_tr_b16 v[160:161], v20 offset:0
    ds_read_b64_tr_b16 v[162:163], v20 offset:1024
    ds_read_b64_tr_b16 v[164:165], v21 offset:0
    buffer_load_dwordx4 v5, s[12:15], s30 offen offset:0  lds
    v_mfma_f32_32x32x16_bf16 v[80:95], v[244:247], v[208:211], v[80:95]
    ds_read_b64_tr_b16 v[166:167], v21 offset:1024
    ds_read_b64_tr_b16 v[168:169], v20 offset:4096
    ds_read_b64_tr_b16 v[170:171], v20 offset:5120
    buffer_load_dwordx4 v6, s[12:15], s30 offen offset:1024  lds
    v_mfma_f32_32x32x16_bf16 v[96:111], v[240:243], v[212:215], v[96:111]
    ds_read_b64_tr_b16 v[172:173], v21 offset:4096
    ds_read_b64_tr_b16 v[174:175], v21 offset:5120
    ds_read_b64_tr_b16 v[176:177], v20 offset:8192
    buffer_load_dwordx4 v7, s[12:15], s30 offen offset:2048  lds
    v_mfma_f32_32x32x16_bf16 v[112:127], v[244:247], v[212:215], v[112:127]
    ds_read_b64_tr_b16 v[178:179], v20 offset:9216
    ds_read_b64_tr_b16 v[180:181], v21 offset:8192
    ds_read_b64_tr_b16 v[182:183], v21 offset:9216
    buffer_load_dwordx4 v8, s[12:15], s30 offen offset:3072  lds
    s_add_u32 s30, s30, 245760
    s_cmp_eq_u32 s30, s32
    s_cselect_b32 s30, s31, s30
    v_mfma_f32_32x32x16_bf16 v[64:79], v[248:251], v[216:219], v[64:79]
    ds_read_b64_tr_b16 v[184:185], v20 offset:12288
    ds_read_b64_tr_b16 v[186:187], v20 offset:13312
    ds_read_b64_tr_b16 v[188:189], v21 offset:12288
    v_mfma_f32_32x32x16_bf16 v[80:95], v[252:255], v[216:219], v[80:95]
    ds_read_b64_tr_b16 v[190:191], v21 offset:13312
    v_mfma_f32_32x32x16_bf16 v[96:111], v[248:251], v[220:223], v[96:111]
    v_mfma_f32_32x32x16_bf16 v[112:127], v[252:255], v[220:223], v[112:127]
    s_mov_b32 s20, s44
    s_mov_b32 s21, s45
    s_mov_b32 s22, 256
    s_mov_b32 s23, 0x00020000
    v_mov_b32 v34, 0
    buffer_load_dword v35, v34, s[20:23], 0 offen sc1
    s_waitcnt vmcnt(12) lgkmcnt(0)
    s_barrier
    v_mfma_f32_32x32x16_bf16 v[64:79], v[160:163], v[128:131], v[64:79]
    s_add_u32 m0, s33, 65536
    s_nop 0
    ds_read_b128 v[192:195], v10 offset:0
    ds_read_b128 v[196:199], v10 offset:4096
    buffer_load_dwordx4 v1, s[8:11], s27 offen offset:0  lds
    v_mfma_f32_32x32x16_bf16 v[80:95], v[164:167], v[128:131], v[80:95]
    ds_read_b128 v[200:203], v11 offset:0
    ds_read_b128 v[204:207], v11 offset:4096
    buffer_load_dwordx4 v2, s[8:11], s27 offen offset:1024  lds
    v_mfma_f32_32x32x16_bf16 v[96:111], v[160:163], v[132:135], v[96:111]
    ds_read_b128 v[208:211], v12 offset:0
    ds_read_b128 v[212:215], v12 offset:4096
    buffer_load_dwordx4 v3, s[8:11], s27 offen offset:2048  lds
    v_mfma_f32_32x32x16_bf16 v[112:127], v[164:167], v[132:135], v[112:127]
    ds_read_b128 v[216:219], v13 offset:0
    ds_read_b128 v[220:223], v13 offset:4096
    buffer_load_dwordx4 v4, s[8:11], s27 offen offset:3072  lds
    s_add_u32 s27, s27, 128
    s_cmp_eq_u32 s27, s29
    s_cselect_b32 s27, s28, s27
    v_mfma_f32_32x32x16_bf16 v[64:79], v[168:171], v[136:139], v[64:79]
    v_mfma_f32_32x32x16_bf16 v[80:95], v[172:175], v[136:139], v[80:95]
    v_mfma_f32_32x32x16_bf16 v[96:111], v[168:171], v[140:143], v[96:111]
    v_mfma_f32_32x32x16_bf16 v[112:127], v[172:175], v[140:143], v[112:127]
    s_waitcnt vmcnt(12) lgkmcnt(0)
    s_barrier
    v_mfma_f32_32x32x16_bf16 v[64:79], v[176:179], v[144:147], v[64:79]
    s_add_u32 m0, s33, 0
    s_nop 0
    ds_read_b64_tr_b16 v[224:225], v18 offset:16384
    ds_read_b64_tr_b16 v[226:227], v18 offset:17408
    ds_read_b64_tr_b16 v[228:229], v19 offset:16384
    buffer_load_dwordx4 v5, s[12:15], s30 offen offset:0  lds
    v_mfma_f32_32x32x16_bf16 v[80:95], v[180:183], v[144:147], v[80:95]
    ds_read_b64_tr_b16 v[230:231], v19 offset:17408
    ds_read_b64_tr_b16 v[232:233], v18 offset:20480
    ds_read_b64_tr_b16 v[234:235], v18 offset:21504
    buffer_load_dwordx4 v6, s[12:15], s30 offen offset:1024  lds
    v_mfma_f32_32x32x16_bf16 v[96:111], v[176:179], v[148:151], v[96:111]
    ds_read_b64_tr_b16 v[236:237], v19 offset:20480
    ds_read_b64_tr_b16 v[238:239], v19 offset:21504
    ds_read_b64_tr_b16 v[240:241], v18 offset:24576
    buffer_load_dwordx4 v7, s[12:15], s30 offen offset:2048  lds
    v_mfma_f32_32x32x16_bf16 v[112:127], v[180:183], v[148:151], v[112:127]
    ds_read_b64_tr_b16 v[242:243], v18 offset:25600
    ds_read_b64_tr_b16 v[244:245], v19 offset:24576
    ds_read_b64_tr_b16 v[246:247], v19 offset:25600
    buffer_load_dwordx4 v8, s[12:15], s30 offen offset:3072  lds
    s_add_u32 s30, s30, 245760
    s_cmp_eq_u32 s30, s32
    s_cselect_b32 s30, s31, s30
    v_mfma_f32_32x32x16_bf16 v[64:79], v[184:187], v[152:155], v[64:79]
    ds_read_b64_tr_b16 v[248:249], v18 offset:28672
    ds_read_b64_tr_b16 v[250:251], v18 offset:29696
    ds_read_b64_tr_b16 v[252:253], v19 offset:28672
    v_mfma_f32_32x32x16_bf16 v[80:95], v[188:191], v[152:155], v[80:95]
    ds_read_b64_tr_b16 v[254:255], v19 offset:29696
    v_mfma_f32_32x32x16_bf16 v[96:111], v[184:187], v[156:159], v[96:111]
    v_mfma_f32_32x32x16_bf16 v[112:127], v[188:191], v[156:159], v[112:127]
    s_waitcnt vmcnt(12) lgkmcnt(0)
    s_barrier
    v_mfma_f32_32x32x16_bf16 v[64:79], v[224:227], v[192:195], v[64:79]
    s_add_u32 m0, s33, 16384
    s_nop 0
    ds_read_b128 v[128:131], v10 offset:32768
    ds_read_b128 v[132:135], v10 offset:36864
    buffer_load_dwordx4 v1, s[8:11], s27 offen offset:0  lds
    v_mfma_f32_32x32x16_bf16 v[80:95], v[228:231], v[192:195], v[80:95]
    ds_read_b128 v[136:139], v11 offset:32768
    ds_read_b128 v[140:143], v11 offset:36864
    buffer_load_dwordx4 v2, s[8:11], s27 offen offset:1024  lds
    v_mfma_f32_32x32x16_bf16 v[96:111], v[224:227], v[196:199], v[96:111]
    ds_read_b128 v[144:147], v12 offset:32768
    ds_read_b128 v[148:151], v12 offset:36864
    buffer_load_dwordx4 v3, s[8:11], s27 offen offset:2048  lds
    v_mfma_f32_32x32x16_bf16 v[112:127], v[228:231], v[196:199], v[112:127]
    ds_read_b128 v[152:155], v13 offset:32768
    ds_read_b128 v[156:159], v13 offset:36864
    buffer_load_dwordx4 v4, s[8:11], s27 offen offset:3072  lds
    s_add_u32 s27, s27, 128
    s_cmp_eq_u32 s27, s29
    s_cselect_b32 s27, s28, s27
    v_mfma_f32_32x32x16_bf16 v[64:79], v[232:235], v[200:203], v[64:79]
    v_mfma_f32_32x32x16_bf16 v[80:95], v[236:239], v[200:203], v[80:95]
    v_mfma_f32_32x32x16_bf16 v[96:111], v[232:235], v[204:207], v[96:111]
    v_mfma_f32_32x32x16_bf16 v[112:127], v[236:239], v[204:207], v[112:127]
    s_waitcnt vmcnt(12) lgkmcnt(0)
    s_barrier
    v_mfma_f32_32x32x16_bf16 v[64:79], v[240:243], v[208:211], v[64:79]
    s_add_u32 m0, s33, 32768
    s_nop 0
    ds_read_b64_tr_b16 v[160:161], v18 offset:49152
    ds_read_b64_tr_b16 v[162:163], v18 offset:50176
    ds_read_b64_tr_b16 v[164:165], v19 offset:49152
    buffer_load_dwordx4 v5, s[12:15], s30 offen offset:0  lds
    v_mfma_f32_32x32x16_bf16 v[80:95], v[244:247], v[208:211], v[80:95]
    ds_read_b64_tr_b16 v[166:167], v19 offset:50176
    ds_read_b64_tr_b16 v[168:169], v18 offset:53248
    ds_read_b64_tr_b16 v[170:171], v18 offset:54272
    buffer_load_dwordx4 v6, s[12:15], s30 offen offset:1024  lds
    v_mfma_f32_32x32x16_bf16 v[96:111], v[240:243], v[212:215], v[96:111]
    ds_read_b64_tr_b16 v[172:173], v19 offset:53248
    ds_read_b64_tr_b16 v[174:175], v19 offset:54272
    ds_read_b64_tr_b16 v[176:177], v18 offset:57344
    buffer_load_dwordx4 v7, s[12:15], s30 offen offset:2048  lds
    v_mfma_f32_32x32x16_bf16 v[112:127], v[244:247], v[212:215], v[112:127]
    ds_read_b64_tr_b16 v[178:179], v18 offset:58368
    ds_read_b64_tr_b16 v[180:181], v19 offset:57344
    ds_read_b64_tr_b16 v[182:183], v19 offset:58368
    buffer_load_dwordx4 v8, s[12:15], s30 offen offset:3072  lds
    s_add_u32 s30, s30, 245760
    s_cmp_eq_u32 s30, s32
    s_cselect_b32 s30, s31, s30
    v_mfma_f32_32x32x16_bf16 v[64:79], v[248:251], v[216:219], v[64:79]
    ds_read_b64_tr_b16 v[184:185], v18 offset:61440
    ds_read_b64_tr_b16 v[186:187], v18 offset:62464
    ds_read_b64_tr_b16 v[188:189], v19 offset:61440
    v_mfma_f32_32x32x16_bf16 v[80:95], v[252:255], v[216:219], v[80:95]
    ds_read_b64_tr_b16 v[190:191], v19 offset:62464
    v_mfma_f32_32x32x16_bf16 v[96:111], v[248:251], v[220:223], v[96:111]
    v_mfma_f32_32x32x16_bf16 v[112:127], v[252:255], v[220:223], v[112:127]
    s_waitcnt vmcnt(12) lgkmcnt(0)
    s_barrier
    v_mfma_f32_32x32x16_bf16 v[64:79], v[160:163], v[128:131], v[64:79]
    s_add_u32 m0, s33, 49152
    s_nop 0
    ds_read_b128 v[192:195], v14 offset:0
    ds_read_b128 v[196:199], v14 offset:4096
    buffer_load_dwordx4 v1, s[8:11], s27 offen offset:0  lds
    v_mfma_f32_32x32x16_bf16 v[80:95], v[164:167], v[128:131], v[80:95]
    ds_read_b128 v[200:203], v15 offset:0
    ds_read_b128 v[204:207], v15 offset:4096
    buffer_load_dwordx4 v2, s[8:11], s27 offen offset:1024  lds
    v_mfma_f32_32x32x16_bf16 v[96:111], v[160:163], v[132:135], v[96:111]
    ds_read_b128 v[208:211], v16 offset:0
    ds_read_b128 v[212:215], v16 offset:4096
    buffer_load_dwordx4 v3, s[8:11], s27 offen offset:2048  lds
    v_mfma_f32_32x32x16_bf16 v[112:127], v[164:167], v[132:135], v[112:127]
    ds_read_b128 v[216:219], v17 offset:0
    ds_read_b128 v[220:223], v17 offset:4096
    buffer_load_dwordx4 v4, s[8:11], s27 offen offset:3072  lds
    s_add_u32 s27, s27, 128
    s_cmp_eq_u32 s27, s29
    s_cselect_b32 s27, s28, s27
    v_mfma_f32_32x32x16_bf16 v[64:79], v[168:171], v[136:139], v[64:79]
    v_mfma_f32_32x32x16_bf16 v[80:95], v[172:175], v[136:139], v[80:95]
    v_mfma_f32_32x32x16_bf16 v[96:111], v[168:171], v[140:143], v[96:111]
    v_mfma_f32_32x32x16_bf16 v[112:127], v[172:175], v[140:143], v[112:127]
    s_waitcnt vmcnt(12) lgkmcnt(0)
    s_barrier
    v_mfma_f32_32x32x16_bf16 v[64:79], v[176:179], v[144:147], v[64:79]
    s_add_u32 m0, s33, 65536
    s_nop 0
    ds_read_b64_tr_b16 v[224:225], v18 offset:0
    ds_read_b64_tr_b16 v[226:227], v18 offset:1024
    ds_read_b64_tr_b16 v[228:229], v19 offset:0
    buffer_load_dwordx4 v5, s[12:15], s30 offen offset:0  lds
    v_mfma_f32_32x32x16_bf16 v[80:95], v[180:183], v[144:147], v[80:95]
    ds_read_b64_tr_b16 v[230:231], v19 offset:1024
    ds_read_b64_tr_b16 v[232:233], v18 offset:4096
    ds_read_b64_tr_b16 v[234:235], v18 offset:5120
    buffer_load_dwordx4 v6, s[12:15], s30 offen offset:1024  lds
    v_mfma_f32_32x32x16_bf16 v[96:111], v[176:179], v[148:151], v[96:111]
    ds_read_b64_tr_b16 v[236:237], v19 offset:4096
    ds_read_b64_tr_b16 v[238:239], v19 offset:5120
    ds_read_b64_tr_b16 v[240:241], v18 offset:8192
    buffer_load_dwordx4 v7, s[12:15], s30 offen offset:2048  lds
    v_mfma_f32_32x32x16_bf16 v[112:127], v[180:183], v[148:151], v[112:127]
    ds_read_b64_tr_b16 v[242:243], v18 offset:9216
    ds_read_b64_tr_b16 v[244:245], v19 offset:8192
    ds_read_b64_tr_b16 v[246:247], v19 offset:9216
    buffer_load_dwordx4 v8, s[12:15], s30 offen offset:3072  lds
    s_add_u32 s30, s30, 245760
    s_cmp_eq_u32 s30, s32
    s_cselect_b32 s30, s31, s30
    v_mfma_f32_32x32x16_bf16 v[64:79], v[184:187], v[152:155], v[64:79]
    ds_read_b64_tr_b16 v[248:249], v18 offset:12288
    ds_read_b64_tr_b16 v[250:251], v18 offset:13312
    ds_read_b64_tr_b16 v[252:253], v19 offset:12288
    v_mfma_f32_32x32x16_bf16 v[80:95], v[188:191], v[152:155], v[80:95]
    ds_read_b64_tr_b16 v[254:255], v19 offset:13312
    v_mfma_f32_32x32x16_bf16 v[96:111], v[184:187], v[156:159], v[96:111]
    v_mfma_f32_32x32x16_bf16 v[112:127], v[188:191], v[156:159], v[112:127]
    s_waitcnt vmcnt(12) lgkmcnt(0)
    s_barrier
    v_mfma_f32_32x32x16_bf16 v[64:79], v[224:227], v[192:195], v[64:79]
    ds_read_b128 v[128:131], v10 offset:16384
    ds_read_b128 v[132:135], v10 offset:20480
    v_mfma_f32_32x32x16_bf16 v[80:95], v[228:231], v[192:195], v[80:95]
    ds_read_b128 v[136:139], v11 offset:16384
    ds_read_b128 v[140:143], v11 offset:20480
    v_mfma_f32_32x32x16_bf16 v[96:111], v[224:227], v[196:199], v[96:111]
    ds_read_b128 v[144:147], v12 offset:16384
    ds_read_b128 v[148:151], v12 offset:20480
    v_mfma_f32_32x32x16_bf16 v[112:127], v[228:231], v[196:199], v[112:127]
    ds_read_b128 v[152:155], v13 offset:16384
    ds_read_b128 v[156:159], v13 offset:20480
    v_mfma_f32_32x32x16_bf16 v[64:79], v[232:235], v[200:203], v[64:79]
    v_mfma_f32_32x32x16_bf16 v[80:95], v[236:239], v[200:203], v[80:95]
    v_mfma_f32_32x32x16_bf16 v[96:111], v[232:235], v[204:207], v[96:111]
    v_mfma_f32_32x32x16_bf16 v[112:127], v[236:239], v[204:207], v[112:127]
    s_waitcnt vmcnt(8) lgkmcnt(0)
    s_barrier
    v_mfma_f32_32x32x16_bf16 v[64:79], v[240:243], v[208:211], v[64:79]
    ds_read_b64_tr_b16 v[160:161], v18 offset:32768
    ds_read_b64_tr_b16 v[162:163], v18 offset:33792
    ds_read_b64_tr_b16 v[164:165], v19 offset:32768
    v_mfma_f32_32x32x16_bf16 v[80:95], v[244:247], v[208:211], v[80:95]
    ds_read_b64_tr_b16 v[166:167], v19 offset:33792
    ds_read_b64_tr_b16 v[168:169], v18 offset:36864
    ds_read_b64_tr_b16 v[170:171], v18 offset:37888
    v_mfma_f32_32x32x16_bf16 v[96:111], v[240:243], v[212:215], v[96:111]
    ds_read_b64_tr_b16 v[172:173], v19 offset:36864
    ds_read_b64_tr_b16 v[174:175], v19 offset:37888
    ds_read_b64_tr_b16 v[176:177], v18 offset:40960
    v_mfma_f32_32x32x16_bf16 v[112:127], v[244:247], v[212:215], v[112:127]
    ds_read_b64_tr_b16 v[178:179], v18 offset:41984
    ds_read_b64_tr_b16 v[180:181], v19 offset:40960
    ds_read_b64_tr_b16 v[182:183], v19 offset:41984
    v_mfma_f32_32x32x16_bf16 v[64:79], v[248:251], v[216:219], v[64:79]
    ds_read_b64_tr_b16 v[184:185], v18 offset:45056
    ds_read_b64_tr_b16 v[186:187], v18 offset:46080
    ds_read_b64_tr_b16 v[188:189], v19 offset:45056
    v_mfma_f32_32x32x16_bf16 v[80:95], v[252:255], v[216:219], v[80:95]
    ds_read_b64_tr_b16 v[190:191], v19 offset:46080
    v_mfma_f32_32x32x16_bf16 v[96:111], v[248:251], v[220:223], v[96:111]
    v_mfma_f32_32x32x16_bf16 v[112:127], v[252:255], v[220:223], v[112:127]
    s_waitcnt vmcnt(4) lgkmcnt(0)
    s_barrier
    v_mfma_f32_32x32x16_bf16 v[64:79], v[160:163], v[128:131], v[64:79]
    ds_read_b128 v[192:195], v10 offset:49152
    ds_read_b128 v[196:199], v10 offset:53248
    v_mfma_f32_32x32x16_bf16 v[80:95], v[164:167], v[128:131], v[80:95]
    ds_read_b128 v[200:203], v11 offset:49152
    ds_read_b128 v[204:207], v11 offset:53248
    v_mfma_f32_32x32x16_bf16 v[96:111], v[160:163], v[132:135], v[96:111]
    ds_read_b128 v[208:211], v12 offset:49152
    ds_read_b128 v[212:215], v12 offset:53248
    v_mfma_f32_32x32x16_bf16 v[112:127], v[164:167], v[132:135], v[112:127]
    ds_read_b128 v[216:219], v13 offset:49152
    ds_read_b128 v[220:223], v13 offset:53248
    v_mfma_f32_32x32x16_bf16 v[64:79], v[168:171], v[136:139], v[64:79]
    v_mfma_f32_32x32x16_bf16 v[80:95], v[172:175], v[136:139], v[80:95]
    v_mfma_f32_32x32x16_bf16 v[96:111], v[168:171], v[140:143], v[96:111]
    v_mfma_f32_32x32x16_bf16 v[112:127], v[172:175], v[140:143], v[112:127]
    s_waitcnt vmcnt(0) lgkmcnt(0)
    s_barrier
    v_mfma_f32_32x32x16_bf16 v[64:79], v[176:179], v[144:147], v[64:79]
    ds_read_b64_tr_b16 v[224:225], v20 offset:0
    ds_read_b64_tr_b16 v[226:227], v20 offset:1024
    ds_read_b64_tr_b16 v[228:229], v21 offset:0
    v_mfma_f32_32x32x16_bf16 v[80:95], v[180:183], v[144:147], v[80:95]
    ds_read_b64_tr_b16 v[230:231], v21 offset:1024
    ds_read_b64_tr_b16 v[232:233], v20 offset:4096
    ds_read_b64_tr_b16 v[234:235], v20 offset:5120
    v_mfma_f32_32x32x16_bf16 v[96:111], v[176:179], v[148:151], v[96:111]
    ds_read_b64_tr_b16 v[236:237], v21 offset:4096
    ds_read_b64_tr_b16 v[238:239], v21 offset:5120
    ds_read_b64_tr_b16 v[240:241], v20 offset:8192
    v_mfma_f32_32x32x16_bf16 v[112:127], v[180:183], v[148:151], v[112:127]
    ds_read_b64_tr_b16 v[242:243], v20 offset:9216
    ds_read_b64_tr_b16 v[244:245], v21 offset:8192
    ds_read_b64_tr_b16 v[246:247], v21 offset:9216
    v_mfma_f32_32x32x16_bf16 v[64:79], v[184:187], v[152:155], v[64:79]
    ds_read_b64_tr_b16 v[248:249], v20 offset:12288
    ds_read_b64_tr_b16 v[250:251], v20 offset:13312
    ds_read_b64_tr_b16 v[252:253], v21 offset:12288
    v_mfma_f32_32x32x16_bf16 v[80:95], v[188:191], v[152:155], v[80:95]
    ds_read_b64_tr_b16 v[254:255], v21 offset:13312
    v_mfma_f32_32x32x16_bf16 v[96:111], v[184:187], v[156:159], v[96:111]
    v_mfma_f32_32x32x16_bf16 v[112:127], v[188:191], v[156:159], v[112:127]
    s_waitcnt lgkmcnt(0)
    s_mov_b32 s16, s46
    s_mov_b32 s17, s47
    s_mov_b32 s18, 18022400
    s_mov_b32 s19, 0x00020000
    v_lshlrev_b32 v24, 4, v22
    s_lshr_b32 s34, s64, 1
    s_lshl_b32 s34, s34, 1
    s_lshl_b32 s35, s25, 2
    s_add_u32 s34, s34, s35
    s_mul_i32 s34, s34, 81920
    s_lshl_b32 s35, s26, 13
    s_add_u32 s34, s34, s35
    s_and_b32 s35, s64, 1
    s_lshl_b32 s35, s35, 12
    s_add_u32 s34, s34, s35
    s_add_u32 s35, s34, 81920
    s_mov_b32 s36, 0x3ea52b5c
    s_cmp_ge_u32 s26, 5
    s_cselect_b32 s36, 1.0, s36
    s_mov_b32 s37, s36
    v_mfma_f32_32x32x16_bf16 v[64:79], v[224:227], v[192:195], v[64:79]
    v_mfma_f32_32x32x16_bf16 v[64:79], v[232:235], v[200:203], v[64:79]
    v_mfma_f32_32x32x16_bf16 v[64:79], v[240:243], v[208:211], v[64:79]
    v_mfma_f32_32x32x16_bf16 v[64:79], v[248:251], v[216:219], v[64:79]
    v_mfma_f32_32x32x16_bf16 v[80:95], v[228:231], v[192:195], v[80:95]
    v_mfma_f32_32x32x16_bf16 v[80:95], v[236:239], v[200:203], v[80:95]
    v_mfma_f32_32x32x16_bf16 v[80:95], v[244:247], v[208:211], v[80:95]
    s_nop 8
    v_pk_mul_f32 v[64:65], v[64:65], s[36:37]
    v_pk_mul_f32 v[66:67], v[66:67], s[36:37]
    v_pk_mul_f32 v[68:69], v[68:69], s[36:37]
    v_pk_mul_f32 v[70:71], v[70:71], s[36:37]
    v_cvt_pk_bf16_f32 v128, v64, v65
    v_mfma_f32_32x32x16_bf16 v[80:95], v[252:255], v[216:219], v[80:95]
    v_cvt_pk_bf16_f32 v129, v66, v67
    v_cvt_pk_bf16_f32 v130, v68, v69
    v_cvt_pk_bf16_f32 v131, v70, v71
    buffer_store_dwordx4 v[128:131], v24, s[16:19], s34 offen offset:0 sc1
    v_pk_mul_f32 v[72:73], v[72:73], s[36:37]
    v_mfma_f32_32x32x16_bf16 v[96:111], v[224:227], v[196:199], v[96:111]
    v_pk_mul_f32 v[74:75], v[74:75], s[36:37]
    v_pk_mul_f32 v[76:77], v[76:77], s[36:37]
    v_pk_mul_f32 v[78:79], v[78:79], s[36:37]
    v_cvt_pk_bf16_f32 v132, v72, v73
    v_cvt_pk_bf16_f32 v133, v74, v75
    v_mfma_f32_32x32x16_bf16 v[96:111], v[232:235], v[204:207], v[96:111]
    v_cvt_pk_bf16_f32 v134, v76, v77
    v_cvt_pk_bf16_f32 v135, v78, v79
    buffer_store_dwordx4 v[132:135], v24, s[16:19], s34 offen offset:1024 sc1
    v_mfma_f32_32x32x16_bf16 v[96:111], v[240:243], v[212:215], v[96:111]
    v_pk_mul_f32 v[80:81], v[80:81], s[36:37]
    v_pk_mul_f32 v[82:83], v[82:83], s[36:37]
    v_pk_mul_f32 v[84:85], v[84:85], s[36:37]
    v_pk_mul_f32 v[86:87], v[86:87], s[36:37]
    v_cvt_pk_bf16_f32 v136, v80, v81
    v_mfma_f32_32x32x16_bf16 v[96:111], v[248:251], v[220:223], v[96:111]
    v_cvt_pk_bf16_f32 v137, v82, v83
    v_cvt_pk_bf16_f32 v138, v84, v85
    v_cvt_pk_bf16_f32 v139, v86, v87
    buffer_store_dwordx4 v[136:139], v24, s[16:19], s34 offen offset:2048 sc1
    v_pk_mul_f32 v[88:89], v[88:89], s[36:37]
    v_mfma_f32_32x32x16_bf16 v[112:127], v[228:231], v[196:199], v[112:127]
    v_pk_mul_f32 v[90:91], v[90:91], s[36:37]
    v_pk_mul_f32 v[92:93], v[92:93], s[36:37]
    v_pk_mul_f32 v[94:95], v[94:95], s[36:37]
    v_cvt_pk_bf16_f32 v140, v88, v89
    v_cvt_pk_bf16_f32 v141, v90, v91
    v_mfma_f32_32x32x16_bf16 v[112:127], v[236:239], v[204:207], v[112:127]
    v_cvt_pk_bf16_f32 v142, v92, v93
    v_cvt_pk_bf16_f32 v143, v94, v95
    buffer_store_dwordx4 v[140:143], v24, s[16:19], s34 offen offset:3072 sc1
    v_mfma_f32_32x32x16_bf16 v[112:127], v[244:247], v[212:215], v[112:127]
    v_pk_mul_f32 v[96:97], v[96:97], s[36:37]
    v_pk_mul_f32 v[98:99], v[98:99], s[36:37]
    v_pk_mul_f32 v[100:101], v[100:101], s[36:37]
    v_pk_mul_f32 v[102:103], v[102:103], s[36:37]
    v_cvt_pk_bf16_f32 v144, v96, v97
    v_cvt_pk_bf16_f32 v145, v98, v99
    v_cvt_pk_bf16_f32 v146, v100, v101
    v_cvt_pk_bf16_f32 v147, v102, v103
    buffer_store_dwordx4 v[144:147], v24, s[16:19], s35 offen offset:0 sc1
    v_mfma_f32_32x32x16_bf16 v[112:127], v[252:255], v[220:223], v[112:127]
    v_pk_mul_f32 v[104:105], v[104:105], s[36:37]
    v_pk_mul_f32 v[106:107], v[106:107], s[36:37]
    v_pk_mul_f32 v[108:109], v[108:109], s[36:37]
    v_pk_mul_f32 v[110:111], v[110:111], s[36:37]
    v_cvt_pk_bf16_f32 v148, v104, v105
    v_cvt_pk_bf16_f32 v149, v106, v107
    v_cvt_pk_bf16_f32 v150, v108, v109
    v_cvt_pk_bf16_f32 v151, v110, v111
    buffer_store_dwordx4 v[148:151], v24, s[16:19], s35 offen offset:1024 sc1
    s_nop 2
    v_pk_mul_f32 v[112:113], v[112:113], s[36:37]
    v_pk_mul_f32 v[114:115], v[114:115], s[36:37]
    v_pk_mul_f32 v[116:117], v[116:117], s[36:37]
    v_pk_mul_f32 v[118:119], v[118:119], s[36:37]
    v_cvt_pk_bf16_f32 v152, v112, v113
    v_cvt_pk_bf16_f32 v153, v114, v115
    v_cvt_pk_bf16_f32 v154, v116, v117
    v_cvt_pk_bf16_f32 v155, v118, v119
    buffer_store_dwordx4 v[152:155], v24, s[16:19], s35 offen offset:2048 sc1
    v_pk_mul_f32 v[120:121], v[120:121], s[36:37]
    v_pk_mul_f32 v[122:123], v[122:123], s[36:37]
    v_pk_mul_f32 v[124:125], v[124:125], s[36:37]
    v_pk_mul_f32 v[126:127], v[126:127], s[36:37]
    v_cvt_pk_bf16_f32 v156, v120, v121
    v_cvt_pk_bf16_f32 v157, v122, v123
    v_cvt_pk_bf16_f32 v158, v124, v125
    v_cvt_pk_bf16_f32 v159, v126, v127
    buffer_store_dwordx4 v[156:159], v24, s[16:19], s35 offen offset:3072 sc1
    s_branch g3_done
g3_v:
    s_add_u32 m0, s33, 0
    s_nop 0
    buffer_load_dwordx4 v1, s[8:11], s27 offen offset:0  lds
    buffer_load_dwordx4 v2, s[8:11], s27 offen offset:1024  lds
    buffer_load_dwordx4 v3, s[8:11], s27 offen offset:2048  lds
    buffer_load_dwordx4 v4, s[8:11], s27 offen offset:3072  lds
    s_add_u32 s27, s27, 128
    s_cmp_eq_u32 s27, s29
    s_cselect_b32 s27, s28, s27
    s_add_u32 m0, s33, 16384
    s_nop 0
    buffer_load_dwordx4 v5, s[12:15], s30 offen offset:0  lds
    buffer_load_dwordx4 v6, s[12:15], s30 offen offset:1024  lds
    buffer_load_dwordx4 v7, s[12:15], s30 offen offset:2048  lds
    buffer_load_dwordx4 v8, s[12:15], s30 offen offset:3072  lds
    s_add_u32 s30, s30, 245760
    s_cmp_eq_u32 s30, s32
    s_cselect_b32 s30, s31, s30
    v_and_b32 v24, 31, v22
    s_lshr_b32 s34, s64, 1
    s_lshl_b32 s34, s34, 6
    v_add_u32 v24, s34, v24
    v_lshrrev_b32 v25, 5, v22
    v_lshrrev_b32 v26, 1, v24
    v_xor_b32 v26, v26, v25
    v_and_b32 v26, 7, v26
    v_lshlrev_b32 v26, 4, v26
    v_lshl_add_u32 v10, v24, 7, v26
    v_xor_b32 v11, 32, v10
    v_xor_b32 v12, 64, v10
    v_xor_b32 v13, 96, v10
    v_add_u32 v14, 65536, v10
    v_add_u32 v15, 65536, v11
    v_add_u32 v16, 65536, v12
    v_add_u32 v17, 65536, v13
    v_bfe_u32 v24, v22, 2, 2
    v_lshlrev_b32 v26, 3, v25
    v_add_u32 v26, v26, v24
    v_lshlrev_b32 v26, 8, v26
    s_and_b32 s34, s64, 1
    s_lshl_b32 s34, s34, 1
    v_xor_b32 v27, s34, v24
    v_lshlrev_b32 v27, 6, v27
    v_add_u32 v26, v26, v27
    v_and_b32 v27, 3, v22
    v_bfe_u32 v28, v22, 4, 1
    v_lshl_add_u32 v27, v28, 2, v27
    v_lshl_add_u32 v18, v27, 3, v26
    v_xor_b32 v19, 64, v18
    v_add_u32 v20, 65536, v18
    v_add_u32 v21, 65536, v19
    s_add_u32 m0, s33, 32768
    s_nop 0
    buffer_load_dwordx4 v1, s[8:11], s27 offen offset:0  lds
    buffer_load_dwordx4 v2, s[8:11], s27 offen offset:1024  lds
    buffer_load_dwordx4 v3, s[8:11], s27 offen offset:2048  lds
    buffer_load_dwordx4 v4, s[8:11], s27 offen offset:3072  lds
    s_add_u32 s27, s27, 128
    s_cmp_eq_u32 s27, s29
    s_cselect_b32 s27, s28, s27
    s_add_u32 m0, s33, 49152
    s_nop 0
    buffer_load_dwordx4 v5, s[12:15], s30 offen offset:0  lds
    buffer_load_dwordx4 v6, s[12:15], s30 offen offset:1024  lds
    buffer_load_dwordx4 v7, s[12:15], s30 offen offset:2048  lds
    buffer_load_dwordx4 v8, s[12:15], s30 offen offset:3072  lds
    s_add_u32 s30, s30, 245760
    s_cmp_eq_u32 s30, s32
    s_cselect_b32 s30, s31, s30
    s_waitcnt vmcnt(12)
    s_barrier
    ds_read_b128 v[128:131], v10 offset:0
    ds_read_b128 v[132:135], v10 offset:4096
    ds_read_b128 v[136:139], v11 offset:0
    ds_read_b128 v[140:143], v11 offset:4096
    ds_read_b128 v[144:147], v12 offset:0
    ds_read_b128 v[148:151], v12 offset:4096
    ds_read_b128 v[152:155], v13 offset:0
    ds_read_b128 v[156:159], v13 offset:4096
    s_waitcnt vmcnt(8) lgkmcnt(0)
    s_barrier
    ds_read_b64_tr_b16 v[160:161], v18 offset:16384
    ds_read_b64_tr_b16 v[162:163], v18 offset:17408
    ds_read_b64_tr_b16 v[164:165], v19 offset:16384
    ds_read_b64_tr_b16 v[166:167], v19 offset:17408
    ds_read_b64_tr_b16 v[168:169], v18 offset:20480
    ds_read_b64_tr_b16 v[170:171], v18 offset:21504
    ds_read_b64_tr_b16 v[172:173], v19 offset:20480
    ds_read_b64_tr_b16 v[174:175], v19 offset:21504
    ds_read_b64_tr_b16 v[176:177], v18 offset:24576
    ds_read_b64_tr_b16 v[178:179], v18 offset:25600
    ds_read_b64_tr_b16 v[180:181], v19 offset:24576
    ds_read_b64_tr_b16 v[182:183], v19 offset:25600
    ds_read_b64_tr_b16 v[184:185], v18 offset:28672
    ds_read_b64_tr_b16 v[186:187], v18 offset:29696
    ds_read_b64_tr_b16 v[188:189], v19 offset:28672
    ds_read_b64_tr_b16 v[190:191], v19 offset:29696
    s_add_u32 m0, s33, 65536
    s_nop 0
    buffer_load_dwordx4 v1, s[8:11], s27 offen offset:0  lds
    buffer_load_dwordx4 v2, s[8:11], s27 offen offset:1024  lds
    buffer_load_dwordx4 v3, s[8:11], s27 offen offset:2048  lds
    buffer_load_dwordx4 v4, s[8:11], s27 offen offset:3072  lds
    s_add_u32 s27, s27, 128
    s_cmp_eq_u32 s27, s29
    s_cselect_b32 s27, s28, s27
    s_add_u32 m0, s33, 0
    s_nop 0
    buffer_load_dwordx4 v5, s[12:15], s30 offen offset:0  lds
    buffer_load_dwordx4 v6, s[12:15], s30 offen offset:1024  lds
    buffer_load_dwordx4 v7, s[12:15], s30 offen offset:2048  lds
    buffer_load_dwordx4 v8, s[12:15], s30 offen offset:3072  lds
    s_add_u32 s30, s30, 245760
    s_cmp_eq_u32 s30, s32
    s_cselect_b32 s30, s31, s30
    s_waitcnt vmcnt(12) lgkmcnt(0)
    s_barrier
    v_mfma_f32_32x32x16_bf16 v[64:79], v[128:131], v[160:163], 0
    ds_read_b128 v[192:195], v10 offset:32768
    ds_read_b128 v[196:199], v10 offset:36864
    v_mfma_f32_32x32x16_bf16 v[80:95], v[128:131], v[164:167], 0
    ds_read_b128 v[200:203], v11 offset:32768
    ds_read_b128 v[204:207], v11 offset:36864
    v_mfma_f32_32x32x16_bf16 v[96:111], v[132:135], v[160:163], 0
    ds_read_b128 v[208:211], v12 offset:32768
    ds_read_b128 v[212:215], v12 offset:36864
    v_mfma_f32_32x32x16_bf16 v[112:127], v[132:135], v[164:167], 0
    ds_read_b128 v[216:219], v13 offset:32768
    ds_read_b128 v[220:223], v13 offset:36864
    v_mfma_f32_32x32x16_bf16 v[64:79], v[136:139], v[168:171], v[64:79]
    v_mfma_f32_32x32x16_bf16 v[80:95], v[136:139], v[172:175], v[80:95]
    v_mfma_f32_32x32x16_bf16 v[96:111], v[140:143], v[168:171], v[96:111]
    v_mfma_f32_32x32x16_bf16 v[112:127], v[140:143], v[172:175], v[112:127]
    s_add_u32 m0, s33, 16384
    s_nop 0
    buffer_load_dwordx4 v1, s[8:11], s27 offen offset:0  lds
    buffer_load_dwordx4 v2, s[8:11], s27 offen offset:1024  lds
    buffer_load_dwordx4 v3, s[8:11], s27 offen offset:2048  lds
    buffer_load_dwordx4 v4, s[8:11], s27 offen offset:3072  lds
    s_add_u32 s27, s27, 128
    s_cmp_eq_u32 s27, s29
    s_cselect_b32 s27, s28, s27
    s_waitcnt vmcnt(12) lgkmcnt(0)
    s_barrier
    v_mfma_f32_32x32x16_bf16 v[64:79], v[144:147], v[176:179], v[64:79]
    ds_read_b64_tr_b16 v[224:225], v18 offset:49152
    ds_read_b64_tr_b16 v[226:227], v18 offset:50176
    ds_read_b64_tr_b16 v[228:229], v19 offset:49152
    v_mfma_f32_32x32x16_bf16 v[80:95], v[144:147], v[180:183], v[80:95]
    ds_read_b64_tr_b16 v[230:231], v19 offset:50176
    ds_read_b64_tr_b16 v[232:233], v18 offset:53248
    ds_read_b64_tr_b16 v[234:235], v18 offset:54272
    v_mfma_f32_32x32x16_bf16 v[96:111], v[148:151], v[176:179], v[96:111]
    ds_read_b64_tr_b16 v[236:237], v19 offset:53248
    ds_read_b64_tr_b16 v[238:239], v19 offset:54272
    ds_read_b64_tr_b16 v[240:241], v18 offset:57344
    v_mfma_f32_32x32x16_bf16 v[112:127], v[148:151], v[180:183], v[112:127]
    ds_read_b64_tr_b16 v[242:243], v18 offset:58368
    ds_read_b64_tr_b16 v[244:245], v19 offset:57344
    ds_read_b64_tr_b16 v[246:247], v19 offset:58368
    v_mfma_f32_32x32x16_bf16 v[64:79], v[152:155], v[184:187], v[64:79]
    ds_read_b64_tr_b16 v[248:249], v18 offset:61440
    ds_read_b64_tr_b16 v[250:251], v18 offset:62464
    ds_read_b64_tr_b16 v[252:253], v19 offset:61440
    v_mfma_f32_32x32x16_bf16 v[80:95], v[152:155], v[188:191], v[80:95]
    ds_read_b64_tr_b16 v[254:255], v19 offset:62464
    v_mfma_f32_32x32x16_bf16 v[96:111], v[156:159], v[184:187], v[96:111]
    v_mfma_f32_32x32x16_bf16 v[112:127], v[156:159], v[188:191], v[112:127]
    s_add_u32 m0, s33, 32768
    s_nop 0
    buffer_load_dwordx4 v5, s[12:15], s30 offen offset:0  lds
    buffer_load_dwordx4 v6, s[12:15], s30 offen offset:1024  lds
    buffer_load_dwordx4 v7, s[12:15], s30 offen offset:2048  lds
    buffer_load_dwordx4 v8, s[12:15], s30 offen offset:3072  lds
    s_add_u32 s30, s30, 245760
    s_cmp_eq_u32 s30, s32
    s_cselect_b32 s30, s31, s30
    s_waitcnt vmcnt(12) lgkmcnt(0)
    s_barrier
    v_mfma_f32_32x32x16_bf16 v[64:79], v[192:195], v[224:227], v[64:79]
    ds_read_b128 v[128:131], v14 offset:0
    ds_read_b128 v[132:135], v14 offset:4096
    v_mfma_f32_32x32x16_bf16 v[80:95], v[192:195], v[228:231], v[80:95]
    ds_read_b128 v[136:139], v15 offset:0
    ds_read_b128 v[140:143], v15 offset:4096
    v_mfma_f32_32x32x16_bf16 v[96:111], v[196:199], v[224:227], v[96:111]
    ds_read_b128 v[144:147], v16 offset:0
    ds_read_b128 v[148:151], v16 offset:4096
    v_mfma_f32_32x32x16_bf16 v[112:127], v[196:199], v[228:231], v[112:127]
    ds_read_b128 v[152:155], v17 offset:0
    ds_read_b128 v[156:159], v17 offset:4096
    v_mfma_f32_32x32x16_bf16 v[64:79], v[200:203], v[232:235], v[64:79]
    v_mfma_f32_32x32x16_bf16 v[80:95], v[200:203], v[236:239], v[80:95]
    v_mfma_f32_32x32x16_bf16 v[96:111], v[204:207], v[232:235], v[96:111]
    v_mfma_f32_32x32x16_bf16 v[112:127], v[204:207], v[236:239], v[112:127]
    s_add_u32 m0, s33, 49152
    s_nop 0
    buffer_load_dwordx4 v1, s[8:11], s27 offen offset:0  lds
    buffer_load_dwordx4 v2, s[8:11], s27 offen offset:1024  lds
    buffer_load_dwordx4 v3, s[8:11], s27 offen offset:2048  lds
    buffer_load_dwordx4 v4, s[8:11], s27 offen offset:3072  lds
    s_add_u32 s27, s27, 128
    s_cmp_eq_u32 s27, s29
    s_cselect_b32 s27, s28, s27
    s_waitcnt vmcnt(12) lgkmcnt(0)
    s_barrier
    v_mfma_f32_32x32x16_bf16 v[64:79], v[208:211], v[240:243], v[64:79]
    ds_read_b64_tr_b16 v[160:161], v18 offset:0
    ds_read_b64_tr_b16 v[162:163], v18 offset:1024
    ds_read_b64_tr_b16 v[164:165], v19 offset:0
    v_mfma_f32_32x32x16_bf16 v[80:95], v[208:211], v[244:247], v[80:95]
    ds_read_b64_tr_b16 v[166:167], v19 offset:1024
    ds_read_b64_tr_b16 v[168:169], v18 offset:4096
    ds_read_b64_tr_b16 v[170:171], v18 offset:5120
    v_mfma_f32_32x32x16_bf16 v[96:111], v[212:215], v[240:243], v[96:111]
    ds_read_b64_tr_b16 v[172:173], v19 offset:4096
    ds_read_b64_tr_b16 v[174:175], v19 offset:5120
    ds_read_b64_tr_b16 v[176:177], v18 offset:8192
    v_mfma_f32_32x32x16_bf16 v[112:127], v[212:215], v[244:247], v[112:127]
    ds_read_b64_tr_b16 v[178:179], v18 offset:9216
    ds_read_b64_tr_b16 v[180:181], v19 offset:8192
    ds_read_b64_tr_b16 v[182:183], v19 offset:9216
    v_mfma_f32_32x32x16_bf16 v[64:79], v[216:219], v[248:251], v[64:79]
    ds_read_b64_tr_b16 v[184:185], v18 offset:12288
    ds_read_b64_tr_b16 v[186:187], v18 offset:13312
    ds_read_b64_tr_b16 v[188:189], v19 offset:12288
    v_mfma_f32_32x32x16_bf16 v[80:95], v[216:219], v[252:255], v[80:95]
    ds_read_b64_tr_b16 v[190:191], v19 offset:13312
    v_mfma_f32_32x32x16_bf16 v[96:111], v[220:223], v[248:251], v[96:111]
    v_mfma_f32_32x32x16_bf16 v[112:127], v[220:223], v[252:255], v[112:127]
    s_add_u32 m0, s33, 65536
    s_nop 0
    buffer_load_dwordx4 v5, s[12:15], s30 offen offset:0  lds
    buffer_load_dwordx4 v6, s[12:15], s30 offen offset:1024  lds
    buffer_load_dwordx4 v7, s[12:15], s30 offen offset:2048  lds
    buffer_load_dwordx4 v8, s[12:15], s30 offen offset:3072  lds
    s_add_u32 s30, s30, 245760
    s_cmp_eq_u32 s30, s32
    s_cselect_b32 s30, s31, s30
    s_waitcnt vmcnt(12) lgkmcnt(0)
    s_barrier
    v_mfma_f32_32x32x16_bf16 v[64:79], v[128:131], v[160:163], v[64:79]
    s_add_u32 m0, s33, 0
    s_nop 0
    ds_read_b128 v[192:195], v10 offset:16384
    ds_read_b128 v[196:199], v10 offset:20480
    buffer_load_dwordx4 v1, s[8:11], s27 offen offset:0  lds
    v_mfma_f32_32x32x16_bf16 v[80:95], v[128:131], v[164:167], v[80:95]
    ds_read_b128 v[200:203], v11 offset:16384
    ds_read_b128 v[204:207], v11 offset:20480
    buffer_load_dwordx4 v2, s[8:11], s27 offen offset:1024  lds
    v_mfma_f32_32x32x16_bf16 v[96:111], v[132:135], v[160:163], v[96:111]
    ds_read_b128 v[208:211], v12 offset:16384
    ds_read_b128 v[212:215], v12 offset:20480
    buffer_load_dwordx4 v3, s[8:11], s27 offen offset:2048  lds
    v_mfma_f32_32x32x16_bf16 v[112:127], v[132:135], v[164:167], v[112:127]
    ds_read_b128 v[216:219], v13 offset:16384
    ds_read_b128 v[220:223], v13 offset:20480
    buffer_load_dwordx4 v4, s[8:11], s27 offen offset:3072  lds
    s_add_u32 s27, s27, 128
    s_cmp_eq_u32 s27, s29
    s_cselect_b32 s27, s28, s27
    v_mfma_f32_32x32x16_bf16 v[64:79], v[136:139], v[168:171], v[64:79]
    v_mfma_f32_32x32x16_bf16 v[80:95], v[136:139], v[172:175], v[80:95]
    v_mfma_f32_32x32x16_bf16 v[96:111], v[140:143], v[168:171], v[96:111]
    v_mfma_f32_32x32x16_bf16 v[112:127], v[140:143], v[172:175], v[112:127]
    s_waitcnt vmcnt(12) lgkmcnt(0)
    s_barrier
    v_mfma_f32_32x32x16_bf16 v[64:79], v[144:147], v[176:179], v[64:79]
    s_add_u32 m0, s33, 16384
    s_nop 0
    ds_read_b64_tr_b16 v[224:225], v18 offset:32768
    ds_read_b64_tr_b16 v[226:227], v18 offset:33792
    ds_read_b64_tr_b16 v[228:229], v19 offset:32768
    buffer_load_dwordx4 v5, s[12:15], s30 offen offset:0  lds
    v_mfma_f32_32x32x16_bf16 v[80:95], v[144:147], v[180:183], v[80:95]
    ds_read_b64_tr_b16 v[230:231], v19 offset:33792
    ds_read_b64_tr_b16 v[232:233], v18 offset:36864
    ds_read_b64_tr_b16 v[234:235], v18 offset:37888
    buffer_load_dwordx4 v6, s[12:15], s30 offen offset:1024  lds
    v_mfma_f32_32x32x16_bf16 v[96:111], v[148:151], v[176:179], v[96:111]
    ds_read_b64_tr_b16 v[236:237], v19 offset:36864
    ds_read_b64_tr_b16 v[238:239], v19 offset:37888
    ds_read_b64_tr_b16 v[240:241], v18 offset:40960
    buffer_load_dwordx4 v7, s[12:15], s30 offen offset:2048  lds
    v_mfma_f32_32x32x16_bf16 v[112:127], v[148:151], v[180:183], v[112:127]
    ds_read_b64_tr_b16 v[242:243], v18 offset:41984
    ds_read_b64_tr_b16 v[244:245], v19 offset:40960
    ds_read_b64_tr_b16 v[246:247], v19 offset:41984
    buffer_load_dwordx4 v8, s[12:15], s30 offen offset:3072  lds
    s_add_u32 s30, s30, 245760
    s_cmp_eq_u32 s30, s32
    s_cselect_b32 s30, s31, s30
    v_mfma_f32_32x32x16_bf16 v[64:79], v[152:155], v[184:187], v[64:79]
    ds_read_b64_tr_b16 v[248:249], v18 offset:45056
    ds_read_b64_tr_b16 v[250:251], v18 offset:46080
    ds_read_b64_tr_b16 v[252:253], v19 offset:45056
    v_mfma_f32_32x32x16_bf16 v[80:95], v[152:155], v[188:191], v[80:95]
    ds_read_b64_tr_b16 v[254:255], v19 offset:46080
    v_mfma_f32_32x32x16_bf16 v[96:111], v[156:159], v[184:187], v[96:111]
    v_mfma_f32_32x32x16_bf16 v[112:127], v[156:159], v[188:191], v[112:127]
    s_waitcnt vmcnt(12) lgkmcnt(0)
    s_barrier
    v_mfma_f32_32x32x16_bf16 v[64:79], v[192:195], v[224:227], v[64:79]
    s_add_u32 m0, s33, 32768
    s_nop 0
    ds_read_b128 v[128:131], v10 offset:49152
    ds_read_b128 v[132:135], v10 offset:53248
    buffer_load_dwordx4 v1, s[8:11], s27 offen offset:0  lds
    v_mfma_f32_32x32x16_bf16 v[80:95], v[192:195], v[228:231], v[80:95]
    ds_read_b128 v[136:139], v11 offset:49152
    ds_read_b128 v[140:143], v11 offset:53248
    buffer_load_dwordx4 v2, s[8:11], s27 offen offset:1024  lds
    v_mfma_f32_32x32x16_bf16 v[96:111], v[196:199], v[224:227], v[96:111]
    ds_read_b128 v[144:147], v12 offset:49152
    ds_read_b128 v[148:151], v12 offset:53248
    buffer_load_dwordx4 v3, s[8:11], s27 offen offset:2048  lds
    v_mfma_f32_32x32x16_bf16 v[112:127], v[196:199], v[228:231], v[112:127]
    ds_read_b128 v[152:155], v13 offset:49152
    ds_read_b128 v[156:159], v13 offset:53248
    buffer_load_dwordx4 v4, s[8:11], s27 offen offset:3072  lds
    s_add_u32 s27, s27, 128
    s_cmp_eq_u32 s27, s29
    s_cselect_b32 s27, s28, s27
    v_mfma_f32_32x32x16_bf16 v[64:79], v[200:203], v[232:235], v[64:79]
    v_mfma_f32_32x32x16_bf16 v[80:95], v[200:203], v[236:239], v[80:95]
    v_mfma_f32_32x32x16_bf16 v[96:111], v[204:207], v[232:235], v[96:111]
    v_mfma_f32_32x32x16_bf16 v[112:127], v[204:207], v[236:239], v[112:127]
    s_waitcnt vmcnt(12) lgkmcnt(0)
    s_barrier
    v_mfma_f32_32x32x16_bf16 v[64:79], v[208:211], v[240:243], v[64:79]
    s_add_u32 m0, s33, 49152
    s_nop 0
    ds_read_b64_tr_b16 v[160:161], v20 offset:0
    ds_read_b64_tr_b16 v[162:163], v20 offset:1024
    ds_read_b64_tr_b16 v[164:165], v21 offset:0
    buffer_load_dwordx4 v5, s[12:15], s30 offen offset:0  lds
    v_mfma_f32_32x32x16_bf16 v[80:95], v[208:211], v[244:247], v[80:95]
    ds_read_b64_tr_b16 v[166:167], v21 offset:1024
    ds_read_b64_tr_b16 v[168:169], v20 offset:4096
    ds_read_b64_tr_b16 v[170:171], v20 offset:5120
    buffer_load_dwordx4 v6, s[12:15], s30 offen offset:1024  lds
    v_mfma_f32_32x32x16_bf16 v[96:111], v[212:215], v[240:243], v[96:111]
    ds_read_b64_tr_b16 v[172:173], v21 offset:4096
    ds_read_b64_tr_b16 v[174:175], v21 offset:5120
    ds_read_b64_tr_b16 v[176:177], v20 offset:8192
    buffer_load_dwordx4 v7, s[12:15], s30 offen offset:2048  lds
    v_mfma_f32_32x32x16_bf16 v[112:127], v[212:215], v[244:247], v[112:127]
    ds_read_b64_tr_b16 v[178:179], v20 offset:9216
    ds_read_b64_tr_b16 v[180:181], v21 offset:8192
    ds_read_b64_tr_b16 v[182:183], v21 offset:9216
    buffer_load_dwordx4 v8, s[12:15], s30 offen offset:3072  lds
    s_add_u32 s30, s30, 245760
    s_cmp_eq_u32 s30, s32
    s_cselect_b32 s30, s31, s30
    v_mfma_f32_32x32x16_bf16 v[64:79], v[216:219], v[248:251], v[64:79]
    ds_read_b64_tr_b16 v[184:185], v20 offset:12288
    ds_read_b64_tr_b16 v[186:187], v20 offset:13312
    ds_read_b64_tr_b16 v[188:189], v21 offset:12288
    v_mfma_f32_32x32x16_bf16 v[80:95], v[216:219], v[252:255], v[80:95]
    ds_read_b64_tr_b16 v[190:191], v21 offset:13312
    v_mfma_f32_32x32x16_bf16 v[96:111], v[220:223], v[248:251], v[96:111]
    v_mfma_f32_32x32x16_bf16 v[112:127], v[220:223], v[252:255], v[112:127]
    s_mov_b32 s20, s44
    s_mov_b32 s21, s45
    s_mov_b32 s22, 256
    s_mov_b32 s23, 0x00020000
    v_mov_b32 v34, 0
    buffer_load_dword v35, v34, s[20:23], 0 offen sc1
    s_waitcnt vmcnt(12) lgkmcnt(0)
    s_barrier
    v_mfma_f32_32x32x16_bf16 v[64:79], v[128:131], v[160:163], v[64:79]
    s_add_u32 m0, s33, 65536
    s_nop 0
    ds_read_b128 v[192:195], v10 offset:0
    ds_read_b128 v[196:199], v10 offset:4096
    buffer_load_dwordx4 v1, s[8:11], s27 offen offset:0  lds
    v_mfma_f32_32x32x16_bf16 v[80:95], v[128:131], v[164:167], v[80:95]
    ds_read_b128 v[200:203], v11 offset:0
    ds_read_b128 v[204:207], v11 offset:4096
    buffer_load_dwordx4 v2, s[8:11], s27 offen offset:1024  lds
    v_mfma_f32_32x32x16_bf16 v[96:111], v[132:135], v[160:163], v[96:111]
    ds_read_b128 v[208:211], v12 offset:0
    ds_read_b128 v[212:215], v12 offset:4096
    buffer_load_dwordx4 v3, s[8:11], s27 offen offset:2048  lds
    v_mfma_f32_32x32x16_bf16 v[112:127], v[132:135], v[164:167], v[112:127]
    ds_read_b128 v[216:219], v13 offset:0
    ds_read_b128 v[220:223], v13 offset:4096
    buffer_load_dwordx4 v4, s[8:11], s27 offen offset:3072  lds
    s_add_u32 s27, s27, 128
    s_cmp_eq_u32 s27, s29
    s_cselect_b32 s27, s28, s27
    v_mfma_f32_32x32x16_bf16 v[64:79], v[136:139], v[168:171], v[64:79]
    v_mfma_f32_32x32x16_bf16 v[80:95], v[136:139], v[172:175], v[80:95]
    v_mfma_f32_32x32x16_bf16 v[96:111], v[140:143], v[168:171], v[96:111]
    v_mfma_f32_32x32x16_bf16 v[112:127], v[140:143], v[172:175], v[112:127]
    s_waitcnt vmcnt(12) lgkmcnt(0)
    s_barrier
    v_mfma_f32_32x32x16_bf16 v[64:79], v[144:147], v[176:179], v[64:79]
    s_add_u32 m0, s33, 0
    s_nop 0
    ds_read_b64_tr_b16 v[224:225], v18 offset:16384
    ds_read_b64_tr_b16 v[226:227], v18 offset:17408
    ds_read_b64_tr_b16 v[228:229], v19 offset:16384
    buffer_load_dwordx4 v5, s[12:15], s30 offen offset:0  lds
    v_mfma_f32_32x32x16_bf16 v[80:95], v[144:147], v[180:183], v[80:95]
    ds_read_b64_tr_b16 v[230:231], v19 offset:17408
    ds_read_b64_tr_b16 v[232:233], v18 offset:20480
    ds_read_b64_tr_b16 v[234:235], v18 offset:21504
    buffer_load_dwordx4 v6, s[12:15], s30 offen offset:1024  lds
    v_mfma_f32_32x32x16_bf16 v[96:111], v[148:151], v[176:179], v[96:111]
    ds_read_b64_tr_b16 v[236:237], v19 offset:20480
    ds_read_b64_tr_b16 v[238:239], v19 offset:21504
    ds_read_b64_tr_b16 v[240:241], v18 offset:24576
    buffer_load_dwordx4 v7, s[12:15], s30 offen offset:2048  lds
    v_mfma_f32_32x32x16_bf16 v[112:127], v[148:151], v[180:183], v[112:127]
    ds_read_b64_tr_b16 v[242:243], v18 offset:25600
    ds_read_b64_tr_b16 v[244:245], v19 offset:24576
    ds_read_b64_tr_b16 v[246:247], v19 offset:25600
    buffer_load_dwordx4 v8, s[12:15], s30 offen offset:3072  lds
    s_add_u32 s30, s30, 245760
    s_cmp_eq_u32 s30, s32
    s_cselect_b32 s30, s31, s30
    v_mfma_f32_32x32x16_bf16 v[64:79], v[152:155], v[184:187], v[64:79]
    ds_read_b64_tr_b16 v[248:249], v18 offset:28672
    ds_read_b64_tr_b16 v[250:251], v18 offset:29696
    ds_read_b64_tr_b16 v[252:253], v19 offset:28672
    v_mfma_f32_32x32x16_bf16 v[80:95], v[152:155], v[188:191], v[80:95]
    ds_read_b64_tr_b16 v[254:255], v19 offset:29696
    v_mfma_f32_32x32x16_bf16 v[96:111], v[156:159], v[184:187], v[96:111]
    v_mfma_f32_32x32x16_bf16 v[112:127], v[156:159], v[188:191], v[112:127]
    s_waitcnt vmcnt(12) lgkmcnt(0)
    s_barrier
    v_mfma_f32_32x32x16_bf16 v[64:79], v[192:195], v[224:227], v[64:79]
    s_add_u32 m0, s33, 16384
    s_nop 0
    ds_read_b128 v[128:131], v10 offset:32768
    ds_read_b128 v[132:135], v10 offset:36864
    buffer_load_dwordx4 v1, s[8:11], s27 offen offset:0  lds
    v_mfma_f32_32x32x16_bf16 v[80:95], v[192:195], v[228:231], v[80:95]
    ds_read_b128 v[136:139], v11 offset:32768
    ds_read_b128 v[140:143], v11 offset:36864
    buffer_load_dwordx4 v2, s[8:11], s27 offen offset:1024  lds
    v_mfma_f32_32x32x16_bf16 v[96:111], v[196:199], v[224:227], v[96:111]
    ds_read_b128 v[144:147], v12 offset:32768
    ds_read_b128 v[148:151], v12 offset:36864
    buffer_load_dwordx4 v3, s[8:11], s27 offen offset:2048  lds
    v_mfma_f32_32x32x16_bf16 v[112:127], v[196:199], v[228:231], v[112:127]
    ds_read_b128 v[152:155], v13 offset:32768
    ds_read_b128 v[156:159], v13 offset:36864
    buffer_load_dwordx4 v4, s[8:11], s27 offen offset:3072  lds
    s_add_u32 s27, s27, 128
    s_cmp_eq_u32 s27, s29
    s_cselect_b32 s27, s28, s27
    v_mfma_f32_32x32x16_bf16 v[64:79], v[200:203], v[232:235], v[64:79]
    v_mfma_f32_32x32x16_bf16 v[80:95], v[200:203], v[236:239], v[80:95]
    v_mfma_f32_32x32x16_bf16 v[96:111], v[204:207], v[232:235], v[96:111]
    v_mfma_f32_32x32x16_bf16 v[112:127], v[204:207], v[236:239], v[112:127]
    s_waitcnt vmcnt(12) lgkmcnt(0)
    s_barrier
    v_mfma_f32_32x32x16_bf16 v[64:79], v[208:211], v[240:243], v[64:79]
    s_add_u32 m0, s33, 32768
    s_nop 0
    ds_read_b64_tr_b16 v[160:161], v18 offset:49152
    ds_read_b64_tr_b16 v[162:163], v18 offset:50176
    ds_read_b64_tr_b16 v[164:165], v19 offset:49152
    buffer_load_dwordx4 v5, s[12:15], s30 offen offset:0  lds
    v_mfma_f32_32x32x16_bf16 v[80:95], v[208:211], v[244:247], v[80:95]
    ds_read_b64_tr_b16 v[166:167], v19 offset:50176
    ds_read_b64_tr_b16 v[168:169], v18 offset:53248
    ds_read_b64_tr_b16 v[170:171], v18 offset:54272
    buffer_load_dwordx4 v6, s[12:15], s30 offen offset:1024  lds
    v_mfma_f32_32x32x16_bf16 v[96:111], v[212:215], v[240:243], v[96:111]
    ds_read_b64_tr_b16 v[172:173], v19 offset:53248
    ds_read_b64_tr_b16 v[174:175], v19 offset:54272
    ds_read_b64_tr_b16 v[176:177], v18 offset:57344
    buffer_load_dwordx4 v7, s[12:15], s30 offen offset:2048  lds
    v_mfma_f32_32x32x16_bf16 v[112:127], v[212:215], v[244:247], v[112:127]
    ds_read_b64_tr_b16 v[178:179], v18 offset:58368
    ds_read_b64_tr_b16 v[180:181], v19 offset:57344
    ds_read_b64_tr_b16 v[182:183], v19 offset:58368
    buffer_load_dwordx4 v8, s[12:15], s30 offen offset:3072  lds
    s_add_u32 s30, s30, 245760
    s_cmp_eq_u32 s30, s32
    s_cselect_b32 s30, s31, s30
    v_mfma_f32_32x32x16_bf16 v[64:79], v[216:219], v[248:251], v[64:79]
    ds_read_b64_tr_b16 v[184:185], v18 offset:61440
    ds_read_b64_tr_b16 v[186:187], v18 offset:62464
    ds_read_b64_tr_b16 v[188:189], v19 offset:61440
    v_mfma_f32_32x32x16_bf16 v[80:95], v[216:219], v[252:255], v[80:95]
    ds_read_b64_tr_b16 v[190:191], v19 offset:62464
    v_mfma_f32_32x32x16_bf16 v[96:111], v[220:223], v[248:251], v[96:111]
    v_mfma_f32_32x32x16_bf16 v[112:127], v[220:223], v[252:255], v[112:127]
    s_waitcnt vmcnt(12) lgkmcnt(0)
    s_barrier
    v_mfma_f32_32x32x16_bf16 v[64:79], v[128:131], v[160:163], v[64:79]
    s_add_u32 m0, s33, 49152
    s_nop 0
    ds_read_b128 v[192:195], v14 offset:0
    ds_read_b128 v[196:199], v14 offset:4096
    buffer_load_dwordx4 v1, s[8:11], s27 offen offset:0  lds
    v_mfma_f32_32x32x16_bf16 v[80:95], v[128:131], v[164:167], v[80:95]
    ds_read_b128 v[200:203], v15 offset:0
    ds_read_b128 v[204:207], v15 offset:4096
    buffer_load_dwordx4 v2, s[8:11], s27 offen offset:1024  lds
    v_mfma_f32_32x32x16_bf16 v[96:111], v[132:135], v[160:163], v[96:111]
    ds_read_b128 v[208:211], v16 offset:0
    ds_read_b128 v[212:215], v16 offset:4096
    buffer_load_dwordx4 v3, s[8:11], s27 offen offset:2048  lds
    v_mfma_f32_32x32x16_bf16 v[112:127], v[132:135], v[164:167], v[112:127]
    ds_read_b128 v[216:219], v17 offset:0
    ds_read_b128 v[220:223], v17 offset:4096
    buffer_load_dwordx4 v4, s[8:11], s27 offen offset:3072  lds
    s_add_u32 s27, s27, 128
    s_cmp_eq_u32 s27, s29
    s_cselect_b32 s27, s28, s27
    v_mfma_f32_32x32x16_bf16 v[64:79], v[136:139], v[168:171], v[64:79]
    v_mfma_f32_32x32x16_bf16 v[80:95], v[136:139], v[172:175], v[80:95]
    v_mfma_f32_32x32x16_bf16 v[96:111], v[140:143], v[168:171], v[96:111]
    v_mfma_f32_32x32x16_bf16 v[112:127], v[140:143], v[172:175], v[112:127]
    s_waitcnt vmcnt(12) lgkmcnt(0)
    s_barrier
    v_mfma_f32_32x32x16_bf16 v[64:79], v[144:147], v[176:179], v[64:79]
    s_add_u32 m0, s33, 65536
    s_nop 0
    ds_read_b64_tr_b16 v[224:225], v18 offset:0
    ds_read_b64_tr_b16 v[226:227], v18 offset:1024
    ds_read_b64_tr_b16 v[228:229], v19 offset:0
    buffer_load_dwordx4 v5, s[12:15], s30 offen offset:0  lds
    v_mfma_f32_32x32x16_bf16 v[80:95], v[144:147], v[180:183], v[80:95]
    ds_read_b64_tr_b16 v[230:231], v19 offset:1024
    ds_read_b64_tr_b16 v[232:233], v18 offset:4096
    ds_read_b64_tr_b16 v[234:235], v18 offset:5120
    buffer_load_dwordx4 v6, s[12:15], s30 offen offset:1024  lds
    v_mfma_f32_32x32x16_bf16 v[96:111], v[148:151], v[176:179], v[96:111]
    ds_read_b64_tr_b16 v[236:237], v19 offset:4096
    ds_read_b64_tr_b16 v[238:239], v19 offset:5120
    ds_read_b64_tr_b16 v[240:241], v18 offset:8192
    buffer_load_dwordx4 v7, s[12:15], s30 offen offset:2048  lds
    v_mfma_f32_32x32x16_bf16 v[112:127], v[148:151], v[180:183], v[112:127]
    ds_read_b64_tr_b16 v[242:243], v18 offset:9216
    ds_read_b64_tr_b16 v[244:245], v19 offset:8192
    ds_read_b64_tr_b16 v[246:247], v19 offset:9216
    buffer_load_dwordx4 v8, s[12:15], s30 offen offset:3072  lds
    s_add_u32 s30, s30, 245760
    s_cmp_eq_u32 s30, s32
    s_cselect_b32 s30, s31, s30
    v_mfma_f32_32x32x16_bf16 v[64:79], v[152:155], v[184:187], v[64:79]
    ds_read_b64_tr_b16 v[248:249], v18 offset:12288
    ds_read_b64_tr_b16 v[250:251], v18 offset:13312
    ds_read_b64_tr_b16 v[252:253], v19 offset:12288
    v_mfma_f32_32x32x16_bf16 v[80:95], v[152:155], v[188:191], v[80:95]
    ds_read_b64_tr_b16 v[254:255], v19 offset:13312
    v_mfma_f32_32x32x16_bf16 v[96:111], v[156:159], v[184:187], v[96:111]
    v_mfma_f32_32x32x16_bf16 v[112:127], v[156:159], v[188:191], v[112:127]
    s_waitcnt vmcnt(12) lgkmcnt(0)
    s_barrier
    v_mfma_f32_32x32x16_bf16 v[64:79], v[192:195], v[224:227], v[64:79]
    ds_read_b128 v[128:131], v10 offset:16384
    ds_read_b128 v[132:135], v10 offset:20480
    v_mfma_f32_32x32x16_bf16 v[80:95], v[192:195], v[228:231], v[80:95]
    ds_read_b128 v[136:139], v11 offset:16384
    ds_read_b128 v[140:143], v11 offset:20480
    v_mfma_f32_32x32x16_bf16 v[96:111], v[196:199], v[224:227], v[96:111]
    ds_read_b128 v[144:147], v12 offset:16384
    ds_read_b128 v[148:151], v12 offset:20480
    v_mfma_f32_32x32x16_bf16 v[112:127], v[196:199], v[228:231], v[112:127]
    ds_read_b128 v[152:155], v13 offset:16384
    ds_read_b128 v[156:159], v13 offset:20480
    v_mfma_f32_32x32x16_bf16 v[64:79], v[200:203], v[232:235], v[64:79]
    v_mfma_f32_32x32x16_bf16 v[80:95], v[200:203], v[236:239], v[80:95]
    v_mfma_f32_32x32x16_bf16 v[96:111], v[204:207], v[232:235], v[96:111]
    v_mfma_f32_32x32x16_bf16 v[112:127], v[204:207], v[236:239], v[112:127]
    s_waitcnt vmcnt(8) lgkmcnt(0)
    s_barrier
    v_mfma_f32_32x32x16_bf16 v[64:79], v[208:211], v[240:243], v[64:79]
    ds_read_b64_tr_b16 v[160:161], v18 offset:32768
    ds_read_b64_tr_b16 v[162:163], v18 offset:33792
    ds_read_b64_tr_b16 v[164:165], v19 offset:32768
    v_mfma_f32_32x32x16_bf16 v[80:95], v[208:211], v[244:247], v[80:95]
    ds_read_b64_tr_b16 v[166:167], v19 offset:33792
    ds_read_b64_tr_b16 v[168:169], v18 offset:36864
    ds_read_b64_tr_b16 v[170:171], v18 offset:37888
    v_mfma_f32_32x32x16_bf16 v[96:111], v[212:215], v[240:243], v[96:111]
    ds_read_b64_tr_b16 v[172:173], v19 offset:36864
    ds_read_b64_tr_b16 v[174:175], v19 offset:37888
    ds_read_b64_tr_b16 v[176:177], v18 offset:40960
    v_mfma_f32_32x32x16_bf16 v[112:127], v[212:215], v[244:247], v[112:127]
    ds_read_b64_tr_b16 v[178:179], v18 offset:41984
    ds_read_b64_tr_b16 v[180:181], v19 offset:40960
    ds_read_b64_tr_b16 v[182:183], v19 offset:41984
    v_mfma_f32_32x32x16_bf16 v[64:79], v[216:219], v[248:251], v[64:79]
    ds_read_b64_tr_b16 v[184:185], v18 offset:45056
    ds_read_b64_tr_b16 v[186:187], v18 offset:46080
    ds_read_b64_tr_b16 v[188:189], v19 offset:45056
    v_mfma_f32_32x32x16_bf16 v[80:95], v[216:219], v[252:255], v[80:95]
    ds_read_b64_tr_b16 v[190:191], v19 offset:46080
    v_mfma_f32_32x32x16_bf16 v[96:111], v[220:223], v[248:251], v[96:111]
    v_mfma_f32_32x32x16_bf16 v[112:127], v[220:223], v[252:255], v[112:127]
    s_waitcnt vmcnt(4) lgkmcnt(0)
    s_barrier
    v_mfma_f32_32x32x16_bf16 v[64:79], v[128:131], v[160:163], v[64:79]
    ds_read_b128 v[192:195], v10 offset:49152
    ds_read_b128 v[196:199], v10 offset:53248
    v_mfma_f32_32x32x16_bf16 v[80:95], v[128:131], v[164:167], v[80:95]
    ds_read_b128 v[200:203], v11 offset:49152
    ds_read_b128 v[204:207], v11 offset:53248
    v_mfma_f32_32x32x16_bf16 v[96:111], v[132:135], v[160:163], v[96:111]
    ds_read_b128 v[208:211], v12 offset:49152
    ds_read_b128 v[212:215], v12 offset:53248
    v_mfma_f32_32x32x16_bf16 v[112:127], v[132:135], v[164:167], v[112:127]
    ds_read_b128 v[216:219], v13 offset:49152
    ds_read_b128 v[220:223], v13 offset:53248
    v_mfma_f32_32x32x16_bf16 v[64:79], v[136:139], v[168:171], v[64:79]
    v_mfma_f32_32x32x16_bf16 v[80:95], v[136:139], v[172:175], v[80:95]
    v_mfma_f32_32x32x16_bf16 v[96:111], v[140:143], v[168:171], v[96:111]
    v_mfma_f32_32x32x16_bf16 v[112:127], v[140:143], v[172:175], v[112:127]
    s_waitcnt vmcnt(0) lgkmcnt(0)
    s_barrier
    v_mfma_f32_32x32x16_bf16 v[64:79], v[144:147], v[176:179], v[64:79]
    ds_read_b64_tr_b16 v[224:225], v20 offset:0
    ds_read_b64_tr_b16 v[226:227], v20 offset:1024
    ds_read_b64_tr_b16 v[228:229], v21 offset:0
    v_mfma_f32_32x32x16_bf16 v[80:95], v[144:147], v[180:183], v[80:95]
    ds_read_b64_tr_b16 v[230:231], v21 offset:1024
    ds_read_b64_tr_b16 v[232:233], v20 offset:4096
    ds_read_b64_tr_b16 v[234:235], v20 offset:5120
    v_mfma_f32_32x32x16_bf16 v[96:111], v[148:151], v[176:179], v[96:111]
    ds_read_b64_tr_b16 v[236:237], v21 offset:4096
    ds_read_b64_tr_b16 v[238:239], v21 offset:5120
    ds_read_b64_tr_b16 v[240:241], v20 offset:8192
    v_mfma_f32_32x32x16_bf16 v[112:127], v[148:151], v[180:183], v[112:127]
    ds_read_b64_tr_b16 v[242:243], v20 offset:9216
    ds_read_b64_tr_b16 v[244:245], v21 offset:8192
    ds_read_b64_tr_b16 v[246:247], v21 offset:9216
    v_mfma_f32_32x32x16_bf16 v[64:79], v[152:155], v[184:187], v[64:79]
    ds_read_b64_tr_b16 v[248:249], v20 offset:12288
    ds_read_b64_tr_b16 v[250:251], v20 offset:13312
    ds_read_b64_tr_b16 v[252:253], v21 offset:12288
    v_mfma_f32_32x32x16_bf16 v[80:95], v[152:155], v[188:191], v[80:95]
    ds_read_b64_tr_b16 v[254:255], v21 offset:13312
    v_mfma_f32_32x32x16_bf16 v[96:111], v[156:159], v[184:187], v[96:111]
    v_mfma_f32_32x32x16_bf16 v[112:127], v[156:159], v[188:191], v[112:127]
    s_waitcnt lgkmcnt(0)
    s_mov_b32 s16, s46
    s_mov_b32 s17, s47
    s_mov_b32 s18, 18022400
    s_mov_b32 s19, 0x00020000
    v_lshrrev_b32 v24, 5, v22
    v_mul_u32_u24 v24, 10368, v24
    v_and_b32 v25, 31, v22
    v_lshl_add_u32 v24, v25, 4, v24
    v_add_u32 v25, 20736, v24
    s_lshr_b32 s34, s64, 1
    s_lshl_b32 s34, s34, 1
    s_lshl_b32 s35, s25, 2
    s_add_u32 s34, s34, s35
    s_mul_i32 s34, s34, 41472
    s_sub_u32 s35, s26, 10
    s_lshl_b32 s35, s35, 11
    s_add_u32 s34, s34, s35
    s_and_b32 s35, s64, 1
    s_lshl_b32 s35, s35, 10
    s_add_u32 s34, s34, s35
    s_add_u32 s34, s34, 5242880
    s_add_u32 s35, s34, 41472
    v_mfma_f32_32x32x16_bf16 v[64:79], v[192:195], v[224:227], v[64:79]
    v_mfma_f32_32x32x16_bf16 v[64:79], v[200:203], v[232:235], v[64:79]
    v_mfma_f32_32x32x16_bf16 v[64:79], v[208:211], v[240:243], v[64:79]
    v_mfma_f32_32x32x16_bf16 v[64:79], v[216:219], v[248:251], v[64:79]
    v_mfma_f32_32x32x16_bf16 v[80:95], v[192:195], v[228:231], v[80:95]
    v_mfma_f32_32x32x16_bf16 v[80:95], v[200:203], v[236:239], v[80:95]
    v_mfma_f32_32x32x16_bf16 v[80:95], v[208:211], v[244:247], v[80:95]
    s_nop 8
    v_cvt_pk_bf16_f32 v128, v64, v65
    v_cvt_pk_bf16_f32 v129, v66, v67
    v_cvt_pk_bf16_f32 v130, v68, v69
    v_mfma_f32_32x32x16_bf16 v[80:95], v[216:219], v[252:255], v[80:95]
    v_cvt_pk_bf16_f32 v131, v70, v71
    buffer_store_dwordx4 v[128:131], v24, s[16:19], s34 offen offset:0 sc1
    v_cvt_pk_bf16_f32 v132, v72, v73
    v_mfma_f32_32x32x16_bf16 v[96:111], v[196:199], v[224:227], v[96:111]
    v_cvt_pk_bf16_f32 v133, v74, v75
    v_cvt_pk_bf16_f32 v134, v76, v77
    v_cvt_pk_bf16_f32 v135, v78, v79
    v_mfma_f32_32x32x16_bf16 v[96:111], v[204:207], v[232:235], v[96:111]
    buffer_store_dwordx4 v[132:135], v25, s[16:19], s34 offen offset:0 sc1
    v_mfma_f32_32x32x16_bf16 v[96:111], v[212:215], v[240:243], v[96:111]
    s_nop 1
    v_cvt_pk_bf16_f32 v136, v80, v81
    v_cvt_pk_bf16_f32 v137, v82, v83
    v_cvt_pk_bf16_f32 v138, v84, v85
    v_mfma_f32_32x32x16_bf16 v[96:111], v[220:223], v[248:251], v[96:111]
    v_cvt_pk_bf16_f32 v139, v86, v87
    buffer_store_dwordx4 v[136:139], v24, s[16:19], s34 offen offset:512 sc1
    v_cvt_pk_bf16_f32 v140, v88, v89
    v_mfma_f32_32x32x16_bf16 v[112:127], v[196:199], v[228:231], v[112:127]
    v_cvt_pk_bf16_f32 v141, v90, v91
    v_cvt_pk_bf16_f32 v142, v92, v93
    v_cvt_pk_bf16_f32 v143, v94, v95
    v_mfma_f32_32x32x16_bf16 v[112:127], v[204:207], v[236:239], v[112:127]
    buffer_store_dwordx4 v[140:143], v25, s[16:19], s34 offen offset:512 sc1
    v_mfma_f32_32x32x16_bf16 v[112:127], v[212:215], v[244:247], v[112:127]
    s_nop 1
    v_cvt_pk_bf16_f32 v144, v96, v97
    v_cvt_pk_bf16_f32 v145, v98, v99
    v_cvt_pk_bf16_f32 v146, v100, v101
    v_cvt_pk_bf16_f32 v147, v102, v103
    buffer_store_dwordx4 v[144:147], v24, s[16:19], s35 offen offset:0 sc1
    v_mfma_f32_32x32x16_bf16 v[112:127], v[220:223], v[252:255], v[112:127]
    v_cvt_pk_bf16_f32 v148, v104, v105
    v_cvt_pk_bf16_f32 v149, v106, v107
    v_cvt_pk_bf16_f32 v150, v108, v109
    v_cvt_pk_bf16_f32 v151, v110, v111
    buffer_store_dwordx4 v[148:151], v25, s[16:19], s35 offen offset:0 sc1
    s_nop 6
    v_cvt_pk_bf16_f32 v152, v112, v113
    v_cvt_pk_bf16_f32 v153, v114, v115
    v_cvt_pk_bf16_f32 v154, v116, v117
    v_cvt_pk_bf16_f32 v155, v118, v119
    buffer_store_dwordx4 v[152:155], v24, s[16:19], s35 offen offset:512 sc1
    v_cvt_pk_bf16_f32 v156, v120, v121
    v_cvt_pk_bf16_f32 v157, v122, v123
    v_cvt_pk_bf16_f32 v158, v124, v125
    v_cvt_pk_bf16_f32 v159, v126, v127
    buffer_store_dwordx4 v[156:159], v25, s[16:19], s35 offen offset:512 sc1
g3_done:
    s_cmp_lg_u32 s64, 0
    s_cbranch_scc1 g3_w
    v_readfirstlane_b32 s65, v35
    s_nop 3
    s_cmp_lg_u32 s65, 0
    s_cbranch_scc1 g3_nonce_ok
    v_mov_b32 v26, 0
    s_mov_b32 s67, 20000
g3_nonce:
    buffer_load_dword v27, v26, s[20:23], 0 offen sc1
    s_waitcnt vmcnt(0)
    v_readfirstlane_b32 s65, v27
    s_nop 3
    s_cmp_lg_u32 s65, 0
    s_cbranch_scc1 g3_nonce_ok
    s_sleep 2
    s_sub_u32 s67, s67, 1
    s_cmp_lg_u32 s67, 0
    s_cbranch_scc1 g3_nonce
g3_nonce_ok:
g3_w:
    s_lshl_b32 s34, s26, 11
    s_lshl_b32 s35, s25, 7
    s_add_u32 s34, s34, s35
    s_add_u32 s34, s34, 17596416
    s_waitcnt vmcnt(0)
    s_barrier
    s_cmp_lg_u32 s64, 0
    s_cbranch_scc1 g3_w2
    v_mbcnt_lo_u32_b32 v24, -1, 0
    v_lshl_add_u32 v24, v24, 2, s34
    v_mov_b32 v25, s65
    s_mov_b32 exec_hi, 0
    buffer_store_dword v25, v24, s[16:19], 0 offen sc1
    s_mov_b64 exec, -1
g3_w2:
    s_branch L_t_attn
L_t_nog3:
    s_sub_u32 s33, s2, 240
    s_or_b32 s4, s33, s64
    s_cmp_lg_u32 s4, 0
    s_cbranch_scc1 L_t_n2
    s_load_dwordx2 s[56:57], s[0:1], 104
    s_memrealtime s[60:61]
    s_waitcnt lgkmcnt(0)
    s_mov_b32 s58, 256
    s_mov_b32 s59, 0x00020000
    s_or_b32 s62, s60, 1
    v_mov_b32 v30, 0
    v_mov_b32 v31, s62
    buffer_store_dword v31, v30, s[56:59], 0 offen sc1
L_t_n2:
    s_load_dwordx4 s[44:47], s[0:1], 104
    v_mbcnt_lo_u32_b32 v31, -1, 0
    v_mbcnt_hi_u32_b32 v31, -1, v31
    s_lshl_b32 s34, s33, 2
    s_add_u32 s34, s34, s64
    s_mul_i32 s34, s34, 41472
    s_add_u32 s34, s34, 5253120
    v_and_b32 v30, 3, v31
    v_mul_u32_u24 v30, 10368, v30
    v_bfe_u32 v31, v31, 2, 3
    v_lshl_add_u32 v30, v31, 4, v30
    v_mov_b32 v32, 0x3f803f80
    v_mov_b32 v33, 0x3f803f80
    v_mov_b32 v34, 0x3f803f80
    v_mov_b32 v35, 0x3f803f80
    s_waitcnt lgkmcnt(0)
    s_mov_b32 s16, s46
    s_mov_b32 s17, s47
    s_mov_b32 s18, 18022400
    s_mov_b32 s19, 0x00020000
    s_mov_b32 s20, s44
    s_mov_b32 s21, s45
    s_mov_b32 s22, 256
    s_mov_b32 s23, 0x00020000
    buffer_store_dwordx4 v[32:35], v30, s[16:19], s34 offen sc1
    s_cmp_lg_u32 s64, 0
    s_cbranch_scc1 on_w
    v_mov_b32 v36, 0
    s_mov_b32 s67, 20000
on_nonce:
    buffer_load_dword v37, v36, s[20:23], 0 offen sc1
    s_waitcnt vmcnt(0)
    v_readfirstlane_b32 s65, v37
    s_nop 3
    s_cmp_lg_u32 s65, 0
    s_cbranch_scc1 on_nonce_ok
    s_sleep 2
    s_sub_u32 s67, s67, 1
    s_cmp_lg_u32 s67, 0
    s_cbranch_scc1 on_nonce
on_nonce_ok:
on_w:
    s_lshl_b32 s34, s33, 7
    s_add_u32 s34, s34, 17627136
    s_waitcnt vmcnt(0)
    s_barrier
    s_cmp_lg_u32 s64, 0
    s_cbranch_scc1 on_w2
    v_mbcnt_lo_u32_b32 v30, -1, 0
    v_lshl_add_u32 v30, v30, 2, s34
    v_mov_b32 v31, s65
    s_mov_b32 exec_hi, 0
    buffer_store_dword v31, v30, s[16:19], 0 offen sc1
    s_mov_b64 exec, -1
on_w2:
L_t_attn:
    s_load_dwordx2 s[44:45], s[0:1], 112
    v_mbcnt_lo_u32_b32 v224, -1, 0
    v_mbcnt_hi_u32_b32 v224, -1, v224
    s_and_b32 s33, s2, 7
    s_lshr_b32 s34, s2, 3
    s_and_b32 s26, s34, 15
    s_lshr_b32 s34, s34, 4
    s_lshl_b32 s25, s33, 1
    s_add_u32 s25, s25, s34
    s_lshr_b32 s27, s64, 1
    s_and_b32 s28, s64, 1
    s_mul_i32 s33, s25, 2560
    s_mul_i32 s34, s27, 1536
    s_add_u32 s34, s34, s33
    v_lshlrev_b32 v226, 4, v224
    v_add_u32 v227, s34, v226
    v_add_u32 v220, 40960, v227
    v_and_b32 v226, 31, v224
    v_lshlrev_b32 v228, 4, v226
    s_lshl_b32 s34, s27, 3
    s_add_u32 s33, s33, s34
    s_add_u32 s33, s33, 1024
    v_add_u32 v228, s33, v228
    v_add_u32 v221, 40960, v228
    v_lshrrev_b32 v229, 5, v224
    v_mul_u32_u24 v230, 81920, v229
    v_add_u32 v228, v228, v230
    s_lshl_b32 s33, s27, 2
    v_add_u32 v230, s33, v226
    v_subrev_u32 v231, 20, v230
    v_cmp_le_u32 vcc, 20, v230
    s_mul_i32 s33, s25, 40
    s_mul_i32 s34, s27, 20
    v_cndmask_b32 v230, v230, v231, vcc
    s_add_u32 s34, s33, s34
    v_add_u32 v230, s34, v230
    v_cmp_le_u32 vcc, 20, v226
    v_mov_b32 v231, 640
    v_mul_u32_u24 v229, 10368, v229
    v_cndmask_b32 v230, v230, v231, vcc
    v_lshl_add_u32 v222, v230, 4, v229
    v_add_u32 v222, 5242880, v222
    v_cmp_lt_u32 vcc, 20, v226
    v_mov_b32 v231, 0x7f000000
    s_lshl_b32 s36, s28, 5
    v_cndmask_b32 v222, v222, v231, vcc
    v_add_u32 v223, 20736, v222
    s_and_b32 s29, s26, 1
    s_mul_i32 s29, s29, 16
    s_waitcnt lgkmcnt(0)
    s_mov_b32 s8, s44
    s_mov_b32 s9, s45
    s_mov_b32 s10, 18022400
    s_mov_b32 s11, 0x00020000
    s_cmp_lg_u32 s64, 0
    s_cbranch_scc1 at_go
    v_lshrrev_b32 v232, 4, v224
    v_and_b32 v233, 1, v232
    v_mul_u32_u24 v233, 39, v233
    v_add_u32 v233, s33, v233
    v_lshrrev_b32 v232, 1, v232
    v_mul_u32_u24 v234, 640, v232
    v_add3_u32 v234, v234, v233, 0
    v_add_u32 v234, 640, v234
    v_and_b32 v232, 15, v224
    v_lshlrev_b32 v232, 7, v232
    v_add_u32 v232, 17596416, v232
    v_lshrrev_b32 v234, 7, v234
    v_lshl_add_u32 v234, v234, 11, v232
    v_lshrrev_b32 v233, 7, v233
    v_lshlrev_b32 v233, 11, v233
    s_lshl_b32 s34, s26, 7
    s_add_u32 s34, s34, 17596416
    v_add_u32 v233, s34, v233
    v_add_u32 v232, 30720, v232
    v_cmp_le_u32 vcc, 32, v224
    s_nop 1
    v_cndmask_b32 v233, v233, v232, vcc
    s_mov_b32 s67, 20000
at_poll:
    buffer_load_dword v235, v234, s[8:11], 0 offen sc1
    buffer_load_dword v236, v233, s[8:11], 0 offen sc1
    s_waitcnt vmcnt(0)
    v_cmp_ne_u32 vcc, s65, v235
    v_cmp_ne_u32 s[58:59], s65, v236
    s_or_b64 vcc, vcc, s[58:59]
    s_cbranch_vccz at_go
    s_sleep 1
    s_sub_u32 s67, s67, 1
    s_cmp_lg_u32 s67, 0
    s_cbranch_scc1 at_poll
at_go:
    s_barrier
    s_cmp_lg_u32 s64, 0
    s_cbranch_scc1 at_nm
    s_getreg_b32 s35, hwreg(HW_REG_HW_ID, 8, 8)
    s_and_b32 s35, s35, 127
    s_getreg_b32 s34, hwreg(HW_REG_XCC_ID, 0, 3)
    s_lshl_b32 s34, s34, 7
    s_add_u32 s35, s35, s34
    s_lshl_b32 s35, s35, 6
    s_add_u32 s35, s35, 17727488
    v_mov_b32 v232, s35
    v_mov_b32 v233, s65
    s_nop 0
    s_mov_b64 exec, 1
    buffer_store_dword v233, v232, s[8:11], 0 offen
    s_mov_b64 exec, -1
at_nm:
    s_lshl_b32 s38, s26, 2
    s_lshl_b32 s34, s28, 1
    s_add_u32 s39, s38, 2
    s_sub_u32 s39, s39, s34
    s_add_u32 s38, s38, s34
    s_add_u32 s33, s29, s36
    s_mul_i32 s30, s33, 81920
    s_mul_i32 s32, s33, 41472
    s_add_u32 s29, s29, 1
    s_and_b32 s29, s29, 31
    s_mul_i32 s34, s38, 81920
    s_mul_i32 s39, s39, 81920
    buffer_load_dwordx2 v[160:161], v228, s[8:11], s34 offen sc1
    buffer_load_dwordx2 v[180:181], v221, s[8:11], s30 offen sc1
    buffer_load_dwordx4 v[144:147], v227, s[8:11], s34 offen sc1
    s_add_u32 s34, s34, 81920
    buffer_load_dwordx4 v[148:151], v227, s[8:11], s34 offen sc1
    buffer_load_dwordx4 v[164:167], v220, s[8:11], s30 offen sc1
    buffer_load_dwordx2 v[162:163], v228, s[8:11], s39 offen sc1
    buffer_load_dwordx4 v[152:155], v227, s[8:11], s39 offen sc1
    s_add_u32 s39, s39, 81920
    buffer_load_dwordx4 v[156:159], v227, s[8:11], s39 offen sc1
    v_mov_b32 v126, 0
    v_mov_b32 v127, 0
    v_mov_b32 v136, 0
    v_mov_b32 v137, 0
    v_mov_b32 v138, 0
    v_mov_b32 v139, 0
    v_mov_b32 v140, 0
    v_mov_b32 v141, 0
    v_mov_b32 v142, 0
    v_mov_b32 v143, 0
    v_mov_b32 v212, 0
    v_mov_b32 v213, 0
    v_mov_b32 v214, 0
    v_mov_b32 v215, 0
    v_mov_b32 v216, 0
    v_mov_b32 v217, 0
    v_mov_b32 v218, 0
    v_mov_b32 v219, 0
    v_mov_b32 v48, 0
    v_mov_b32 v49, 0
    v_mov_b32 v50, 0
    v_mov_b32 v51, 0
    v_mov_b32 v52, 0
    v_mov_b32 v53, 0
    v_mov_b32 v54, 0
    v_mov_b32 v55, 0
    v_mov_b32 v56, 0
    v_mov_b32 v57, 0
    v_mov_b32 v58, 0
    v_mov_b32 v59, 0
    v_mov_b32 v60, 0
    v_mov_b32 v61, 0
    v_mov_b32 v62, 0
    v_mov_b32 v63, 0
    buffer_load_dwordx4 v[188:191], v222, s[8:11], s32 offen sc1
    buffer_load_dwordx4 v[192:195], v223, s[8:11], s32 offen sc1
    s_add_u32 s33, s29, s36
    s_mul_i32 s30, s33, 81920
    s_mul_i32 s32, s33, 41472
    s_add_u32 s29, s29, 1
    s_and_b32 s29, s29, 31
    buffer_load_dwordx2 v[182:183], v221, s[8:11], s30 offen sc1
    buffer_load_dwordx4 v[168:171], v220, s[8:11], s30 offen sc1
    v_mov_b32 v24, 0
    v_mov_b32 v25, 0
    v_mov_b32 v26, 0
    v_mov_b32 v27, 0
    v_mov_b32 v28, 0
    v_mov_b32 v29, 0
    v_mov_b32 v30, 0
    v_mov_b32 v31, 0
    v_mov_b32 v32, 0
    v_mov_b32 v33, 0
    v_mov_b32 v34, 0
    v_mov_b32 v35, 0
    v_mov_b32 v36, 0
    v_mov_b32 v37, 0
    v_mov_b32 v38, 0
    v_mov_b32 v39, 0
    v_mov_b32 v40, 0
    v_mov_b32 v41, 0
    v_mov_b32 v42, 0
    v_mov_b32 v43, 0
    v_mov_b32 v44, 0
    v_mov_b32 v45, 0
    v_mov_b32 v46, 0
    v_mov_b32 v47, 0
    buffer_load_dwordx4 v[196:199], v222, s[8:11], s32 offen sc1
    buffer_load_dwordx4 v[200:203], v223, s[8:11], s32 offen sc1
    s_add_u32 s33, s29, s36
    s_mul_i32 s30, s33, 81920
    s_mul_i32 s32, s33, 41472
    s_add_u32 s29, s29, 1
    s_and_b32 s29, s29, 31
    buffer_load_dwordx2 v[184:185], v221, s[8:11], s30 offen sc1
    buffer_load_dwordx4 v[172:175], v220, s[8:11], s30 offen sc1
    buffer_load_dwordx4 v[204:207], v222, s[8:11], s32 offen sc1
    buffer_load_dwordx4 v[208:211], v223, s[8:11], s32 offen sc1
    s_add_u32 s33, s29, s36
    s_mul_i32 s30, s33, 81920
    s_mul_i32 s32, s33, 41472
    s_add_u32 s29, s29, 1
    s_and_b32 s29, s29, 31
    buffer_load_dwordx2 v[186:187], v221, s[8:11], s30 offen sc1
    buffer_load_dwordx4 v[176:179], v220, s[8:11], s30 offen sc1
    s_mov_b32 s31, s32
    s_add_u32 s33, s29, s36
    s_mul_i32 s30, s33, 81920
    s_mul_i32 s32, s33, 41472
    s_add_u32 s29, s29, 1
    s_and_b32 s29, s29, 31
    s_waitcnt vmcnt(18)
    v_mfma_f32_32x32x4_2b_bf16 v[64:95], v[180:181], v[160:161], 0
    v_mov_b32 v0, 0
    v_mov_b32 v1, 0
    v_mov_b32 v2, 0
    v_mov_b32 v3, 0
    v_mov_b32 v4, 0
    v_mov_b32 v5, 0
    v_mov_b32 v6, 0
    v_mov_b32 v7, 0
    v_mov_b32 v8, 0
    v_mov_b32 v9, 0
    v_mov_b32 v10, 0
    v_mov_b32 v11, 0
    v_mov_b32 v12, 0
    v_mov_b32 v13, 0
    v_mov_b32 v14, 0
    v_mov_b32 v15, 0
    v_mov_b32 v16, 0
    v_mov_b32 v17, 0
    v_mov_b32 v18, 0
    v_mov_b32 v19, 0
    v_mov_b32 v20, 0
    v_mov_b32 v21, 0
    v_mov_b32 v22, 0
    v_mov_b32 v23, 0
    s_waitcnt vmcnt(15)
    v_mfma_f32_32x32x16_bf16 v[64:79], v[164:167], v[144:147], v[64:79]
    v_mfma_f32_32x32x16_bf16 v[80:95], v[164:167], v[148:151], v[80:95]
    s_waitcnt vmcnt(12)
    s_getreg_b32 s35, hwreg(HW_REG_HW_ID, 8, 8)
    s_and_b32 s35, s35, 127
    s_getreg_b32 s34, hwreg(HW_REG_XCC_ID, 0, 3)
    s_lshl_b32 s34, s34, 7
    s_add_u32 s35, s35, s34
    s_lshl_b32 s35, s35, 6
    s_add_u32 s35, s35, 17727488
    s_add_u32 s35, s35, 32
    s_cmp_eq_u32 s64, 0
    s_cselect_b32 s35, s35, 0x7f000000
    v_lshlrev_b32 v246, 24, v224
    v_add_u32 v246, s35, v246
    v_min_u32 v246, 0x7f000000, v246
    v_mov_b32 v247, s65
    s_mov_b32 s35, 4
    s_nop 10
.p2align 6
at_loop:
    v_exp_f32 v64, v64
    v_exp_f32 v65, v65
    v_cvt_pk_bf16_f32 v143, v126, v127
    v_mfma_f32_32x32x4_2b_bf16 v[96:127], v[180:181], v[162:163], 0
    s_waitcnt vmcnt(8)
    v_exp_f32 v66, v66
    v_exp_f32 v67, v67
    v_cvt_pk_bf16_f32 v128, v64, v65
    v_exp_f32 v68, v68
    v_exp_f32 v69, v69
    v_cvt_pk_bf16_f32 v129, v66, v67
    v_exp_f32 v70, v70
    v_exp_f32 v71, v71
    v_cvt_pk_bf16_f32 v130, v68, v69
    v_exp_f32 v72, v72
    v_mfma_f32_32x32x16_bf16 v[48:63], v[212:215], v[136:139], v[48:63]
    v_exp_f32 v73, v73
    v_cvt_pk_bf16_f32 v131, v70, v71
    v_exp_f32 v74, v74
    v_exp_f32 v75, v75
    v_cvt_pk_bf16_f32 v132, v72, v73
    v_exp_f32 v76, v76
    v_mfma_f32_32x32x16_bf16 v[48:63], v[216:219], v[140:143], v[48:63]
    buffer_load_dwordx4 v[212:215], v222, s[8:11], s31 offen sc1
    v_exp_f32 v77, v77
    v_cvt_pk_bf16_f32 v133, v74, v75
    v_exp_f32 v78, v78
    v_exp_f32 v79, v79
    v_cvt_pk_bf16_f32 v134, v76, v77
    v_exp_f32 v80, v80
    v_mfma_f32_32x32x16_bf16 v[96:111], v[164:167], v[152:155], v[96:111]
    buffer_load_dwordx4 v[216:219], v223, s[8:11], s31 offen sc1
    v_exp_f32 v81, v81
    v_cvt_pk_bf16_f32 v135, v78, v79
    v_exp_f32 v82, v82
    v_exp_f32 v83, v83
    v_cvt_pk_bf16_f32 v136, v80, v81
    v_exp_f32 v84, v84
    v_mfma_f32_32x32x16_bf16 v[0:15], v[188:191], v[128:131], v[0:15]
    v_exp_f32 v85, v85
    v_cvt_pk_bf16_f32 v137, v82, v83
    v_exp_f32 v86, v86
    v_exp_f32 v87, v87
    v_cvt_pk_bf16_f32 v138, v84, v85
    v_exp_f32 v88, v88
    v_mfma_f32_32x32x16_bf16 v[112:127], v[164:167], v[156:159], v[112:127]
    buffer_load_dwordx2 v[180:181], v221, s[8:11], s30 offen sc1
    v_exp_f32 v89, v89
    v_cvt_pk_bf16_f32 v139, v86, v87
    v_exp_f32 v90, v90
    v_exp_f32 v91, v91
    v_cvt_pk_bf16_f32 v140, v88, v89
    v_exp_f32 v92, v92
    v_mfma_f32_32x32x16_bf16 v[0:15], v[192:195], v[132:135], v[0:15]
    buffer_load_dwordx4 v[164:167], v220, s[8:11], s30 offen sc1
    v_exp_f32 v93, v93
    v_cvt_pk_bf16_f32 v141, v90, v91
    v_exp_f32 v94, v94
    v_exp_f32 v95, v95
    v_cvt_pk_bf16_f32 v142, v92, v93
    v_exp_f32 v96, v96
    v_exp_f32 v97, v97
    v_cvt_pk_bf16_f32 v143, v94, v95
    v_mfma_f32_32x32x4_2b_bf16 v[64:95], v[182:183], v[160:161], 0
    s_mov_b32 s31, s32
    v_exp_f32 v98, v98
    v_exp_f32 v99, v99
    v_cvt_pk_bf16_f32 v128, v96, v97
    v_exp_f32 v100, v100
    v_exp_f32 v101, v101
    v_cvt_pk_bf16_f32 v129, v98, v99
    v_exp_f32 v102, v102
    v_exp_f32 v103, v103
    v_cvt_pk_bf16_f32 v130, v100, v101
    v_exp_f32 v104, v104
    v_mfma_f32_32x32x16_bf16 v[16:31], v[188:191], v[136:139], v[16:31]
    s_add_u32 s33, s29, s36
    v_exp_f32 v105, v105
    v_cvt_pk_bf16_f32 v131, v102, v103
    v_exp_f32 v106, v106
    v_exp_f32 v107, v107
    v_cvt_pk_bf16_f32 v132, v104, v105
    v_exp_f32 v108, v108
    v_mfma_f32_32x32x16_bf16 v[16:31], v[192:195], v[140:143], v[16:31]
    s_mul_i32 s30, s33, 81920
    v_exp_f32 v109, v109
    v_cvt_pk_bf16_f32 v133, v106, v107
    v_exp_f32 v110, v110
    v_exp_f32 v111, v111
    v_cvt_pk_bf16_f32 v134, v108, v109
    v_exp_f32 v112, v112
    v_mfma_f32_32x32x16_bf16 v[64:79], v[168:171], v[144:147], v[64:79]
    s_mul_i32 s32, s33, 41472
    v_exp_f32 v113, v113
    v_cvt_pk_bf16_f32 v135, v110, v111
    v_exp_f32 v114, v114
    v_exp_f32 v115, v115
    v_cvt_pk_bf16_f32 v136, v112, v113
    v_exp_f32 v116, v116
    v_mfma_f32_32x32x16_bf16 v[32:47], v[188:191], v[128:131], v[32:47]
    s_add_u32 s29, s29, 1
    v_exp_f32 v117, v117
    v_cvt_pk_bf16_f32 v137, v114, v115
    v_exp_f32 v118, v118
    v_exp_f32 v119, v119
    v_cvt_pk_bf16_f32 v138, v116, v117
    v_exp_f32 v120, v120
    v_mfma_f32_32x32x16_bf16 v[80:95], v[168:171], v[148:151], v[80:95]
    s_and_b32 s29, s29, 31
    v_exp_f32 v121, v121
    v_cvt_pk_bf16_f32 v139, v118, v119
    v_exp_f32 v122, v122
    v_exp_f32 v123, v123
    v_cvt_pk_bf16_f32 v140, v120, v121
    v_exp_f32 v124, v124
    v_mfma_f32_32x32x16_bf16 v[32:47], v[192:195], v[132:135], v[32:47]
    v_exp_f32 v125, v125
    v_cvt_pk_bf16_f32 v141, v122, v123
    v_exp_f32 v126, v126
    v_exp_f32 v127, v127
    v_cvt_pk_bf16_f32 v142, v124, v125
    v_exp_f32 v64, v64
    v_exp_f32 v65, v65
    v_cvt_pk_bf16_f32 v143, v126, v127
    v_mfma_f32_32x32x4_2b_bf16 v[96:127], v[182:183], v[162:163], 0
    s_waitcnt vmcnt(8)
    v_exp_f32 v66, v66
    v_exp_f32 v67, v67
    v_cvt_pk_bf16_f32 v128, v64, v65
    v_exp_f32 v68, v68
    v_exp_f32 v69, v69
    v_cvt_pk_bf16_f32 v129, v66, v67
    v_exp_f32 v70, v70
    v_exp_f32 v71, v71
    v_cvt_pk_bf16_f32 v130, v68, v69
    v_exp_f32 v72, v72
    v_mfma_f32_32x32x16_bf16 v[48:63], v[188:191], v[136:139], v[48:63]
    v_exp_f32 v73, v73
    v_cvt_pk_bf16_f32 v131, v70, v71
    v_exp_f32 v74, v74
    v_exp_f32 v75, v75
    v_cvt_pk_bf16_f32 v132, v72, v73
    v_exp_f32 v76, v76
    v_mfma_f32_32x32x16_bf16 v[48:63], v[192:195], v[140:143], v[48:63]
    buffer_load_dwordx4 v[188:191], v222, s[8:11], s31 offen sc1
    v_exp_f32 v77, v77
    v_cvt_pk_bf16_f32 v133, v74, v75
    v_exp_f32 v78, v78
    v_exp_f32 v79, v79
    v_cvt_pk_bf16_f32 v134, v76, v77
    v_exp_f32 v80, v80
    v_mfma_f32_32x32x16_bf16 v[96:111], v[168:171], v[152:155], v[96:111]
    buffer_load_dwordx4 v[192:195], v223, s[8:11], s31 offen sc1
    v_exp_f32 v81, v81
    v_cvt_pk_bf16_f32 v135, v78, v79
    v_exp_f32 v82, v82
    v_exp_f32 v83, v83
    v_cvt_pk_bf16_f32 v136, v80, v81
    v_exp_f32 v84, v84
    v_mfma_f32_32x32x16_bf16 v[0:15], v[196:199], v[128:131], v[0:15]
    v_exp_f32 v85, v85
    v_cvt_pk_bf16_f32 v137, v82, v83
    v_exp_f32 v86, v86
    v_exp_f32 v87, v87
    v_cvt_pk_bf16_f32 v138, v84, v85
    v_exp_f32 v88, v88
    v_mfma_f32_32x32x16_bf16 v[112:127], v[168:171], v[156:159], v[112:127]
    buffer_load_dwordx2 v[182:183], v221, s[8:11], s30 offen sc1
    v_exp_f32 v89, v89
    v_cvt_pk_bf16_f32 v139, v86, v87
    v_exp_f32 v90, v90
    v_exp_f32 v91, v91
    v_cvt_pk_bf16_f32 v140, v88, v89
    v_exp_f32 v92, v92
    v_mfma_f32_32x32x16_bf16 v[0:15], v[200:203], v[132:135], v[0:15]
    buffer_load_dwordx4 v[168:171], v220, s[8:11], s30 offen sc1
    v_exp_f32 v93, v93
    v_cvt_pk_bf16_f32 v141, v90, v91
    v_exp_f32 v94, v94
    v_exp_f32 v95, v95
    v_cvt_pk_bf16_f32 v142, v92, v93
    v_exp_f32 v96, v96
    v_exp_f32 v97, v97
    v_cvt_pk_bf16_f32 v143, v94, v95
    v_mfma_f32_32x32x4_2b_bf16 v[64:95], v[184:185], v[160:161], 0
    s_mov_b32 s31, s32
    v_exp_f32 v98, v98
    v_exp_f32 v99, v99
    v_cvt_pk_bf16_f32 v128, v96, v97
    v_exp_f32 v100, v100
    v_exp_f32 v101, v101
    v_cvt_pk_bf16_f32 v129, v98, v99
    v_exp_f32 v102, v102
    v_exp_f32 v103, v103
    v_cvt_pk_bf16_f32 v130, v100, v101
    v_exp_f32 v104, v104
    v_mfma_f32_32x32x16_bf16 v[16:31], v[196:199], v[136:139], v[16:31]
    s_add_u32 s33, s29, s36
    v_exp_f32 v105, v105
    v_cvt_pk_bf16_f32 v131, v102, v103
    v_exp_f32 v106, v106
    v_exp_f32 v107, v107
    v_cvt_pk_bf16_f32 v132, v104, v105
    v_exp_f32 v108, v108
    v_mfma_f32_32x32x16_bf16 v[16:31], v[200:203], v[140:143], v[16:31]
    s_mul_i32 s30, s33, 81920
    v_exp_f32 v109, v109
    v_cvt_pk_bf16_f32 v133, v106, v107
    v_exp_f32 v110, v110
    v_exp_f32 v111, v111
    v_cvt_pk_bf16_f32 v134, v108, v109
    v_exp_f32 v112, v112
    v_mfma_f32_32x32x16_bf16 v[64:79], v[172:175], v[144:147], v[64:79]
    s_mul_i32 s32, s33, 41472
    v_exp_f32 v113, v113
    v_cvt_pk_bf16_f32 v135, v110, v111
    v_exp_f32 v114, v114
    v_exp_f32 v115, v115
    v_cvt_pk_bf16_f32 v136, v112, v113
    v_exp_f32 v116, v116
    v_mfma_f32_32x32x16_bf16 v[32:47], v[196:199], v[128:131], v[32:47]
    s_add_u32 s29, s29, 1
    v_exp_f32 v117, v117
    v_cvt_pk_bf16_f32 v137, v114, v115
    v_exp_f32 v118, v118
    v_exp_f32 v119, v119
    v_cvt_pk_bf16_f32 v138, v116, v117
    v_exp_f32 v120, v120
    v_mfma_f32_32x32x16_bf16 v[80:95], v[172:175], v[148:151], v[80:95]
    s_and_b32 s29, s29, 31
    v_exp_f32 v121, v121
    v_cvt_pk_bf16_f32 v139, v118, v119
    v_exp_f32 v122, v122
    v_exp_f32 v123, v123
    v_cvt_pk_bf16_f32 v140, v120, v121
    v_exp_f32 v124, v124
    v_mfma_f32_32x32x16_bf16 v[32:47], v[200:203], v[132:135], v[32:47]
    v_exp_f32 v125, v125
    v_cvt_pk_bf16_f32 v141, v122, v123
    v_exp_f32 v126, v126
    v_exp_f32 v127, v127
    v_cvt_pk_bf16_f32 v142, v124, v125
    v_exp_f32 v64, v64
    v_exp_f32 v65, v65
    v_cvt_pk_bf16_f32 v143, v126, v127
    v_mfma_f32_32x32x4_2b_bf16 v[96:127], v[184:185], v[162:163], 0
    s_waitcnt vmcnt(8)
    v_exp_f32 v66, v66
    v_exp_f32 v67, v67
    v_cvt_pk_bf16_f32 v128, v64, v65
    v_exp_f32 v68, v68
    v_exp_f32 v69, v69
    v_cvt_pk_bf16_f32 v129, v66, v67
    v_exp_f32 v70, v70
    v_exp_f32 v71, v71
    v_cvt_pk_bf16_f32 v130, v68, v69
    v_exp_f32 v72, v72
    v_mfma_f32_32x32x16_bf16 v[48:63], v[196:199], v[136:139], v[48:63]
    v_exp_f32 v73, v73
    v_cvt_pk_bf16_f32 v131, v70, v71
    v_exp_f32 v74, v74
    v_exp_f32 v75, v75
    v_cvt_pk_bf16_f32 v132, v72, v73
    v_exp_f32 v76, v76
    v_mfma_f32_32x32x16_bf16 v[48:63], v[200:203], v[140:143], v[48:63]
    buffer_load_dwordx4 v[196:199], v222, s[8:11], s31 offen sc1
    v_exp_f32 v77, v77
    v_cvt_pk_bf16_f32 v133, v74, v75
    v_exp_f32 v78, v78
    v_exp_f32 v79, v79
    v_cvt_pk_bf16_f32 v134, v76, v77
    v_exp_f32 v80, v80
    v_mfma_f32_32x32x16_bf16 v[96:111], v[172:175], v[152:155], v[96:111]
    buffer_load_dwordx4 v[200:203], v223, s[8:11], s31 offen sc1
    v_exp_f32 v81, v81
    v_cvt_pk_bf16_f32 v135, v78, v79
    v_exp_f32 v82, v82
    v_exp_f32 v83, v83
    v_cvt_pk_bf16_f32 v136, v80, v81
    v_exp_f32 v84, v84
    v_mfma_f32_32x32x16_bf16 v[0:15], v[204:207], v[128:131], v[0:15]
    v_exp_f32 v85, v85
    v_cvt_pk_bf16_f32 v137, v82, v83
    v_exp_f32 v86, v86
    v_exp_f32 v87, v87
    v_cvt_pk_bf16_f32 v138, v84, v85
    v_exp_f32 v88, v88
    v_mfma_f32_32x32x16_bf16 v[112:127], v[172:175], v[156:159], v[112:127]
    buffer_load_dwordx2 v[184:185], v221, s[8:11], s30 offen sc1
    v_exp_f32 v89, v89
    v_cvt_pk_bf16_f32 v139, v86, v87
    v_exp_f32 v90, v90
    v_exp_f32 v91, v91
    v_cvt_pk_bf16_f32 v140, v88, v89
    v_exp_f32 v92, v92
    v_mfma_f32_32x32x16_bf16 v[0:15], v[208:211], v[132:135], v[0:15]
    buffer_load_dwordx4 v[172:175], v220, s[8:11], s30 offen sc1
    v_exp_f32 v93, v93
    v_cvt_pk_bf16_f32 v141, v90, v91
    v_exp_f32 v94, v94
    v_exp_f32 v95, v95
    v_cvt_pk_bf16_f32 v142, v92, v93
    v_exp_f32 v96, v96
    v_exp_f32 v97, v97
    v_cvt_pk_bf16_f32 v143, v94, v95
    v_mfma_f32_32x32x4_2b_bf16 v[64:95], v[186:187], v[160:161], 0
    s_mov_b32 s31, s32
    v_exp_f32 v98, v98
    v_exp_f32 v99, v99
    v_cvt_pk_bf16_f32 v128, v96, v97
    v_exp_f32 v100, v100
    v_exp_f32 v101, v101
    v_cvt_pk_bf16_f32 v129, v98, v99
    v_exp_f32 v102, v102
    v_exp_f32 v103, v103
    v_cvt_pk_bf16_f32 v130, v100, v101
    v_exp_f32 v104, v104
    v_mfma_f32_32x32x16_bf16 v[16:31], v[204:207], v[136:139], v[16:31]
    s_add_u32 s33, s29, s36
    v_exp_f32 v105, v105
    v_cvt_pk_bf16_f32 v131, v102, v103
    v_exp_f32 v106, v106
    v_exp_f32 v107, v107
    v_cvt_pk_bf16_f32 v132, v104, v105
    v_exp_f32 v108, v108
    v_mfma_f32_32x32x16_bf16 v[16:31], v[208:211], v[140:143], v[16:31]
    s_mul_i32 s30, s33, 81920
    v_exp_f32 v109, v109
    v_cvt_pk_bf16_f32 v133, v106, v107
    v_exp_f32 v110, v110
    v_exp_f32 v111, v111
    v_cvt_pk_bf16_f32 v134, v108, v109
    v_exp_f32 v112, v112
    v_mfma_f32_32x32x16_bf16 v[64:79], v[176:179], v[144:147], v[64:79]
    s_mul_i32 s32, s33, 41472
    v_exp_f32 v113, v113
    v_cvt_pk_bf16_f32 v135, v110, v111
    v_exp_f32 v114, v114
    v_exp_f32 v115, v115
    v_cvt_pk_bf16_f32 v136, v112, v113
    v_exp_f32 v116, v116
    v_mfma_f32_32x32x16_bf16 v[32:47], v[204:207], v[128:131], v[32:47]
    s_add_u32 s29, s29, 1
    v_exp_f32 v117, v117
    v_cvt_pk_bf16_f32 v137, v114, v115
    v_exp_f32 v118, v118
    v_exp_f32 v119, v119
    v_cvt_pk_bf16_f32 v138, v116, v117
    v_exp_f32 v120, v120
    v_mfma_f32_32x32x16_bf16 v[80:95], v[176:179], v[148:151], v[80:95]
    s_and_b32 s29, s29, 31
    v_exp_f32 v121, v121
    v_cvt_pk_bf16_f32 v139, v118, v119
    v_exp_f32 v122, v122
    v_exp_f32 v123, v123
    v_cvt_pk_bf16_f32 v140, v120, v121
    v_exp_f32 v124, v124
    v_mfma_f32_32x32x16_bf16 v[32:47], v[208:211], v[132:135], v[32:47]
    v_exp_f32 v125, v125
    v_cvt_pk_bf16_f32 v141, v122, v123
    v_exp_f32 v126, v126
    v_exp_f32 v127, v127
    v_cvt_pk_bf16_f32 v142, v124, v125
    v_exp_f32 v64, v64
    v_exp_f32 v65, v65
    v_cvt_pk_bf16_f32 v143, v126, v127
    v_mfma_f32_32x32x4_2b_bf16 v[96:127], v[186:187], v[162:163], 0
    s_waitcnt vmcnt(8)
    v_exp_f32 v66, v66
    v_exp_f32 v67, v67
    v_cvt_pk_bf16_f32 v128, v64, v65
    v_exp_f32 v68, v68
    v_exp_f32 v69, v69
    v_cvt_pk_bf16_f32 v129, v66, v67
    v_exp_f32 v70, v70
    v_exp_f32 v71, v71
    v_cvt_pk_bf16_f32 v130, v68, v69
    v_exp_f32 v72, v72
    v_mfma_f32_32x32x16_bf16 v[48:63], v[204:207], v[136:139], v[48:63]
    v_exp_f32 v73, v73
    v_cvt_pk_bf16_f32 v131, v70, v71
    v_exp_f32 v74, v74
    v_exp_f32 v75, v75
    v_cvt_pk_bf16_f32 v132, v72, v73
    v_exp_f32 v76, v76
    v_mfma_f32_32x32x16_bf16 v[48:63], v[208:211], v[140:143], v[48:63]
    buffer_load_dwordx4 v[204:207], v222, s[8:11], s31 offen sc1
    v_exp_f32 v77, v77
    v_cvt_pk_bf16_f32 v133, v74, v75
    v_exp_f32 v78, v78
    v_exp_f32 v79, v79
    v_cvt_pk_bf16_f32 v134, v76, v77
    v_exp_f32 v80, v80
    v_mfma_f32_32x32x16_bf16 v[96:111], v[176:179], v[152:155], v[96:111]
    buffer_load_dwordx4 v[208:211], v223, s[8:11], s31 offen sc1
    v_exp_f32 v81, v81
    v_cvt_pk_bf16_f32 v135, v78, v79
    v_exp_f32 v82, v82
    v_exp_f32 v83, v83
    v_cvt_pk_bf16_f32 v136, v80, v81
    v_exp_f32 v84, v84
    v_mfma_f32_32x32x16_bf16 v[0:15], v[212:215], v[128:131], v[0:15]
    v_exp_f32 v85, v85
    v_cvt_pk_bf16_f32 v137, v82, v83
    v_exp_f32 v86, v86
    v_exp_f32 v87, v87
    v_cvt_pk_bf16_f32 v138, v84, v85
    v_exp_f32 v88, v88
    v_mfma_f32_32x32x16_bf16 v[112:127], v[176:179], v[156:159], v[112:127]
    buffer_load_dwordx2 v[186:187], v221, s[8:11], s30 offen sc1
    v_exp_f32 v89, v89
    v_cvt_pk_bf16_f32 v139, v86, v87
    v_exp_f32 v90, v90
    v_exp_f32 v91, v91
    v_cvt_pk_bf16_f32 v140, v88, v89
    v_exp_f32 v92, v92
    v_mfma_f32_32x32x16_bf16 v[0:15], v[216:219], v[132:135], v[0:15]
    buffer_load_dwordx4 v[176:179], v220, s[8:11], s30 offen sc1
    v_exp_f32 v93, v93
    v_cvt_pk_bf16_f32 v141, v90, v91
    v_exp_f32 v94, v94
    v_exp_f32 v95, v95
    v_cvt_pk_bf16_f32 v142, v92, v93
    v_exp_f32 v96, v96
    v_exp_f32 v97, v97
    v_cvt_pk_bf16_f32 v143, v94, v95
    v_mfma_f32_32x32x4_2b_bf16 v[64:95], v[180:181], v[160:161], 0
    s_mov_b32 s31, s32
    v_exp_f32 v98, v98
    v_exp_f32 v99, v99
    v_cvt_pk_bf16_f32 v128, v96, v97
    v_exp_f32 v100, v100
    v_exp_f32 v101, v101
    v_cvt_pk_bf16_f32 v129, v98, v99
    v_exp_f32 v102, v102
    v_exp_f32 v103, v103
    v_cvt_pk_bf16_f32 v130, v100, v101
    v_exp_f32 v104, v104
    v_mfma_f32_32x32x16_bf16 v[16:31], v[212:215], v[136:139], v[16:31]
    s_add_u32 s33, s29, s36
    v_exp_f32 v105, v105
    v_cvt_pk_bf16_f32 v131, v102, v103
    v_exp_f32 v106, v106
    v_exp_f32 v107, v107
    v_cvt_pk_bf16_f32 v132, v104, v105
    v_exp_f32 v108, v108
    v_mfma_f32_32x32x16_bf16 v[16:31], v[216:219], v[140:143], v[16:31]
    s_mul_i32 s30, s33, 81920
    v_exp_f32 v109, v109
    v_cvt_pk_bf16_f32 v133, v106, v107
    v_exp_f32 v110, v110
    v_exp_f32 v111, v111
    v_cvt_pk_bf16_f32 v134, v108, v109
    v_exp_f32 v112, v112
    v_mfma_f32_32x32x16_bf16 v[64:79], v[164:167], v[144:147], v[64:79]
    s_mul_i32 s32, s33, 41472
    v_exp_f32 v113, v113
    v_cvt_pk_bf16_f32 v135, v110, v111
    v_exp_f32 v114, v114
    v_exp_f32 v115, v115
    v_cvt_pk_bf16_f32 v136, v112, v113
    v_exp_f32 v116, v116
    v_mfma_f32_32x32x16_bf16 v[32:47], v[212:215], v[128:131], v[32:47]
    s_add_u32 s29, s29, 1
    v_exp_f32 v117, v117
    v_cvt_pk_bf16_f32 v137, v114, v115
    v_exp_f32 v118, v118
    v_exp_f32 v119, v119
    v_cvt_pk_bf16_f32 v138, v116, v117
    v_exp_f32 v120, v120
    v_mfma_f32_32x32x16_bf16 v[80:95], v[164:167], v[148:151], v[80:95]
    s_and_b32 s29, s29, 31
    v_exp_f32 v121, v121
    v_cvt_pk_bf16_f32 v139, v118, v119
    v_exp_f32 v122, v122
    v_exp_f32 v123, v123
    v_cvt_pk_bf16_f32 v140, v120, v121
    v_exp_f32 v124, v124
    v_mfma_f32_32x32x16_bf16 v[32:47], v[216:219], v[132:135], v[32:47]
    v_exp_f32 v125, v125
    v_cvt_pk_bf16_f32 v141, v122, v123
    v_exp_f32 v126, v126
    v_exp_f32 v127, v127
    v_cvt_pk_bf16_f32 v142, v124, v125
    v_exp_f32 v64, v64
    v_exp_f32 v65, v65
    v_cvt_pk_bf16_f32 v143, v126, v127
    v_mfma_f32_32x32x4_2b_bf16 v[96:127], v[180:181], v[162:163], 0
    s_waitcnt vmcnt(8)
    v_exp_f32 v66, v66
    v_exp_f32 v67, v67
    v_cvt_pk_bf16_f32 v128, v64, v65
    v_exp_f32 v68, v68
    v_exp_f32 v69, v69
    v_cvt_pk_bf16_f32 v129, v66, v67
    v_exp_f32 v70, v70
    v_exp_f32 v71, v71
    v_cvt_pk_bf16_f32 v130, v68, v69
    v_exp_f32 v72, v72
    v_mfma_f32_32x32x16_bf16 v[48:63], v[212:215], v[136:139], v[48:63]
    v_exp_f32 v73, v73
    v_cvt_pk_bf16_f32 v131, v70, v71
    v_exp_f32 v74, v74
    v_exp_f32 v75, v75
    v_cvt_pk_bf16_f32 v132, v72, v73
    v_exp_f32 v76, v76
    v_mfma_f32_32x32x16_bf16 v[48:63], v[216:219], v[140:143], v[48:63]
    buffer_load_dwordx4 v[212:215], v222, s[8:11], s31 offen sc1
    v_exp_f32 v77, v77
    v_cvt_pk_bf16_f32 v133, v74, v75
    v_exp_f32 v78, v78
    v_exp_f32 v79, v79
    v_cvt_pk_bf16_f32 v134, v76, v77
    v_exp_f32 v80, v80
    v_mfma_f32_32x32x16_bf16 v[96:111], v[164:167], v[152:155], v[96:111]
    buffer_load_dwordx4 v[216:219], v223, s[8:11], s31 offen sc1
    v_exp_f32 v81, v81
    v_cvt_pk_bf16_f32 v135, v78, v79
    v_exp_f32 v82, v82
    v_exp_f32 v83, v83
    v_cvt_pk_bf16_f32 v136, v80, v81
    v_exp_f32 v84, v84
    v_mfma_f32_32x32x16_bf16 v[0:15], v[188:191], v[128:131], v[0:15]
    v_exp_f32 v85, v85
    v_cvt_pk_bf16_f32 v137, v82, v83
    v_exp_f32 v86, v86
    v_exp_f32 v87, v87
    v_cvt_pk_bf16_f32 v138, v84, v85
    v_exp_f32 v88, v88
    v_mfma_f32_32x32x16_bf16 v[112:127], v[164:167], v[156:159], v[112:127]
    buffer_load_dwordx2 v[180:181], v221, s[8:11], s30 offen sc1
    v_exp_f32 v89, v89
    v_cvt_pk_bf16_f32 v139, v86, v87
    v_exp_f32 v90, v90
    v_exp_f32 v91, v91
    v_cvt_pk_bf16_f32 v140, v88, v89
    v_exp_f32 v92, v92
    v_mfma_f32_32x32x16_bf16 v[0:15], v[192:195], v[132:135], v[0:15]
    buffer_load_dwordx4 v[164:167], v220, s[8:11], s30 offen sc1
    v_exp_f32 v93, v93
    v_cvt_pk_bf16_f32 v141, v90, v91
    v_exp_f32 v94, v94
    v_exp_f32 v95, v95
    v_cvt_pk_bf16_f32 v142, v92, v93
    v_exp_f32 v96, v96
    v_exp_f32 v97, v97
    v_cvt_pk_bf16_f32 v143, v94, v95
    v_mfma_f32_32x32x4_2b_bf16 v[64:95], v[182:183], v[160:161], 0
    s_mov_b32 s31, s32
    v_exp_f32 v98, v98
    v_exp_f32 v99, v99
    v_cvt_pk_bf16_f32 v128, v96, v97
    v_exp_f32 v100, v100
    v_exp_f32 v101, v101
    v_cvt_pk_bf16_f32 v129, v98, v99
    v_exp_f32 v102, v102
    v_exp_f32 v103, v103
    v_cvt_pk_bf16_f32 v130, v100, v101
    v_exp_f32 v104, v104
    v_mfma_f32_32x32x16_bf16 v[16:31], v[188:191], v[136:139], v[16:31]
    s_add_u32 s33, s29, s36
    v_exp_f32 v105, v105
    v_cvt_pk_bf16_f32 v131, v102, v103
    v_exp_f32 v106, v106
    v_exp_f32 v107, v107
    v_cvt_pk_bf16_f32 v132, v104, v105
    v_exp_f32 v108, v108
    v_mfma_f32_32x32x16_bf16 v[16:31], v[192:195], v[140:143], v[16:31]
    s_mul_i32 s30, s33, 81920
    v_exp_f32 v109, v109
    v_cvt_pk_bf16_f32 v133, v106, v107
    v_exp_f32 v110, v110
    v_exp_f32 v111, v111
    v_cvt_pk_bf16_f32 v134, v108, v109
    v_exp_f32 v112, v112
    v_mfma_f32_32x32x16_bf16 v[64:79], v[168:171], v[144:147], v[64:79]
    s_mul_i32 s32, s33, 41472
    v_exp_f32 v113, v113
    v_cvt_pk_bf16_f32 v135, v110, v111
    v_exp_f32 v114, v114
    v_exp_f32 v115, v115
    v_cvt_pk_bf16_f32 v136, v112, v113
    v_exp_f32 v116, v116
    v_mfma_f32_32x32x16_bf16 v[32:47], v[188:191], v[128:131], v[32:47]
    s_add_u32 s29, s29, 1
    v_exp_f32 v117, v117
    v_cvt_pk_bf16_f32 v137, v114, v115
    v_exp_f32 v118, v118
    v_exp_f32 v119, v119
    v_cvt_pk_bf16_f32 v138, v116, v117
    v_exp_f32 v120, v120
    v_mfma_f32_32x32x16_bf16 v[80:95], v[168:171], v[148:151], v[80:95]
    s_and_b32 s29, s29, 31
    v_exp_f32 v121, v121
    v_cvt_pk_bf16_f32 v139, v118, v119
    v_exp_f32 v122, v122
    v_exp_f32 v123, v123
    v_cvt_pk_bf16_f32 v140, v120, v121
    v_exp_f32 v124, v124
    v_mfma_f32_32x32x16_bf16 v[32:47], v[192:195], v[132:135], v[32:47]
    v_exp_f32 v125, v125
    v_cvt_pk_bf16_f32 v141, v122, v123
    v_exp_f32 v126, v126
    v_exp_f32 v127, v127
    v_cvt_pk_bf16_f32 v142, v124, v125
    v_exp_f32 v64, v64
    v_exp_f32 v65, v65
    v_cvt_pk_bf16_f32 v143, v126, v127
    v_mfma_f32_32x32x4_2b_bf16 v[96:127], v[182:183], v[162:163], 0
    s_waitcnt vmcnt(8)
    v_exp_f32 v66, v66
    v_exp_f32 v67, v67
    v_cvt_pk_bf16_f32 v128, v64, v65
    v_exp_f32 v68, v68
    v_exp_f32 v69, v69
    v_cvt_pk_bf16_f32 v129, v66, v67
    v_exp_f32 v70, v70
    v_exp_f32 v71, v71
    v_cvt_pk_bf16_f32 v130, v68, v69
    v_exp_f32 v72, v72
    v_mfma_f32_32x32x16_bf16 v[48:63], v[188:191], v[136:139], v[48:63]
    v_exp_f32 v73, v73
    v_cvt_pk_bf16_f32 v131, v70, v71
    v_exp_f32 v74, v74
    v_exp_f32 v75, v75
    v_cvt_pk_bf16_f32 v132, v72, v73
    v_exp_f32 v76, v76
    v_mfma_f32_32x32x16_bf16 v[48:63], v[192:195], v[140:143], v[48:63]
    buffer_load_dwordx4 v[188:191], v222, s[8:11], s31 offen sc1
    v_exp_f32 v77, v77
    v_cvt_pk_bf16_f32 v133, v74, v75
    v_exp_f32 v78, v78
    v_exp_f32 v79, v79
    v_cvt_pk_bf16_f32 v134, v76, v77
    v_exp_f32 v80, v80
    v_mfma_f32_32x32x16_bf16 v[96:111], v[168:171], v[152:155], v[96:111]
    buffer_load_dwordx4 v[192:195], v223, s[8:11], s31 offen sc1
    v_exp_f32 v81, v81
    v_cvt_pk_bf16_f32 v135, v78, v79
    v_exp_f32 v82, v82
    v_exp_f32 v83, v83
    v_cvt_pk_bf16_f32 v136, v80, v81
    v_exp_f32 v84, v84
    v_mfma_f32_32x32x16_bf16 v[0:15], v[196:199], v[128:131], v[0:15]
    v_exp_f32 v85, v85
    v_cvt_pk_bf16_f32 v137, v82, v83
    v_exp_f32 v86, v86
    v_exp_f32 v87, v87
    v_cvt_pk_bf16_f32 v138, v84, v85
    v_exp_f32 v88, v88
    v_mfma_f32_32x32x16_bf16 v[112:127], v[168:171], v[156:159], v[112:127]
    buffer_load_dwordx2 v[182:183], v221, s[8:11], s30 offen sc1
    v_exp_f32 v89, v89
    v_cvt_pk_bf16_f32 v139, v86, v87
    v_exp_f32 v90, v90
    v_exp_f32 v91, v91
    v_cvt_pk_bf16_f32 v140, v88, v89
    v_exp_f32 v92, v92
    v_mfma_f32_32x32x16_bf16 v[0:15], v[200:203], v[132:135], v[0:15]
    buffer_load_dwordx4 v[168:171], v220, s[8:11], s30 offen sc1
    v_exp_f32 v93, v93
    v_cvt_pk_bf16_f32 v141, v90, v91
    v_exp_f32 v94, v94
    v_exp_f32 v95, v95
    v_cvt_pk_bf16_f32 v142, v92, v93
    v_exp_f32 v96, v96
    v_exp_f32 v97, v97
    v_cvt_pk_bf16_f32 v143, v94, v95
    v_mfma_f32_32x32x4_2b_bf16 v[64:95], v[184:185], v[160:161], 0
    s_mov_b32 s31, s32
    v_exp_f32 v98, v98
    v_exp_f32 v99, v99
    v_cvt_pk_bf16_f32 v128, v96, v97
    v_exp_f32 v100, v100
    v_exp_f32 v101, v101
    v_cvt_pk_bf16_f32 v129, v98, v99
    v_exp_f32 v102, v102
    v_exp_f32 v103, v103
    v_cvt_pk_bf16_f32 v130, v100, v101
    v_exp_f32 v104, v104
    v_mfma_f32_32x32x16_bf16 v[16:31], v[196:199], v[136:139], v[16:31]
    s_add_u32 s33, s29, s36
    v_exp_f32 v105, v105
    v_cvt_pk_bf16_f32 v131, v102, v103
    v_exp_f32 v106, v106
    v_exp_f32 v107, v107
    v_cvt_pk_bf16_f32 v132, v104, v105
    v_exp_f32 v108, v108
    v_mfma_f32_32x32x16_bf16 v[16:31], v[200:203], v[140:143], v[16:31]
    s_mul_i32 s30, s33, 81920
    v_exp_f32 v109, v109
    v_cvt_pk_bf16_f32 v133, v106, v107
    v_exp_f32 v110, v110
    v_exp_f32 v111, v111
    v_cvt_pk_bf16_f32 v134, v108, v109
    v_exp_f32 v112, v112
    v_mfma_f32_32x32x16_bf16 v[64:79], v[172:175], v[144:147], v[64:79]
    s_mul_i32 s32, s33, 41472
    v_exp_f32 v113, v113
    v_cvt_pk_bf16_f32 v135, v110, v111
    v_exp_f32 v114, v114
    v_exp_f32 v115, v115
    v_cvt_pk_bf16_f32 v136, v112, v113
    v_exp_f32 v116, v116
    v_mfma_f32_32x32x16_bf16 v[32:47], v[196:199], v[128:131], v[32:47]
    s_add_u32 s29, s29, 1
    v_exp_f32 v117, v117
    v_cvt_pk_bf16_f32 v137, v114, v115
    v_exp_f32 v118, v118
    v_exp_f32 v119, v119
    v_cvt_pk_bf16_f32 v138, v116, v117
    v_exp_f32 v120, v120
    v_mfma_f32_32x32x16_bf16 v[80:95], v[172:175], v[148:151], v[80:95]
    s_and_b32 s29, s29, 31
    v_exp_f32 v121, v121
    v_cvt_pk_bf16_f32 v139, v118, v119
    v_exp_f32 v122, v122
    v_exp_f32 v123, v123
    v_cvt_pk_bf16_f32 v140, v120, v121
    v_exp_f32 v124, v124
    v_mfma_f32_32x32x16_bf16 v[32:47], v[200:203], v[132:135], v[32:47]
    v_exp_f32 v125, v125
    v_cvt_pk_bf16_f32 v141, v122, v123
    v_exp_f32 v126, v126
    v_exp_f32 v127, v127
    buffer_store_dword v247, v246, s[8:11], 0 offen
    v_cvt_pk_bf16_f32 v142, v124, v125
    v_exp_f32 v64, v64
    v_exp_f32 v65, v65
    v_cvt_pk_bf16_f32 v143, v126, v127
    v_mfma_f32_32x32x4_2b_bf16 v[96:127], v[184:185], v[162:163], 0
    s_waitcnt vmcnt(8)
    v_exp_f32 v66, v66
    v_exp_f32 v67, v67
    v_cvt_pk_bf16_f32 v128, v64, v65
    v_exp_f32 v68, v68
    v_exp_f32 v69, v69
    v_cvt_pk_bf16_f32 v129, v66, v67
    v_exp_f32 v70, v70
    v_exp_f32 v71, v71
    v_cvt_pk_bf16_f32 v130, v68, v69
    v_exp_f32 v72, v72
    v_mfma_f32_32x32x16_bf16 v[48:63], v[196:199], v[136:139], v[48:63]
    v_exp_f32 v73, v73
    v_cvt_pk_bf16_f32 v131, v70, v71
    v_exp_f32 v74, v74
    v_exp_f32 v75, v75
    v_cvt_pk_bf16_f32 v132, v72, v73
    v_exp_f32 v76, v76
    v_mfma_f32_32x32x16_bf16 v[48:63], v[200:203], v[140:143], v[48:63]
    buffer_load_dwordx4 v[196:199], v222, s[8:11], s31 offen sc1
    v_exp_f32 v77, v77
    v_cvt_pk_bf16_f32 v133, v74, v75
    v_exp_f32 v78, v78
    v_exp_f32 v79, v79
    v_cvt_pk_bf16_f32 v134, v76, v77
    v_exp_f32 v80, v80
    v_mfma_f32_32x32x16_bf16 v[96:111], v[172:175], v[152:155], v[96:111]
    buffer_load_dwordx4 v[200:203], v223, s[8:11], s31 offen sc1
    v_exp_f32 v81, v81
    v_cvt_pk_bf16_f32 v135, v78, v79
    v_exp_f32 v82, v82
    v_exp_f32 v83, v83
    v_cvt_pk_bf16_f32 v136, v80, v81
    v_exp_f32 v84, v84
    v_mfma_f32_32x32x16_bf16 v[0:15], v[204:207], v[128:131], v[0:15]
    v_exp_f32 v85, v85
    v_cvt_pk_bf16_f32 v137, v82, v83
    v_exp_f32 v86, v86
    v_exp_f32 v87, v87
    v_cvt_pk_bf16_f32 v138, v84, v85
    v_exp_f32 v88, v88
    v_mfma_f32_32x32x16_bf16 v[112:127], v[172:175], v[156:159], v[112:127]
    buffer_load_dwordx2 v[184:185], v221, s[8:11], s30 offen sc1
    v_exp_f32 v89, v89
    v_cvt_pk_bf16_f32 v139, v86, v87
    v_exp_f32 v90, v90
    v_exp_f32 v91, v91
    v_cvt_pk_bf16_f32 v140, v88, v89
    v_exp_f32 v92, v92
    v_mfma_f32_32x32x16_bf16 v[0:15], v[208:211], v[132:135], v[0:15]
    buffer_load_dwordx4 v[172:175], v220, s[8:11], s30 offen sc1
    v_exp_f32 v93, v93
    v_cvt_pk_bf16_f32 v141, v90, v91
    v_exp_f32 v94, v94
    v_exp_f32 v95, v95
    v_cvt_pk_bf16_f32 v142, v92, v93
    v_exp_f32 v96, v96
    v_exp_f32 v97, v97
    v_cvt_pk_bf16_f32 v143, v94, v95
    v_mfma_f32_32x32x4_2b_bf16 v[64:95], v[186:187], v[160:161], 0
    s_mov_b32 s31, s32
    v_exp_f32 v98, v98
    v_exp_f32 v99, v99
    v_cvt_pk_bf16_f32 v128, v96, v97
    v_exp_f32 v100, v100
    v_exp_f32 v101, v101
    v_cvt_pk_bf16_f32 v129, v98, v99
    v_exp_f32 v102, v102
    v_exp_f32 v103, v103
    v_cvt_pk_bf16_f32 v130, v100, v101
    v_exp_f32 v104, v104
    v_mfma_f32_32x32x16_bf16 v[16:31], v[204:207], v[136:139], v[16:31]
    s_add_u32 s33, s29, s36
    v_exp_f32 v105, v105
    v_cvt_pk_bf16_f32 v131, v102, v103
    v_exp_f32 v106, v106
    v_exp_f32 v107, v107
    v_cvt_pk_bf16_f32 v132, v104, v105
    v_exp_f32 v108, v108
    v_mfma_f32_32x32x16_bf16 v[16:31], v[208:211], v[140:143], v[16:31]
    s_mul_i32 s30, s33, 81920
    v_exp_f32 v109, v109
    v_cvt_pk_bf16_f32 v133, v106, v107
    v_exp_f32 v110, v110
    v_exp_f32 v111, v111
    v_cvt_pk_bf16_f32 v134, v108, v109
    v_exp_f32 v112, v112
    v_mfma_f32_32x32x16_bf16 v[64:79], v[176:179], v[144:147], v[64:79]
    s_mul_i32 s32, s33, 41472
    v_exp_f32 v113, v113
    v_cvt_pk_bf16_f32 v135, v110, v111
    v_exp_f32 v114, v114
    v_exp_f32 v115, v115
    v_cvt_pk_bf16_f32 v136, v112, v113
    v_exp_f32 v116, v116
    v_mfma_f32_32x32x16_bf16 v[32:47], v[204:207], v[128:131], v[32:47]
    s_add_u32 s29, s29, 1
    v_exp_f32 v117, v117
    v_cvt_pk_bf16_f32 v137, v114, v115
    v_exp_f32 v118, v118
    v_exp_f32 v119, v119
    v_cvt_pk_bf16_f32 v138, v116, v117
    v_exp_f32 v120, v120
    v_mfma_f32_32x32x16_bf16 v[80:95], v[176:179], v[148:151], v[80:95]
    s_and_b32 s29, s29, 31
    v_exp_f32 v121, v121
    v_cvt_pk_bf16_f32 v139, v118, v119
    v_exp_f32 v122, v122
    v_exp_f32 v123, v123
    v_cvt_pk_bf16_f32 v140, v120, v121
    v_exp_f32 v124, v124
    v_mfma_f32_32x32x16_bf16 v[32:47], v[208:211], v[132:135], v[32:47]
    v_exp_f32 v125, v125
    v_cvt_pk_bf16_f32 v141, v122, v123
    v_exp_f32 v126, v126
    v_exp_f32 v127, v127
    v_cvt_pk_bf16_f32 v142, v124, v125
    v_exp_f32 v64, v64
    v_exp_f32 v65, v65
    v_cvt_pk_bf16_f32 v143, v126, v127
    v_mfma_f32_32x32x4_2b_bf16 v[96:127], v[186:187], v[162:163], 0
    s_waitcnt vmcnt(8)
    v_exp_f32 v66, v66
    v_exp_f32 v67, v67
    v_cvt_pk_bf16_f32 v128, v64, v65
    v_exp_f32 v68, v68
    v_exp_f32 v69, v69
    v_cvt_pk_bf16_f32 v129, v66, v67
    v_exp_f32 v70, v70
    v_exp_f32 v71, v71
    v_cvt_pk_bf16_f32 v130, v68, v69
    v_exp_f32 v72, v72
    v_mfma_f32_32x32x16_bf16 v[48:63], v[204:207], v[136:139], v[48:63]
    v_exp_f32 v73, v73
    v_cvt_pk_bf16_f32 v131, v70, v71
    v_exp_f32 v74, v74
    v_exp_f32 v75, v75
    v_cvt_pk_bf16_f32 v132, v72, v73
    v_exp_f32 v76, v76
    v_mfma_f32_32x32x16_bf16 v[48:63], v[208:211], v[140:143], v[48:63]
    buffer_load_dwordx4 v[204:207], v222, s[8:11], s31 offen sc1
    v_exp_f32 v77, v77
    v_cvt_pk_bf16_f32 v133, v74, v75
    v_exp_f32 v78, v78
    v_exp_f32 v79, v79
    v_cvt_pk_bf16_f32 v134, v76, v77
    v_exp_f32 v80, v80
    v_mfma_f32_32x32x16_bf16 v[96:111], v[176:179], v[152:155], v[96:111]
    buffer_load_dwordx4 v[208:211], v223, s[8:11], s31 offen sc1
    v_exp_f32 v81, v81
    v_cvt_pk_bf16_f32 v135, v78, v79
    v_exp_f32 v82, v82
    v_exp_f32 v83, v83
    v_cvt_pk_bf16_f32 v136, v80, v81
    v_exp_f32 v84, v84
    v_mfma_f32_32x32x16_bf16 v[0:15], v[212:215], v[128:131], v[0:15]
    v_exp_f32 v85, v85
    v_cvt_pk_bf16_f32 v137, v82, v83
    v_exp_f32 v86, v86
    v_exp_f32 v87, v87
    v_cvt_pk_bf16_f32 v138, v84, v85
    v_exp_f32 v88, v88
    v_mfma_f32_32x32x16_bf16 v[112:127], v[176:179], v[156:159], v[112:127]
    buffer_load_dwordx2 v[186:187], v221, s[8:11], s30 offen sc1
    v_exp_f32 v89, v89
    v_cvt_pk_bf16_f32 v139, v86, v87
    v_exp_f32 v90, v90
    v_exp_f32 v91, v91
    v_cvt_pk_bf16_f32 v140, v88, v89
    v_exp_f32 v92, v92
    v_mfma_f32_32x32x16_bf16 v[0:15], v[216:219], v[132:135], v[0:15]
    buffer_load_dwordx4 v[176:179], v220, s[8:11], s30 offen sc1
    v_exp_f32 v93, v93
    v_cvt_pk_bf16_f32 v141, v90, v91
    v_exp_f32 v94, v94
    v_exp_f32 v95, v95
    v_cvt_pk_bf16_f32 v142, v92, v93
    v_exp_f32 v96, v96
    v_exp_f32 v97, v97
    v_cvt_pk_bf16_f32 v143, v94, v95
    v_mfma_f32_32x32x4_2b_bf16 v[64:95], v[180:181], v[160:161], 0
    s_mov_b32 s31, s32
    v_exp_f32 v98, v98
    v_exp_f32 v99, v99
    v_cvt_pk_bf16_f32 v128, v96, v97
    v_exp_f32 v100, v100
    v_exp_f32 v101, v101
    v_cvt_pk_bf16_f32 v129, v98, v99
    v_exp_f32 v102, v102
    v_exp_f32 v103, v103
    v_cvt_pk_bf16_f32 v130, v100, v101
    v_exp_f32 v104, v104
    v_mfma_f32_32x32x16_bf16 v[16:31], v[212:215], v[136:139], v[16:31]
    s_add_u32 s33, s29, s36
    v_exp_f32 v105, v105
    v_cvt_pk_bf16_f32 v131, v102, v103
    v_exp_f32 v106, v106
    v_exp_f32 v107, v107
    v_cvt_pk_bf16_f32 v132, v104, v105
    v_exp_f32 v108, v108
    v_mfma_f32_32x32x16_bf16 v[16:31], v[216:219], v[140:143], v[16:31]
    s_mul_i32 s30, s33, 81920
    v_exp_f32 v109, v109
    v_cvt_pk_bf16_f32 v133, v106, v107
    v_exp_f32 v110, v110
    v_exp_f32 v111, v111
    v_cvt_pk_bf16_f32 v134, v108, v109
    v_exp_f32 v112, v112
    v_mfma_f32_32x32x16_bf16 v[64:79], v[164:167], v[144:147], v[64:79]
    s_mul_i32 s32, s33, 41472
    v_exp_f32 v113, v113
    v_cvt_pk_bf16_f32 v135, v110, v111
    v_exp_f32 v114, v114
    v_exp_f32 v115, v115
    v_cvt_pk_bf16_f32 v136, v112, v113
    v_exp_f32 v116, v116
    v_mfma_f32_32x32x16_bf16 v[32:47], v[212:215], v[128:131], v[32:47]
    s_add_u32 s29, s29, 1
    v_exp_f32 v117, v117
    v_cvt_pk_bf16_f32 v137, v114, v115
    v_exp_f32 v118, v118
    v_exp_f32 v119, v119
    v_cvt_pk_bf16_f32 v138, v116, v117
    v_exp_f32 v120, v120
    v_mfma_f32_32x32x16_bf16 v[80:95], v[164:167], v[148:151], v[80:95]
    s_and_b32 s29, s29, 31
    s_sub_u32 s35, s35, 1
    v_exp_f32 v121, v121
    v_cvt_pk_bf16_f32 v139, v118, v119
    v_exp_f32 v122, v122
    v_exp_f32 v123, v123
    v_cvt_pk_bf16_f32 v140, v120, v121
    v_exp_f32 v124, v124
    v_mfma_f32_32x32x16_bf16 v[32:47], v[216:219], v[132:135], v[32:47]
    s_cmp_lg_u32 s35, 0
    v_exp_f32 v125, v125
    v_cvt_pk_bf16_f32 v141, v122, v123
    v_exp_f32 v126, v126
    v_exp_f32 v127, v127
    v_cvt_pk_bf16_f32 v142, v124, v125
    s_cbranch_scc1 at_loop
    s_setprio 3
    v_mfma_f32_32x32x16_bf16 v[48:63], v[212:215], v[136:139], v[48:63]
    v_cvt_pk_bf16_f32 v143, v126, v127
    v_lshlrev_b32 v226, 4, v224
    s_mul_i32 s33, s64, 6144
    s_add_u32 s33, s33, 32768
    v_mfma_f32_32x32x16_bf16 v[48:63], v[216:219], v[140:143], v[48:63]
    v_add_u32 v227, s33, v226
    s_xor_b32 s34, s64, 1
    s_mul_i32 s34, s34, 6144
    s_add_u32 s34, s34, 32768
    v_add_u32 v228, s34, v226
    ds_write_b128 v227, v[32:35] offset:0
    ds_write_b128 v227, v[36:39] offset:1024
    ds_write_b128 v227, v[40:43] offset:2048
    s_mul_i32 s33, s38, 40960
    s_add_u32 s33, s33, 8388608
    s_add_u32 s34, s33, 40960
    s_mov_b32 s29, 40960
    v_subrev_u32 v229, s29, v220
    v_subrev_u32 v230, s29, v221
    v_cmp_le_u32 vcc, 32, v224
    ds_write_b128 v227, v[48:51] offset:3072
    ds_write_b128 v227, v[52:55] offset:4096
    ds_write_b128 v227, v[56:59] offset:5120
    v_and_b32 v230, -16, v230
    v_cndmask_b32 v230, v230, v231, vcc
    s_lshl_b32 s29, s64, 10
    s_add_u32 s29, s29, 61440
    v_lshrrev_b32 v234, 1, v226
    v_add_u32 v233, s29, v234
    s_lshl_b32 s29, s28, 10
    s_lshl_b32 s30, s27, 9
    s_add_u32 s29, s29, s30
    s_add_u32 s29, s29, 61440
    v_add_u32 v234, s29, v234
    s_waitcnt lgkmcnt(0)
    s_barrier
    ds_read_b128 v[96:99], v228 offset:0
    ds_read_b128 v[100:103], v228 offset:1024
    ds_read_b128 v[104:107], v228 offset:2048
    ds_read_b128 v[112:115], v228 offset:3072
    ds_read_b128 v[116:119], v228 offset:4096
    ds_read_b128 v[120:123], v228 offset:5120
    v_mov_b32 v232, 0x207
    s_mov_b64 s[40:41], 0
    s_waitcnt lgkmcnt(3)
    v_pk_add_f32 v[0:1], v[0:1], v[96:97]
    v_pk_add_f32 v[2:3], v[2:3], v[98:99]
    v_pk_add_f32 v[4:5], v[4:5], v[100:101]
    v_pk_add_f32 v[6:7], v[6:7], v[102:103]
    v_pk_add_f32 v[8:9], v[8:9], v[104:105]
    v_pk_add_f32 v[10:11], v[10:11], v[106:107]
    v_pk_add_f32 v[64:65], v[0:1], v[2:3]
    v_pk_add_f32 v[66:67], v[4:5], v[6:7]
    v_pk_add_f32 v[68:69], v[8:9], v[10:11]
    v_cmp_nle_f32 vcc, 0x17800000, v8
    s_or_b32 s41, s41, vcc_hi
    v_pk_add_f32 v[64:65], v[64:65], v[66:67]
    v_cmp_nge_f32 vcc, 0x67800000, v8
    s_or_b32 s41, s41, vcc_hi
    v_pk_add_f32 v[64:65], v[64:65], v[68:69]
    v_add_f32 v64, v64, v65
    v_cmp_class_f32 vcc, v64, v232
    s_or_b64 s[40:41], s[40:41], vcc
    s_waitcnt lgkmcnt(0)
    v_pk_add_f32 v[16:17], v[16:17], v[112:113]
    v_pk_add_f32 v[18:19], v[18:19], v[114:115]
    v_pk_add_f32 v[20:21], v[20:21], v[116:117]
    v_pk_add_f32 v[22:23], v[22:23], v[118:119]
    v_pk_add_f32 v[24:25], v[24:25], v[120:121]
    v_pk_add_f32 v[26:27], v[26:27], v[122:123]
    v_pk_add_f32 v[72:73], v[16:17], v[18:19]
    v_pk_add_f32 v[74:75], v[20:21], v[22:23]
    v_pk_add_f32 v[76:77], v[24:25], v[26:27]
    v_cmp_nle_f32 vcc, 0x17800000, v24
    s_or_b32 s41, s41, vcc_hi
    v_pk_add_f32 v[72:73], v[72:73], v[74:75]
    v_cmp_nge_f32 vcc, 0x67800000, v24
    s_or_b32 s41, s41, vcc_hi
    v_pk_add_f32 v[72:73], v[72:73], v[76:77]
    v_add_f32 v72, v72, v73
    v_cmp_class_f32 vcc, v72, v232
    s_or_b64 s[40:41], s[40:41], vcc
    s_cmp_lg_u64 s[40:41], 0
    s_cbranch_scc1 at_slow
at_fin:
    v_mov_b32 v12, v8
    v_mov_b32 v14, v8
    v_mov_b32 v28, v24
    v_mov_b32 v30, v24
    s_nop 0
    v_permlane32_swap_b32 v12, v14
    v_permlane32_swap_b32 v28, v30
    s_nop 0
    v_rcp_f32 v14, v14
    v_rcp_f32 v30, v30
    s_nop 0
    v_pk_mul_f32 v[0:1], v[0:1], v[14:15] op_sel_hi:[1,0]
    v_pk_mul_f32 v[2:3], v[2:3], v[14:15] op_sel_hi:[1,0]
    v_pk_mul_f32 v[4:5], v[4:5], v[14:15] op_sel_hi:[1,0]
    v_pk_mul_f32 v[6:7], v[6:7], v[14:15] op_sel_hi:[1,0]
    v_pk_mul_f32 v[8:9], v[8:9], v[14:15] op_sel_hi:[1,0]
    v_pk_mul_f32 v[10:11], v[10:11], v[14:15] op_sel_hi:[1,0]
    v_cvt_pk_bf16_f32 v96, v0, v1
    v_cvt_pk_bf16_f32 v97, v2, v3
    v_cvt_pk_bf16_f32 v98, v4, v5
    v_cvt_pk_bf16_f32 v99, v6, v7
    v_cvt_pk_bf16_f32 v100, v8, v9
    v_cvt_pk_bf16_f32 v101, v10, v11
    ds_write_b64 v233, v[100:101] offset:0
    v_permlane32_swap_b32 v96, v98
    v_permlane32_swap_b32 v97, v99
    buffer_store_dwordx4 v[96:99], v229, s[8:11], s33 offen sc1
    v_pk_mul_f32 v[16:17], v[16:17], v[30:31] op_sel_hi:[1,0]
    v_pk_mul_f32 v[18:19], v[18:19], v[30:31] op_sel_hi:[1,0]
    v_pk_mul_f32 v[20:21], v[20:21], v[30:31] op_sel_hi:[1,0]
    v_pk_mul_f32 v[22:23], v[22:23], v[30:31] op_sel_hi:[1,0]
    v_pk_mul_f32 v[24:25], v[24:25], v[30:31] op_sel_hi:[1,0]
    v_pk_mul_f32 v[26:27], v[26:27], v[30:31] op_sel_hi:[1,0]
    v_cvt_pk_bf16_f32 v112, v16, v17
    v_cvt_pk_bf16_f32 v113, v18, v19
    v_cvt_pk_bf16_f32 v114, v20, v21
    v_cvt_pk_bf16_f32 v115, v22, v23
    v_cvt_pk_bf16_f32 v116, v24, v25
    v_cvt_pk_bf16_f32 v117, v26, v27
    ds_write_b64 v233, v[116:117] offset:512
    v_permlane32_swap_b32 v112, v114
    v_permlane32_swap_b32 v113, v115
    buffer_store_dwordx4 v[112:115], v229, s[8:11], s34 offen sc1
    s_cmp_eq_u32 s27, 0
    s_cselect_b32 s33, s33, s34
    s_waitcnt lgkmcnt(0)
    s_barrier
    ds_read_b64 v[64:65], v234
    ds_read_b64 v[66:67], v234 offset:2048
    s_waitcnt lgkmcnt(0)
    buffer_store_dwordx4 v[64:67], v230, s[8:11], s33 offen sc1
    s_lshl_b32 s33, s26, 11
    s_lshl_b32 s34, s25, 7
    s_add_u32 s33, s33, s34
    s_add_u32 s33, s33, 17629184
    s_waitcnt vmcnt(0)
    s_barrier
    s_cmp_lg_u32 s64, 0
    s_cbranch_scc1 at_done
    v_mbcnt_lo_u32_b32 v226, -1, 0
    v_lshl_add_u32 v226, v226, 2, s33
    v_mov_b32 v227, s65
    s_mov_b32 exec_hi, 0
    buffer_store_dword v227, v226, s[8:11], 0 offen sc1
    s_mov_b64 exec, -1
    s_branch at_done
at_slow:
    s_waitcnt vmcnt(0)
    v_mov_b32 v240, 0xff800000
    v_mov_b32 v241, 0xff800000
    s_mov_b32 s30, 0
at_s1:
    buffer_load_dwordx2 v[180:181], v221, s[8:11], s30 offen sc1
    buffer_load_dwordx4 v[164:167], v220, s[8:11], s30 offen sc1
    s_waitcnt vmcnt(0)
    v_mfma_f32_32x32x4_2b_bf16 v[64:95], v[180:181], v[160:161], 0
    s_nop 15
    s_nop 3
    v_mfma_f32_32x32x16_bf16 v[64:79], v[164:167], v[144:147], v[64:79]
    v_mfma_f32_32x32x16_bf16 v[80:95], v[164:167], v[148:151], v[80:95]
    s_nop 15
    v_max3_f32 v240, v64, v65, v240
    v_max3_f32 v240, v66, v67, v240
    v_max3_f32 v240, v68, v69, v240
    v_max3_f32 v240, v70, v71, v240
    v_max3_f32 v240, v72, v73, v240
    v_max3_f32 v240, v74, v75, v240
    v_max3_f32 v240, v76, v77, v240
    v_max3_f32 v240, v78, v79, v240
    v_max3_f32 v241, v80, v81, v241
    v_max3_f32 v241, v82, v83, v241
    v_max3_f32 v241, v84, v85, v241
    v_max3_f32 v241, v86, v87, v241
    v_max3_f32 v241, v88, v89, v241
    v_max3_f32 v241, v90, v91, v241
    v_max3_f32 v241, v92, v93, v241
    v_max3_f32 v241, v94, v95, v241
    s_add_u32 s30, s30, 81920
    s_cmp_lg_u32 s30, 5242880
    s_cbranch_scc1 at_s1
    v_mov_b32 v244, v240
    v_mov_b32 v245, v240
    s_nop 1
    v_permlane32_swap_b32 v244, v245
    s_nop 1
    v_max_f32 v240, v244, v245
    v_mov_b32 v244, v241
    v_mov_b32 v245, v241
    s_nop 1
    v_permlane32_swap_b32 v244, v245
    s_nop 1
    v_max_f32 v241, v244, v245
    v_mov_b32 v0, 0
    v_mov_b32 v1, 0
    v_mov_b32 v2, 0
    v_mov_b32 v3, 0
    v_mov_b32 v4, 0
    v_mov_b32 v5, 0
    v_mov_b32 v6, 0
    v_mov_b32 v7, 0
    v_mov_b32 v8, 0
    v_mov_b32 v9, 0
    v_mov_b32 v10, 0
    v_mov_b32 v11, 0
    v_mov_b32 v12, 0
    v_mov_b32 v13, 0
    v_mov_b32 v14, 0
    v_mov_b32 v15, 0
    v_mov_b32 v16, 0
    v_mov_b32 v17, 0
    v_mov_b32 v18, 0
    v_mov_b32 v19, 0
    v_mov_b32 v20, 0
    v_mov_b32 v21, 0
    v_mov_b32 v22, 0
    v_mov_b32 v23, 0
    v_mov_b32 v24, 0
    v_mov_b32 v25, 0
    v_mov_b32 v26, 0
    v_mov_b32 v27, 0
    v_mov_b32 v28, 0
    v_mov_b32 v29, 0
    v_mov_b32 v30, 0
    v_mov_b32 v31, 0
    s_mov_b32 s30, 0
    s_mov_b32 s32, 0
at_s2:
    buffer_load_dwordx2 v[180:181], v221, s[8:11], s30 offen sc1
    buffer_load_dwordx4 v[164:167], v220, s[8:11], s30 offen sc1
    buffer_load_dwordx4 v[188:191], v222, s[8:11], s32 offen sc1
    buffer_load_dwordx4 v[192:195], v223, s[8:11], s32 offen sc1
    s_waitcnt vmcnt(0)
    v_mfma_f32_32x32x4_2b_bf16 v[64:95], v[180:181], v[160:161], 0
    s_nop 15
    s_nop 3
    v_mfma_f32_32x32x16_bf16 v[64:79], v[164:167], v[144:147], v[64:79]
    v_mfma_f32_32x32x16_bf16 v[80:95], v[164:167], v[148:151], v[80:95]
    s_nop 15
    v_sub_f32 v64, v64, v240
    v_sub_f32 v65, v65, v240
    v_sub_f32 v66, v66, v240
    v_sub_f32 v67, v67, v240
    v_sub_f32 v68, v68, v240
    v_sub_f32 v69, v69, v240
    v_sub_f32 v70, v70, v240
    v_sub_f32 v71, v71, v240
    v_sub_f32 v72, v72, v240
    v_sub_f32 v73, v73, v240
    v_sub_f32 v74, v74, v240
    v_sub_f32 v75, v75, v240
    v_sub_f32 v76, v76, v240
    v_sub_f32 v77, v77, v240
    v_sub_f32 v78, v78, v240
    v_sub_f32 v79, v79, v240
    v_exp_f32 v64, v64
    v_exp_f32 v65, v65
    v_exp_f32 v66, v66
    v_exp_f32 v67, v67
    v_exp_f32 v68, v68
    v_exp_f32 v69, v69
    v_exp_f32 v70, v70
    v_exp_f32 v71, v71
    v_exp_f32 v72, v72
    v_exp_f32 v73, v73
    v_exp_f32 v74, v74
    v_exp_f32 v75, v75
    v_exp_f32 v76, v76
    v_exp_f32 v77, v77
    v_exp_f32 v78, v78
    v_exp_f32 v79, v79
    s_nop 0
    v_cvt_pk_bf16_f32 v128, v64, v65
    v_cvt_pk_bf16_f32 v129, v66, v67
    v_cvt_pk_bf16_f32 v130, v68, v69
    v_cvt_pk_bf16_f32 v131, v70, v71
    v_cvt_pk_bf16_f32 v132, v72, v73
    v_cvt_pk_bf16_f32 v133, v74, v75
    v_cvt_pk_bf16_f32 v134, v76, v77
    v_cvt_pk_bf16_f32 v135, v78, v79
    s_nop 1
    v_mfma_f32_32x32x16_bf16 v[0:15], v[188:191], v[128:131], v[0:15]
    v_mfma_f32_32x32x16_bf16 v[0:15], v[192:195], v[132:135], v[0:15]
    v_sub_f32 v80, v80, v241
    v_sub_f32 v81, v81, v241
    v_sub_f32 v82, v82, v241
    v_sub_f32 v83, v83, v241
    v_sub_f32 v84, v84, v241
    v_sub_f32 v85, v85, v241
    v_sub_f32 v86, v86, v241
    v_sub_f32 v87, v87, v241
    v_sub_f32 v88, v88, v241
    v_sub_f32 v89, v89, v241
    v_sub_f32 v90, v90, v241
    v_sub_f32 v91, v91, v241
    v_sub_f32 v92, v92, v241
    v_sub_f32 v93, v93, v241
    v_sub_f32 v94, v94, v241
    v_sub_f32 v95, v95, v241
    v_exp_f32 v80, v80
    v_exp_f32 v81, v81
    v_exp_f32 v82, v82
    v_exp_f32 v83, v83
    v_exp_f32 v84, v84
    v_exp_f32 v85, v85
    v_exp_f32 v86, v86
    v_exp_f32 v87, v87
    v_exp_f32 v88, v88
    v_exp_f32 v89, v89
    v_exp_f32 v90, v90
    v_exp_f32 v91, v91
    v_exp_f32 v92, v92
    v_exp_f32 v93, v93
    v_exp_f32 v94, v94
    v_exp_f32 v95, v95
    s_nop 0
    v_cvt_pk_bf16_f32 v128, v80, v81
    v_cvt_pk_bf16_f32 v129, v82, v83
    v_cvt_pk_bf16_f32 v130, v84, v85
    v_cvt_pk_bf16_f32 v131, v86, v87
    v_cvt_pk_bf16_f32 v132, v88, v89
    v_cvt_pk_bf16_f32 v133, v90, v91
    v_cvt_pk_bf16_f32 v134, v92, v93
    v_cvt_pk_bf16_f32 v135, v94, v95
    s_nop 1
    v_mfma_f32_32x32x16_bf16 v[16:31], v[188:191], v[128:131], v[16:31]
    v_mfma_f32_32x32x16_bf16 v[16:31], v[192:195], v[132:135], v[16:31]
    s_add_u32 s30, s30, 81920
    s_add_u32 s32, s32, 41472
    s_cmp_lg_u32 s30, 5242880
    s_cbranch_scc1 at_s2
    s_nop 15
    s_branch at_fin
at_done:
    s_endpgm
L_a:
    s_sub_u32 s66, s2, 256
    s_lshr_b32 s68, s66, 3
    s_setprio 3
    s_sub_u32 s60, s68, 20
    s_load_dwordx2 s[44:45], s[0:1], 104
    s_waitcnt lgkmcnt(0)
    s_mov_b32 s20, s44
    s_mov_b32 s21, s45
    s_mov_b32 s22, 256
    s_mov_b32 s23, 0x00020000
    v_mov_b32 v30, 0
    s_mov_b32 s67, 20000
an_nonce:
    buffer_load_dword v31, v30, s[20:23], 0 offen sc1
    s_waitcnt vmcnt(0)
    v_readfirstlane_b32 s65, v31
    s_nop 3
    s_cmp_lg_u32 s65, 0
    s_cbranch_scc1 an_nonce_ok
    s_sleep 2
    s_sub_u32 s67, s67, 1
    s_cmp_lg_u32 s67, 0
    s_cbranch_scc1 an_nonce
an_nonce_ok:
    s_getreg_b32 s69, hwreg(HW_REG_XCC_ID, 0, 3)
    s_or_b32 s69, s69, s65
    s_cmp_lt_u32 s68, 20
    s_cbranch_scc1 L_a_g1
    s_sub_u32 s61, s68, 20
    s_lshl_b32 s61, s61, 3
    s_and_b32 s4, s66, 7
    s_add_u32 s61, s61, s4
    s_lshl_b32 s61, s61, 2
    s_add_u32 s61, s61, s64
    s_load_dwordx2 s[40:41], s[0:1], 112
    v_mbcnt_lo_u32_b32 v31, -1, 0
    v_mbcnt_hi_u32_b32 v31, -1, v31
    s_waitcnt lgkmcnt(0)
    s_mov_b32 s8, s40
    s_mov_b32 s9, s41
    s_mov_b32 s10, 18022400
    s_mov_b32 s11, 0x00020000
    s_cmp_lg_u32 s64, 0
    s_cbranch_scc1 L_a_w
    s_getreg_b32 s4, hwreg(HW_REG_HW_ID, 8, 8)
    s_and_b32 s4, s4, 127
    s_getreg_b32 s67, hwreg(HW_REG_XCC_ID, 0, 3)
    s_lshl_b32 s67, s67, 7
    s_add_u32 s4, s4, s67
    s_lshl_b32 s4, s4, 6
    s_add_u32 s4, s4, 17727488
    s_add_u32 s4, s4, 32
    v_mov_b32 v32, s4
    s_mov_b32 s67, 600
aw_poll:
    buffer_load_dword v33, v32, s[8:11], 0 offen sc1
    s_waitcnt vmcnt(0)
    v_cmp_ne_u32 vcc, s65, v33
    s_nop 4
    s_cbranch_vccz aw_ok
    s_sleep 8
    s_sub_u32 s67, s67, 1
    s_cmp_lg_u32 s67, 0
    s_cbranch_scc1 aw_poll
aw_ok:
L_a_w:
    s_barrier
    s_cmp_lt_u32 s68, 30
    s_cbranch_scc1 L_a_pc
    s_cmp_ge_u32 s64, 2
    s_cbranch_scc1 L_a_np
    s_sub_u32 s39, s68, 30
    s_lshl_b32 s39, s39, 1
    s_add_u32 s39, s39, s64
    s_load_dwordx2 s[40:41], s[0:1], 88
    v_mbcnt_lo_u32_b32 v32, -1, 0
    v_mbcnt_hi_u32_b32 v32, -1, v32
    s_lshl_b32 s50, s39, 6
    v_add_u32 v32, s50, v32
    v_lshlrev_b32 v32, 7, v32
    s_waitcnt lgkmcnt(0)
    v_add_u32 v33, 0, v32
    v_min_u32 v33, 819072, v33
    global_load_dword v34, v33, s[40:41]
    s_waitcnt vmcnt(0)
    v_add_u32 v33, 32768, v32
    v_min_u32 v33, 819072, v33
    global_load_dword v34, v33, s[40:41]
    s_waitcnt vmcnt(0)
    v_add_u32 v33, 65536, v32
    v_min_u32 v33, 819072, v33
    global_load_dword v34, v33, s[40:41]
    s_waitcnt vmcnt(0)
    v_add_u32 v33, 98304, v32
    v_min_u32 v33, 819072, v33
    global_load_dword v34, v33, s[40:41]
    s_waitcnt vmcnt(0)
    v_add_u32 v33, 131072, v32
    v_min_u32 v33, 819072, v33
    global_load_dword v34, v33, s[40:41]
    s_waitcnt vmcnt(0)
    v_add_u32 v33, 163840, v32
    v_min_u32 v33, 819072, v33
    global_load_dword v34, v33, s[40:41]
    s_waitcnt vmcnt(0)
    v_add_u32 v33, 196608, v32
    v_min_u32 v33, 819072, v33
    global_load_dword v34, v33, s[40:41]
    s_waitcnt vmcnt(0)
    v_add_u32 v33, 229376, v32
    v_min_u32 v33, 819072, v33
    global_load_dword v34, v33, s[40:41]
    s_waitcnt vmcnt(0)
    v_add_u32 v33, 262144, v32
    v_min_u32 v33, 819072, v33
    global_load_dword v34, v33, s[40:41]
    s_waitcnt vmcnt(0)
    v_add_u32 v33, 294912, v32
    v_min_u32 v33, 819072, v33
    global_load_dword v34, v33, s[40:41]
    s_waitcnt vmcnt(0)
    v_add_u32 v33, 327680, v32
    v_min_u32 v33, 819072, v33
    global_load_dword v34, v33, s[40:41]
    s_waitcnt vmcnt(0)
    v_add_u32 v33, 360448, v32
    v_min_u32 v33, 819072, v33
    global_load_dword v34, v33, s[40:41]
    s_waitcnt vmcnt(0)
    v_add_u32 v33, 393216, v32
    v_min_u32 v33, 819072, v33
    global_load_dword v34, v33, s[40:41]
    s_waitcnt vmcnt(0)
    v_add_u32 v33, 425984, v32
    v_min_u32 v33, 819072, v33
    global_load_dword v34, v33, s[40:41]
    s_waitcnt vmcnt(0)
    v_add_u32 v33, 458752, v32
    v_min_u32 v33, 819072, v33
    global_load_dword v34, v33, s[40:41]
    s_waitcnt vmcnt(0)
    v_add_u32 v33, 491520, v32
    v_min_u32 v33, 819072, v33
    global_load_dword v34, v33, s[40:41]
    s_waitcnt vmcnt(0)
    v_add_u32 v33, 524288, v32
    v_min_u32 v33, 819072, v33
    global_load_dword v34, v33, s[40:41]
    s_waitcnt vmcnt(0)
    v_add_u32 v33, 557056, v32
    v_min_u32 v33, 819072, v33
    global_load_dword v34, v33, s[40:41]
    s_waitcnt vmcnt(0)
    v_add_u32 v33, 589824, v32
    v_min_u32 v33, 819072, v33
    global_load_dword v34, v33, s[40:41]
    s_waitcnt vmcnt(0)
    v_add_u32 v33, 622592, v32
    v_min_u32 v33, 819072, v33
    global_load_dword v34, v33, s[40:41]
    s_waitcnt vmcnt(0)
    v_add_u32 v33, 655360, v32
    v_min_u32 v33, 819072, v33
    global_load_dword v34, v33, s[40:41]
    s_waitcnt vmcnt(0)
    v_add_u32 v33, 688128, v32
    v_min_u32 v33, 819072, v33
    global_load_dword v34, v33, s[40:41]
    s_waitcnt vmcnt(0)
    v_add_u32 v33, 720896, v32
    v_min_u32 v33, 819072, v33
    global_load_dword v34, v33, s[40:41]
    s_waitcnt vmcnt(0)
    v_add_u32 v33, 753664, v32
    v_min_u32 v33, 819072, v33
    global_load_dword v34, v33, s[40:41]
    s_waitcnt vmcnt(0)
    v_add_u32 v33, 786432, v32
    v_min_u32 v33, 819072, v33
    global_load_dword v34, v33, s[40:41]
    s_waitcnt vmcnt(0)
    s_branch L_a_np
L_a_pc:
    s_cmp_ge_u32 s64, 2
    s_cbranch_scc1 L_a_np
    s_sub_u32 s39, s68, 20
    s_mul_i32 s39, s39, 2
    s_add_u32 s39, s39, s64
    s_load_dwordx2 s[40:41], s[0:1], 40
    s_load_dwordx2 s[42:43], s[0:1], 48
    v_mbcnt_lo_u32_b32 v32, -1, 0
    v_mbcnt_hi_u32_b32 v32, -1, v32
    s_lshl_b32 s50, s39, 6
    v_add_u32 v32, s50, v32
    v_lshlrev_b32 v32, 7, v32
    s_waitcnt lgkmcnt(0)
    v_add_u32 v33, 0, v32
    v_min_u32 v33, 819072, v33
    global_load_dword v34, v33, s[40:41]
    s_waitcnt vmcnt(0)
    v_add_u32 v33, 163840, v32
    v_min_u32 v33, 819072, v33
    global_load_dword v34, v33, s[40:41]
    s_waitcnt vmcnt(0)
    v_add_u32 v33, 327680, v32
    v_min_u32 v33, 819072, v33
    global_load_dword v34, v33, s[40:41]
    s_waitcnt vmcnt(0)
    v_add_u32 v33, 491520, v32
    v_min_u32 v33, 819072, v33
    global_load_dword v34, v33, s[40:41]
    s_waitcnt vmcnt(0)
    v_add_u32 v33, 655360, v32
    v_min_u32 v33, 819072, v33
    global_load_dword v34, v33, s[40:41]
    s_waitcnt vmcnt(0)
    v_add_u32 v33, 0, v32
    v_min_u32 v33, 819072, v33
    global_load_dword v34, v33, s[42:43]
    s_waitcnt vmcnt(0)
    v_add_u32 v33, 163840, v32
    v_min_u32 v33, 819072, v33
    global_load_dword v34, v33, s[42:43]
    s_waitcnt vmcnt(0)
    v_add_u32 v33, 327680, v32
    v_min_u32 v33, 819072, v33
    global_load_dword v34, v33, s[42:43]
    s_waitcnt vmcnt(0)
    v_add_u32 v33, 491520, v32
    v_min_u32 v33, 819072, v33
    global_load_dword v34, v33, s[42:43]
    s_waitcnt vmcnt(0)
    v_add_u32 v33, 655360, v32
    v_min_u32 v33, 819072, v33
    global_load_dword v34, v33, s[42:43]
    s_waitcnt vmcnt(0)
L_a_np:
    s_branch L_a_g2
L_a_g1:
    s_load_dwordx2 s[40:41], s[0:1], 0
    s_load_dwordx4 s[44:47], s[0:1], 24
    s_load_dwordx4 s[48:51], s[0:1], 8
    s_load_dwordx2 s[52:53], s[0:1], 56
    s_load_dwordx2 s[62:63], s[0:1], 112
    v_mbcnt_lo_u32_b32 v26, -1, 0
    v_mbcnt_hi_u32_b32 v26, -1, v26
    s_lshr_b32 s36, s64, 1
    s_and_b32 s37, s64, 1
    s_and_b32 s34, s68, 3
    s_lshr_b32 s27, s68, 2
    s_bfe_u32 s25, s66, 0x20001
    s_lshl_b32 s25, s25, 2
    s_add_u32 s25, s25, s34
    s_and_b32 s26, s66, 1
    s_mul_i32 s26, s26, 5
    s_add_u32 s26, s26, s27
    s_mul_i32 s35, s34, 5
    s_add_u32 s35, s35, 1
    s_lshr_b32 s35, s35, 1
    s_lshl_b32 s27, s27, 1
    s_add_u32 s35, s35, s27
    s_cmp_ge_u32 s35, 10
    s_cselect_b32 s34, 10, 0
    s_sub_u32 s35, s35, s34
    s_lshl_b32 s35, s35, 7
    s_mul_i32 s28, s25, 163840
    s_add_u32 s29, s28, 1280
    s_add_u32 s27, s28, s35
    s_mul_i32 s31, s26, 81920
    s_add_u32 s32, s31, 1280
    s_add_u32 s30, s31, s35
    s_lshl_b32 s33, s64, 12
    s_mul_i32 s34, s64, 40960
    v_lshrrev_b32 v192, 3, v26
    v_mul_u32_u24 v192, 1280, v192
    v_add_u32 v192, s34, v192
    v_lshrrev_b32 v193, 4, v26
    v_xor_b32 v193, v193, v26
    v_and_b32 v193, 7, v193
    v_lshlrev_b32 v193, 4, v193
    v_add_u32 v1, v192, v193
    v_xor_b32 v2, 64, v193
    v_add_u32 v2, v192, v2
    v_add_u32 v2, 9216, v2
    v_add_u32 v3, v192, v193
    v_add_u32 v3, 18432, v3
    v_xor_b32 v4, 64, v193
    v_add_u32 v4, v192, v4
    v_add_u32 v4, 27648, v4
    s_mul_i32 s34, s37, 40960
    v_lshrrev_b32 v192, 3, v26
    v_mul_u32_u24 v192, 1280, v192
    v_add_u32 v192, s34, v192
    v_lshrrev_b32 v193, 4, v26
    v_xor_b32 v193, v193, v26
    v_and_b32 v193, 7, v193
    v_lshlrev_b32 v193, 4, v193
    v_add_u32 v5, v192, v193
    v_xor_b32 v6, 64, v193
    v_add_u32 v6, v192, v6
    v_add_u32 v6, 9216, v6
    v_add_u32 v7, v192, v193
    v_add_u32 v7, 18432, v7
    v_xor_b32 v8, 64, v193
    v_add_u32 v8, v192, v8
    v_add_u32 v8, 27648, v8
    v_and_b32 v192, 31, v26
    s_lshl_b32 s34, s26, 6
    s_lshl_b32 s35, s37, 5
    s_add_u32 s34, s34, s35
    v_add_u32 v27, s34, v192
    v_lshlrev_b32 v193, 1, v27
    s_waitcnt lgkmcnt(0)
    v_mov_b32 v203, v193
    global_load_ushort v200, v203, s[48:49]
    global_load_ushort v201, v203, s[50:51]
    global_load_ushort v202, v203, s[52:53]
    s_mov_b32 s8, s40
    s_mov_b32 s9, s41
    s_mov_b32 s10, 2621440
    s_mov_b32 s11, 0x00020000
    s_cmp_eq_u32 s36, 0
    s_cselect_b32 s42, s44, s46
    s_cselect_b32 s43, s45, s47
    s_mov_b32 s12, s42
    s_mov_b32 s13, s43
    s_mov_b32 s14, 819200
    s_mov_b32 s15, 0x00020000
    s_mov_b32 s16, s62
    s_mov_b32 s17, s63
    s_mov_b32 s18, 18022400
    s_mov_b32 s19, 0x00020000
    v_bfe_u32 v193, v26, 2, 1
    v_lshlrev_b32 v193, 4, v193
    v_and_b32 v194, 1, v26
    v_lshl_add_u32 v193, v194, 3, v193
    v_bfe_u32 v194, v26, 3, 2
    v_lshl_add_u32 v193, v194, 1, v193
    v_bfe_u32 v194, v26, 1, 1
    v_add_u32 v193, v193, v194
    s_lshl_b32 s34, s36, 6
    v_add_u32 v193, s34, v193
    v_lshrrev_b32 v194, 5, v26
    v_lshrrev_b32 v195, 1, v193
    v_xor_b32 v195, v195, v194
    v_and_b32 v195, 7, v195
    v_lshlrev_b32 v195, 4, v195
    v_lshl_add_u32 v10, v193, 7, v195
    v_xor_b32 v11, 32, v10
    v_xor_b32 v12, 64, v10
    v_xor_b32 v13, 96, v10
    v_add_u32 v14, 65536, v10
    v_add_u32 v15, 65536, v11
    v_add_u32 v16, 65536, v12
    v_add_u32 v17, 65536, v13
    v_add_u32 v193, s35, v192
    v_lshrrev_b32 v195, 1, v193
    v_xor_b32 v195, v195, v194
    v_and_b32 v195, 7, v195
    v_lshlrev_b32 v195, 4, v195
    v_lshl_add_u32 v18, v193, 7, v195
    v_xor_b32 v19, 32, v18
    v_xor_b32 v20, 64, v18
    v_xor_b32 v21, 96, v18
    v_add_u32 v22, 65536, v18
    v_add_u32 v23, 65536, v19
    v_add_u32 v24, 65536, v20
    v_add_u32 v25, 65536, v21
    s_waitcnt vmcnt(0)
    v_lshlrev_b32 v200, 16, v200
    v_lshlrev_b32 v201, 16, v201
    v_lshlrev_b32 v192, 16, v202
    v_mul_f32 v192, 0x3fb8aa3b, v192
    v_exp_f32 v192, v192
    s_nop 0
    v_cvt_pk_bf16_f32 v192, v192, v192
    v_lshlrev_b32 v192, 16, v192
    v_mul_f32 v193, v192, v200
    v_mul_f32 v194, v192, v201
    v_mul_f32 v193, 0x3fb8aa3b, v193
    v_mul_f32 v194, 0.15915494, v194
    v_exp_f32 v193, v193
    v_fract_f32 v194, v194
    v_cos_f32 v195, v194
    v_sin_f32 v196, v194
    s_nop 0
    v_mul_f32 v28, v193, v195
    v_mul_f32 v29, v193, v196
    v_mul_f32 v192, v200, v200
    v_fma_f32 v192, v201, v201, v192
    v_rcp_f32 v192, v192
    v_add_f32 v193, -1.0, v28
    v_mul_f32 v194, v193, v200
    v_fma_f32 v194, v29, v201, v194
    v_mul_f32 v195, v193, v201
    v_fma_f32 v195, v29, v200, -v195
    v_add_f32 v192, v192, v192
    v_mul_f32 v44, v194, v192
    v_mul_f32 v45, v195, v192
    v_mul_f32 v192, v29, v29
    v_fma_f32 v192, v28, v28, -v192
    v_mul_f32 v193, v28, v29
    v_fma_f32 v31, v29, v28, v193
    v_mov_b32 v30, v192
    v_mul_f32 v192, v31, v29
    v_fma_f32 v192, v30, v28, -v192
    v_mul_f32 v193, v30, v29
    v_fma_f32 v33, v31, v28, v193
    v_mov_b32 v32, v192
    v_mul_f32 v192, v31, v31
    v_fma_f32 v192, v30, v30, -v192
    v_mul_f32 v193, v30, v31
    v_fma_f32 v35, v31, v30, v193
    v_mov_b32 v34, v192
    v_mul_f32 v192, v35, v29
    v_fma_f32 v192, v34, v28, -v192
    v_mul_f32 v193, v34, v29
    v_fma_f32 v37, v35, v28, v193
    v_mov_b32 v36, v192
    v_mul_f32 v192, v33, v33
    v_fma_f32 v192, v32, v32, -v192
    v_mul_f32 v193, v32, v33
    v_fma_f32 v39, v33, v32, v193
    v_mov_b32 v38, v192
    v_mul_f32 v192, v39, v29
    v_fma_f32 v192, v38, v28, -v192
    v_mul_f32 v193, v38, v29
    v_fma_f32 v41, v39, v28, v193
    v_mov_b32 v40, v192
    v_mul_f32 v192, v35, v35
    v_fma_f32 v192, v34, v34, -v192
    v_mul_f32 v193, v34, v35
    v_fma_f32 v43, v35, v34, v193
    v_mov_b32 v42, v192
    v_mul_f32 v192, v43, v43
    v_fma_f32 v192, v42, v42, -v192
    v_mul_f32 v193, v42, v43
    v_fma_f32 v47, v43, v42, v193
    v_mov_b32 v46, v192
    v_mul_f32 v192, v47, v47
    v_fma_f32 v192, v46, v46, -v192
    v_mul_f32 v193, v46, v47
    v_fma_f32 v49, v47, v46, v193
    v_mov_b32 v48, v192
    v_mul_f32 v192, v49, v49
    v_fma_f32 v192, v48, v48, -v192
    v_mul_f32 v193, v48, v49
    v_fma_f32 v51, v49, v48, v193
    v_mov_b32 v50, v192
    v_mul_f32 v192, v51, v51
    v_fma_f32 v192, v50, v50, -v192
    v_mul_f32 v193, v50, v51
    v_fma_f32 v53, v51, v50, v193
    v_mov_b32 v52, v192
    s_cmp_lg_u32 s64, 0
    s_cbranch_scc1 L_trig
    s_getreg_b32 s4, hwreg(HW_REG_HW_ID, 8, 8)
    s_and_b32 s4, s4, 127
    s_getreg_b32 s67, hwreg(HW_REG_XCC_ID, 0, 3)
    s_lshl_b32 s67, s67, 7
    s_add_u32 s4, s4, s67
    s_lshl_b32 s4, s4, 6
    s_add_u32 s4, s4, 17727488
    v_mov_b32 v192, s4
    s_mov_b32 s67, 600
tw_poll:
    buffer_load_dword v193, v192, s[16:19], 0 offen sc1
    s_waitcnt vmcnt(0)
    v_cmp_ne_u32 vcc, s65, v193
    s_nop 4
    s_cbranch_vccz tw_ok
    s_sleep 2
    s_sub_u32 s67, s67, 1
    s_cmp_lg_u32 s67, 0
    s_cbranch_scc1 tw_poll
tw_ok:
L_trig:
    s_barrier
    s_setprio 0
    s_add_u32 m0, s33, 0
    s_nop 0
    buffer_load_dwordx4 v1, s[8:11], s27 offen offset:0  lds
    buffer_load_dwordx4 v2, s[8:11], s27 offen offset:1024  lds
    buffer_load_dwordx4 v3, s[8:11], s27 offen offset:2048  lds
    buffer_load_dwordx4 v4, s[8:11], s27 offen offset:3072  lds
    s_add_u32 s27, s27, 128
    s_cmp_eq_u32 s27, s29
    s_cselect_b32 s27, s28, s27
    s_add_u32 m0, s33, 16384
    s_nop 0
    buffer_load_dwordx4 v5, s[12:15], s30 offen offset:0  lds
    buffer_load_dwordx4 v6, s[12:15], s30 offen offset:1024  lds
    buffer_load_dwordx4 v7, s[12:15], s30 offen offset:2048  lds
    buffer_load_dwordx4 v8, s[12:15], s30 offen offset:3072  lds
    s_add_u32 s30, s30, 128
    s_cmp_eq_u32 s30, s32
    s_cselect_b32 s30, s31, s30
    s_add_u32 m0, s33, 32768
    s_nop 0
    buffer_load_dwordx4 v1, s[8:11], s27 offen offset:0  lds
    buffer_load_dwordx4 v2, s[8:11], s27 offen offset:1024  lds
    buffer_load_dwordx4 v3, s[8:11], s27 offen offset:2048  lds
    buffer_load_dwordx4 v4, s[8:11], s27 offen offset:3072  lds
    s_add_u32 s27, s27, 128
    s_cmp_eq_u32 s27, s29
    s_cselect_b32 s27, s28, s27
    s_waitcnt vmcnt(8)
    s_barrier
    ds_read_b128 v[128:131], v10 offset:0
    ds_read_b128 v[132:135], v10 offset:4096
    ds_read_b128 v[136:139], v11 offset:0
    ds_read_b128 v[140:143], v11 offset:4096
    ds_read_b128 v[144:147], v12 offset:0
    ds_read_b128 v[148:151], v12 offset:4096
    ds_read_b128 v[152:155], v13 offset:0
    ds_read_b128 v[156:159], v13 offset:4096
    s_waitcnt vmcnt(4) lgkmcnt(0)
    s_barrier
    ds_read_b128 v[160:163], v18 offset:16384
    ds_read_b128 v[164:167], v18 offset:24576
    ds_read_b128 v[168:171], v19 offset:16384
    ds_read_b128 v[172:175], v19 offset:24576
    ds_read_b128 v[176:179], v20 offset:16384
    ds_read_b128 v[180:183], v20 offset:24576
    ds_read_b128 v[184:187], v21 offset:16384
    ds_read_b128 v[188:191], v21 offset:24576
    s_add_u32 m0, s33, 49152
    s_nop 0
    buffer_load_dwordx4 v5, s[12:15], s30 offen offset:0  lds
    buffer_load_dwordx4 v6, s[12:15], s30 offen offset:1024  lds
    buffer_load_dwordx4 v7, s[12:15], s30 offen offset:2048  lds
    buffer_load_dwordx4 v8, s[12:15], s30 offen offset:3072  lds
    s_add_u32 s30, s30, 128
    s_cmp_eq_u32 s30, s32
    s_cselect_b32 s30, s31, s30
    s_waitcnt vmcnt(4) lgkmcnt(0)
    s_barrier
    v_mfma_f32_32x32x16_bf16 v[64:79], v[128:131], v[160:163], 0
    s_add_u32 m0, s33, 65536
    s_nop 0
    ds_read_b128 v[192:195], v10 offset:32768
    ds_read_b128 v[196:199], v10 offset:36864
    buffer_load_dwordx4 v1, s[8:11], s27 offen offset:0  lds
    v_mfma_f32_32x32x16_bf16 v[80:95], v[128:131], v[164:167], 0
    ds_read_b128 v[200:203], v11 offset:32768
    ds_read_b128 v[204:207], v11 offset:36864
    buffer_load_dwordx4 v2, s[8:11], s27 offen offset:1024  lds
    v_mfma_f32_32x32x16_bf16 v[96:111], v[132:135], v[160:163], 0
    ds_read_b128 v[208:211], v12 offset:32768
    ds_read_b128 v[212:215], v12 offset:36864
    buffer_load_dwordx4 v3, s[8:11], s27 offen offset:2048  lds
    v_mfma_f32_32x32x16_bf16 v[112:127], v[132:135], v[164:167], 0
    ds_read_b128 v[216:219], v13 offset:32768
    ds_read_b128 v[220:223], v13 offset:36864
    buffer_load_dwordx4 v4, s[8:11], s27 offen offset:3072  lds
    s_add_u32 s27, s27, 128
    s_cmp_eq_u32 s27, s29
    s_cselect_b32 s27, s28, s27
    v_mfma_f32_32x32x16_bf16 v[64:79], v[136:139], v[168:171], v[64:79]
    v_mfma_f32_32x32x16_bf16 v[80:95], v[136:139], v[172:175], v[80:95]
    v_mfma_f32_32x32x16_bf16 v[96:111], v[140:143], v[168:171], v[96:111]
    v_mfma_f32_32x32x16_bf16 v[112:127], v[140:143], v[172:175], v[112:127]
    s_waitcnt vmcnt(4) lgkmcnt(0)
    s_barrier
    v_mfma_f32_32x32x16_bf16 v[64:79], v[144:147], v[176:179], v[64:79]
    s_add_u32 m0, s33, 0
    s_nop 0
    ds_read_b128 v[224:227], v18 offset:49152
    ds_read_b128 v[228:231], v18 offset:57344
    buffer_load_dwordx4 v5, s[12:15], s30 offen offset:0  lds
    v_mfma_f32_32x32x16_bf16 v[80:95], v[144:147], v[180:183], v[80:95]
    ds_read_b128 v[232:235], v19 offset:49152
    ds_read_b128 v[236:239], v19 offset:57344
    buffer_load_dwordx4 v6, s[12:15], s30 offen offset:1024  lds
    v_mfma_f32_32x32x16_bf16 v[96:111], v[148:151], v[176:179], v[96:111]
    ds_read_b128 v[240:243], v20 offset:49152
    ds_read_b128 v[244:247], v20 offset:57344
    buffer_load_dwordx4 v7, s[12:15], s30 offen offset:2048  lds
    v_mfma_f32_32x32x16_bf16 v[112:127], v[148:151], v[180:183], v[112:127]
    ds_read_b128 v[248:251], v21 offset:49152
    ds_read_b128 v[252:255], v21 offset:57344
    buffer_load_dwordx4 v8, s[12:15], s30 offen offset:3072  lds
    s_add_u32 s30, s30, 128
    s_cmp_eq_u32 s30, s32
    s_cselect_b32 s30, s31, s30
    v_mfma_f32_32x32x16_bf16 v[64:79], v[152:155], v[184:187], v[64:79]
    v_mfma_f32_32x32x16_bf16 v[80:95], v[152:155], v[188:191], v[80:95]
    v_mfma_f32_32x32x16_bf16 v[96:111], v[156:159], v[184:187], v[96:111]
    v_mfma_f32_32x32x16_bf16 v[112:127], v[156:159], v[188:191], v[112:127]
    s_waitcnt vmcnt(4) lgkmcnt(0)
    s_barrier
    v_mfma_f32_32x32x16_bf16 v[64:79], v[192:195], v[224:227], v[64:79]
    s_add_u32 m0, s33, 16384
    s_nop 0
    ds_read_b128 v[128:131], v14 offset:0
    ds_read_b128 v[132:135], v14 offset:4096
    buffer_load_dwordx4 v1, s[8:11], s27 offen offset:0  lds
    v_mfma_f32_32x32x16_bf16 v[80:95], v[192:195], v[228:231], v[80:95]
    ds_read_b128 v[136:139], v15 offset:0
    ds_read_b128 v[140:143], v15 offset:4096
    buffer_load_dwordx4 v2, s[8:11], s27 offen offset:1024  lds
    v_mfma_f32_32x32x16_bf16 v[96:111], v[196:199], v[224:227], v[96:111]
    ds_read_b128 v[144:147], v16 offset:0
    ds_read_b128 v[148:151], v16 offset:4096
    buffer_load_dwordx4 v3, s[8:11], s27 offen offset:2048  lds
    v_mfma_f32_32x32x16_bf16 v[112:127], v[196:199], v[228:231], v[112:127]
    ds_read_b128 v[152:155], v17 offset:0
    ds_read_b128 v[156:159], v17 offset:4096
    buffer_load_dwordx4 v4, s[8:11], s27 offen offset:3072  lds
    s_add_u32 s27, s27, 128
    s_cmp_eq_u32 s27, s29
    s_cselect_b32 s27, s28, s27
    v_mfma_f32_32x32x16_bf16 v[64:79], v[200:203], v[232:235], v[64:79]
    v_mfma_f32_32x32x16_bf16 v[80:95], v[200:203], v[236:239], v[80:95]
    v_mfma_f32_32x32x16_bf16 v[96:111], v[204:207], v[232:235], v[96:111]
    v_mfma_f32_32x32x16_bf16 v[112:127], v[204:207], v[236:239], v[112:127]
    s_waitcnt vmcnt(4) lgkmcnt(0)
    s_barrier
    v_mfma_f32_32x32x16_bf16 v[64:79], v[208:211], v[240:243], v[64:79]
    s_add_u32 m0, s33, 32768
    s_nop 0
    ds_read_b128 v[160:163], v18 offset:0
    ds_read_b128 v[164:167], v18 offset:8192
    buffer_load_dwordx4 v5, s[12:15], s30 offen offset:0  lds
    v_mfma_f32_32x32x16_bf16 v[80:95], v[208:211], v[244:247], v[80:95]
    ds_read_b128 v[168:171], v19 offset:0
    ds_read_b128 v[172:175], v19 offset:8192
    buffer_load_dwordx4 v6, s[12:15], s30 offen offset:1024  lds
    v_mfma_f32_32x32x16_bf16 v[96:111], v[212:215], v[240:243], v[96:111]
    ds_read_b128 v[176:179], v20 offset:0
    ds_read_b128 v[180:183], v20 offset:8192
    buffer_load_dwordx4 v7, s[12:15], s30 offen offset:2048  lds
    v_mfma_f32_32x32x16_bf16 v[112:127], v[212:215], v[244:247], v[112:127]
    ds_read_b128 v[184:187], v21 offset:0
    ds_read_b128 v[188:191], v21 offset:8192
    buffer_load_dwordx4 v8, s[12:15], s30 offen offset:3072  lds
    s_add_u32 s30, s30, 128
    s_cmp_eq_u32 s30, s32
    s_cselect_b32 s30, s31, s30
    v_mfma_f32_32x32x16_bf16 v[64:79], v[216:219], v[248:251], v[64:79]
    v_mfma_f32_32x32x16_bf16 v[80:95], v[216:219], v[252:255], v[80:95]
    v_mfma_f32_32x32x16_bf16 v[96:111], v[220:223], v[248:251], v[96:111]
    v_mfma_f32_32x32x16_bf16 v[112:127], v[220:223], v[252:255], v[112:127]
    s_waitcnt vmcnt(4) lgkmcnt(0)
    s_barrier
    v_mfma_f32_32x32x16_bf16 v[64:79], v[128:131], v[160:163], v[64:79]
    s_add_u32 m0, s33, 49152
    s_nop 0
    ds_read_b128 v[192:195], v10 offset:16384
    ds_read_b128 v[196:199], v10 offset:20480
    buffer_load_dwordx4 v1, s[8:11], s27 offen offset:0  lds
    v_mfma_f32_32x32x16_bf16 v[80:95], v[128:131], v[164:167], v[80:95]
    ds_read_b128 v[200:203], v11 offset:16384
    ds_read_b128 v[204:207], v11 offset:20480
    buffer_load_dwordx4 v2, s[8:11], s27 offen offset:1024  lds
    v_mfma_f32_32x32x16_bf16 v[96:111], v[132:135], v[160:163], v[96:111]
    ds_read_b128 v[208:211], v12 offset:16384
    ds_read_b128 v[212:215], v12 offset:20480
    buffer_load_dwordx4 v3, s[8:11], s27 offen offset:2048  lds
    v_mfma_f32_32x32x16_bf16 v[112:127], v[132:135], v[164:167], v[112:127]
    ds_read_b128 v[216:219], v13 offset:16384
    ds_read_b128 v[220:223], v13 offset:20480
    buffer_load_dwordx4 v4, s[8:11], s27 offen offset:3072  lds
    s_add_u32 s27, s27, 128
    s_cmp_eq_u32 s27, s29
    s_cselect_b32 s27, s28, s27
    v_mfma_f32_32x32x16_bf16 v[64:79], v[136:139], v[168:171], v[64:79]
    v_mfma_f32_32x32x16_bf16 v[80:95], v[136:139], v[172:175], v[80:95]
    v_mfma_f32_32x32x16_bf16 v[96:111], v[140:143], v[168:171], v[96:111]
    v_mfma_f32_32x32x16_bf16 v[112:127], v[140:143], v[172:175], v[112:127]
    s_waitcnt vmcnt(4) lgkmcnt(0)
    s_barrier
    v_mfma_f32_32x32x16_bf16 v[64:79], v[144:147], v[176:179], v[64:79]
    s_add_u32 m0, s33, 65536
    s_nop 0
    ds_read_b128 v[224:227], v18 offset:32768
    ds_read_b128 v[228:231], v18 offset:40960
    buffer_load_dwordx4 v5, s[12:15], s30 offen offset:0  lds
    v_mfma_f32_32x32x16_bf16 v[80:95], v[144:147], v[180:183], v[80:95]
    ds_read_b128 v[232:235], v19 offset:32768
    ds_read_b128 v[236:239], v19 offset:40960
    buffer_load_dwordx4 v6, s[12:15], s30 offen offset:1024  lds
    v_mfma_f32_32x32x16_bf16 v[96:111], v[148:151], v[176:179], v[96:111]
    ds_read_b128 v[240:243], v20 offset:32768
    ds_read_b128 v[244:247], v20 offset:40960
    buffer_load_dwordx4 v7, s[12:15], s30 offen offset:2048  lds
    v_mfma_f32_32x32x16_bf16 v[112:127], v[148:151], v[180:183], v[112:127]
    ds_read_b128 v[248:251], v21 offset:32768
    ds_read_b128 v[252:255], v21 offset:40960
    buffer_load_dwordx4 v8, s[12:15], s30 offen offset:3072  lds
    s_add_u32 s30, s30, 128
    s_cmp_eq_u32 s30, s32
    s_cselect_b32 s30, s31, s30
    v_mfma_f32_32x32x16_bf16 v[64:79], v[152:155], v[184:187], v[64:79]
    v_mfma_f32_32x32x16_bf16 v[80:95], v[152:155], v[188:191], v[80:95]
    v_mfma_f32_32x32x16_bf16 v[96:111], v[156:159], v[184:187], v[96:111]
    v_mfma_f32_32x32x16_bf16 v[112:127], v[156:159], v[188:191], v[112:127]
    s_waitcnt vmcnt(4) lgkmcnt(0)
    s_barrier
    v_mfma_f32_32x32x16_bf16 v[64:79], v[192:195], v[224:227], v[64:79]
    s_add_u32 m0, s33, 0
    s_nop 0
    ds_read_b128 v[128:131], v10 offset:49152
    ds_read_b128 v[132:135], v10 offset:53248
    buffer_load_dwordx4 v1, s[8:11], s27 offen offset:0  lds
    v_mfma_f32_32x32x16_bf16 v[80:95], v[192:195], v[228:231], v[80:95]
    ds_read_b128 v[136:139], v11 offset:49152
    ds_read_b128 v[140:143], v11 offset:53248
    buffer_load_dwordx4 v2, s[8:11], s27 offen offset:1024  lds
    v_mfma_f32_32x32x16_bf16 v[96:111], v[196:199], v[224:227], v[96:111]
    ds_read_b128 v[144:147], v12 offset:49152
    ds_read_b128 v[148:151], v12 offset:53248
    buffer_load_dwordx4 v3, s[8:11], s27 offen offset:2048  lds
    v_mfma_f32_32x32x16_bf16 v[112:127], v[196:199], v[228:231], v[112:127]
    ds_read_b128 v[152:155], v13 offset:49152
    ds_read_b128 v[156:159], v13 offset:53248
    buffer_load_dwordx4 v4, s[8:11], s27 offen offset:3072  lds
    s_add_u32 s27, s27, 128
    s_cmp_eq_u32 s27, s29
    s_cselect_b32 s27, s28, s27
    v_mfma_f32_32x32x16_bf16 v[64:79], v[200:203], v[232:235], v[64:79]
    v_mfma_f32_32x32x16_bf16 v[80:95], v[200:203], v[236:239], v[80:95]
    v_mfma_f32_32x32x16_bf16 v[96:111], v[204:207], v[232:235], v[96:111]
    v_mfma_f32_32x32x16_bf16 v[112:127], v[204:207], v[236:239], v[112:127]
    s_waitcnt vmcnt(4) lgkmcnt(0)
    s_barrier
    v_mfma_f32_32x32x16_bf16 v[64:79], v[208:211], v[240:243], v[64:79]
    s_add_u32 m0, s33, 16384
    s_nop 0
    ds_read_b128 v[160:163], v22 offset:0
    ds_read_b128 v[164:167], v22 offset:8192
    buffer_load_dwordx4 v5, s[12:15], s30 offen offset:0  lds
    v_mfma_f32_32x32x16_bf16 v[80:95], v[208:211], v[244:247], v[80:95]
    ds_read_b128 v[168:171], v23 offset:0
    ds_read_b128 v[172:175], v23 offset:8192
    buffer_load_dwordx4 v6, s[12:15], s30 offen offset:1024  lds
    v_mfma_f32_32x32x16_bf16 v[96:111], v[212:215], v[240:243], v[96:111]
    ds_read_b128 v[176:179], v24 offset:0
    ds_read_b128 v[180:183], v24 offset:8192
    buffer_load_dwordx4 v7, s[12:15], s30 offen offset:2048  lds
    v_mfma_f32_32x32x16_bf16 v[112:127], v[212:215], v[244:247], v[112:127]
    ds_read_b128 v[184:187], v25 offset:0
    ds_read_b128 v[188:191], v25 offset:8192
    buffer_load_dwordx4 v8, s[12:15], s30 offen offset:3072  lds
    s_add_u32 s30, s30, 128
    s_cmp_eq_u32 s30, s32
    s_cselect_b32 s30, s31, s30
    v_mfma_f32_32x32x16_bf16 v[64:79], v[216:219], v[248:251], v[64:79]
    v_mfma_f32_32x32x16_bf16 v[80:95], v[216:219], v[252:255], v[80:95]
    v_mfma_f32_32x32x16_bf16 v[96:111], v[220:223], v[248:251], v[96:111]
    v_mfma_f32_32x32x16_bf16 v[112:127], v[220:223], v[252:255], v[112:127]
    s_waitcnt vmcnt(4) lgkmcnt(0)
    s_barrier
    v_mfma_f32_32x32x16_bf16 v[64:79], v[128:131], v[160:163], v[64:79]
    s_add_u32 m0, s33, 32768
    s_nop 0
    ds_read_b128 v[192:195], v10 offset:0
    ds_read_b128 v[196:199], v10 offset:4096
    buffer_load_dwordx4 v1, s[8:11], s27 offen offset:0  lds
    v_mfma_f32_32x32x16_bf16 v[80:95], v[128:131], v[164:167], v[80:95]
    ds_read_b128 v[200:203], v11 offset:0
    ds_read_b128 v[204:207], v11 offset:4096
    buffer_load_dwordx4 v2, s[8:11], s27 offen offset:1024  lds
    v_mfma_f32_32x32x16_bf16 v[96:111], v[132:135], v[160:163], v[96:111]
    ds_read_b128 v[208:211], v12 offset:0
    ds_read_b128 v[212:215], v12 offset:4096
    buffer_load_dwordx4 v3, s[8:11], s27 offen offset:2048  lds
    v_mfma_f32_32x32x16_bf16 v[112:127], v[132:135], v[164:167], v[112:127]
    ds_read_b128 v[216:219], v13 offset:0
    ds_read_b128 v[220:223], v13 offset:4096
    buffer_load_dwordx4 v4, s[8:11], s27 offen offset:3072  lds
    s_add_u32 s27, s27, 128
    s_cmp_eq_u32 s27, s29
    s_cselect_b32 s27, s28, s27
    v_mfma_f32_32x32x16_bf16 v[64:79], v[136:139], v[168:171], v[64:79]
    v_mfma_f32_32x32x16_bf16 v[80:95], v[136:139], v[172:175], v[80:95]
    v_mfma_f32_32x32x16_bf16 v[96:111], v[140:143], v[168:171], v[96:111]
    v_mfma_f32_32x32x16_bf16 v[112:127], v[140:143], v[172:175], v[112:127]
    s_waitcnt vmcnt(4) lgkmcnt(0)
    s_barrier
    v_mfma_f32_32x32x16_bf16 v[64:79], v[144:147], v[176:179], v[64:79]
    s_add_u32 m0, s33, 49152
    s_nop 0
    ds_read_b128 v[224:227], v18 offset:16384
    ds_read_b128 v[228:231], v18 offset:24576
    buffer_load_dwordx4 v5, s[12:15], s30 offen offset:0  lds
    v_mfma_f32_32x32x16_bf16 v[80:95], v[144:147], v[180:183], v[80:95]
    ds_read_b128 v[232:235], v19 offset:16384
    ds_read_b128 v[236:239], v19 offset:24576
    buffer_load_dwordx4 v6, s[12:15], s30 offen offset:1024  lds
    v_mfma_f32_32x32x16_bf16 v[96:111], v[148:151], v[176:179], v[96:111]
    ds_read_b128 v[240:243], v20 offset:16384
    ds_read_b128 v[244:247], v20 offset:24576
    buffer_load_dwordx4 v7, s[12:15], s30 offen offset:2048  lds
    v_mfma_f32_32x32x16_bf16 v[112:127], v[148:151], v[180:183], v[112:127]
    ds_read_b128 v[248:251], v21 offset:16384
    ds_read_b128 v[252:255], v21 offset:24576
    buffer_load_dwordx4 v8, s[12:15], s30 offen offset:3072  lds
    s_add_u32 s30, s30, 128
    s_cmp_eq_u32 s30, s32
    s_cselect_b32 s30, s31, s30
    v_mfma_f32_32x32x16_bf16 v[64:79], v[152:155], v[184:187], v[64:79]
    v_mfma_f32_32x32x16_bf16 v[80:95], v[152:155], v[188:191], v[80:95]
    v_mfma_f32_32x32x16_bf16 v[96:111], v[156:159], v[184:187], v[96:111]
    v_mfma_f32_32x32x16_bf16 v[112:127], v[156:159], v[188:191], v[112:127]
    s_waitcnt vmcnt(4) lgkmcnt(0)
    s_barrier
    v_mfma_f32_32x32x16_bf16 v[64:79], v[192:195], v[224:227], v[64:79]
    s_add_u32 m0, s33, 65536
    s_nop 0
    ds_read_b128 v[128:131], v10 offset:32768
    ds_read_b128 v[132:135], v10 offset:36864
    buffer_load_dwordx4 v1, s[8:11], s27 offen offset:0  lds
    v_mfma_f32_32x32x16_bf16 v[80:95], v[192:195], v[228:231], v[80:95]
    ds_read_b128 v[136:139], v11 offset:32768
    ds_read_b128 v[140:143], v11 offset:36864
    buffer_load_dwordx4 v2, s[8:11], s27 offen offset:1024  lds
    v_mfma_f32_32x32x16_bf16 v[96:111], v[196:199], v[224:227], v[96:111]
    ds_read_b128 v[144:147], v12 offset:32768
    ds_read_b128 v[148:151], v12 offset:36864
    buffer_load_dwordx4 v3, s[8:11], s27 offen offset:2048  lds
    v_mfma_f32_32x32x16_bf16 v[112:127], v[196:199], v[228:231], v[112:127]
    ds_read_b128 v[152:155], v13 offset:32768
    ds_read_b128 v[156:159], v13 offset:36864
    buffer_load_dwordx4 v4, s[8:11], s27 offen offset:3072  lds
    s_add_u32 s27, s27, 128
    s_cmp_eq_u32 s27, s29
    s_cselect_b32 s27, s28, s27
    v_mfma_f32_32x32x16_bf16 v[64:79], v[200:203], v[232:235], v[64:79]
    v_mfma_f32_32x32x16_bf16 v[80:95], v[200:203], v[236:239], v[80:95]
    v_mfma_f32_32x32x16_bf16 v[96:111], v[204:207], v[232:235], v[96:111]
    v_mfma_f32_32x32x16_bf16 v[112:127], v[204:207], v[236:239], v[112:127]
    s_waitcnt vmcnt(4) lgkmcnt(0)
    s_barrier
    v_mfma_f32_32x32x16_bf16 v[64:79], v[208:211], v[240:243], v[64:79]
    s_add_u32 m0, s33, 0
    s_nop 0
    ds_read_b128 v[160:163], v18 offset:49152
    ds_read_b128 v[164:167], v18 offset:57344
    buffer_load_dwordx4 v5, s[12:15], s30 offen offset:0  lds
    v_mfma_f32_32x32x16_bf16 v[80:95], v[208:211], v[244:247], v[80:95]
    ds_read_b128 v[168:171], v19 offset:49152
    ds_read_b128 v[172:175], v19 offset:57344
    buffer_load_dwordx4 v6, s[12:15], s30 offen offset:1024  lds
    v_mfma_f32_32x32x16_bf16 v[96:111], v[212:215], v[240:243], v[96:111]
    ds_read_b128 v[176:179], v20 offset:49152
    ds_read_b128 v[180:183], v20 offset:57344
    buffer_load_dwordx4 v7, s[12:15], s30 offen offset:2048  lds
    v_mfma_f32_32x32x16_bf16 v[112:127], v[212:215], v[244:247], v[112:127]
    ds_read_b128 v[184:187], v21 offset:49152
    ds_read_b128 v[188:191], v21 offset:57344
    buffer_load_dwordx4 v8, s[12:15], s30 offen offset:3072  lds
    s_add_u32 s30, s30, 128
    s_cmp_eq_u32 s30, s32
    s_cselect_b32 s30, s31, s30
    v_mfma_f32_32x32x16_bf16 v[64:79], v[216:219], v[248:251], v[64:79]
    v_mfma_f32_32x32x16_bf16 v[80:95], v[216:219], v[252:255], v[80:95]
    v_mfma_f32_32x32x16_bf16 v[96:111], v[220:223], v[248:251], v[96:111]
    v_mfma_f32_32x32x16_bf16 v[112:127], v[220:223], v[252:255], v[112:127]
    s_waitcnt vmcnt(4) lgkmcnt(0)
    s_barrier
    v_mfma_f32_32x32x16_bf16 v[64:79], v[128:131], v[160:163], v[64:79]
    s_add_u32 m0, s33, 16384
    s_nop 0
    ds_read_b128 v[192:195], v14 offset:0
    ds_read_b128 v[196:199], v14 offset:4096
    buffer_load_dwordx4 v1, s[8:11], s27 offen offset:0  lds
    v_mfma_f32_32x32x16_bf16 v[80:95], v[128:131], v[164:167], v[80:95]
    ds_read_b128 v[200:203], v15 offset:0
    ds_read_b128 v[204:207], v15 offset:4096
    buffer_load_dwordx4 v2, s[8:11], s27 offen offset:1024  lds
    v_mfma_f32_32x32x16_bf16 v[96:111], v[132:135], v[160:163], v[96:111]
    ds_read_b128 v[208:211], v16 offset:0
    ds_read_b128 v[212:215], v16 offset:4096
    buffer_load_dwordx4 v3, s[8:11], s27 offen offset:2048  lds
    v_mfma_f32_32x32x16_bf16 v[112:127], v[132:135], v[164:167], v[112:127]
    ds_read_b128 v[216:219], v17 offset:0
    ds_read_b128 v[220:223], v17 offset:4096
    buffer_load_dwordx4 v4, s[8:11], s27 offen offset:3072  lds
    s_add_u32 s27, s27, 128
    s_cmp_eq_u32 s27, s29
    s_cselect_b32 s27, s28, s27
    v_mfma_f32_32x32x16_bf16 v[64:79], v[136:139], v[168:171], v[64:79]
    v_mfma_f32_32x32x16_bf16 v[80:95], v[136:139], v[172:175], v[80:95]
    v_mfma_f32_32x32x16_bf16 v[96:111], v[140:143], v[168:171], v[96:111]
    v_mfma_f32_32x32x16_bf16 v[112:127], v[140:143], v[172:175], v[112:127]
    s_waitcnt vmcnt(4) lgkmcnt(0)
    s_barrier
    v_mfma_f32_32x32x16_bf16 v[64:79], v[144:147], v[176:179], v[64:79]
    s_add_u32 m0, s33, 32768
    s_nop 0
    ds_read_b128 v[224:227], v18 offset:0
    ds_read_b128 v[228:231], v18 offset:8192
    buffer_load_dwordx4 v5, s[12:15], s30 offen offset:0  lds
    v_mfma_f32_32x32x16_bf16 v[80:95], v[144:147], v[180:183], v[80:95]
    ds_read_b128 v[232:235], v19 offset:0
    ds_read_b128 v[236:239], v19 offset:8192
    buffer_load_dwordx4 v6, s[12:15], s30 offen offset:1024  lds
    v_mfma_f32_32x32x16_bf16 v[96:111], v[148:151], v[176:179], v[96:111]
    ds_read_b128 v[240:243], v20 offset:0
    ds_read_b128 v[244:247], v20 offset:8192
    buffer_load_dwordx4 v7, s[12:15], s30 offen offset:2048  lds
    v_mfma_f32_32x32x16_bf16 v[112:127], v[148:151], v[180:183], v[112:127]
    ds_read_b128 v[248:251], v21 offset:0
    ds_read_b128 v[252:255], v21 offset:8192
    buffer_load_dwordx4 v8, s[12:15], s30 offen offset:3072  lds
    s_add_u32 s30, s30, 128
    s_cmp_eq_u32 s30, s32
    s_cselect_b32 s30, s31, s30
    v_mfma_f32_32x32x16_bf16 v[64:79], v[152:155], v[184:187], v[64:79]
    v_mfma_f32_32x32x16_bf16 v[80:95], v[152:155], v[188:191], v[80:95]
    v_mfma_f32_32x32x16_bf16 v[96:111], v[156:159], v[184:187], v[96:111]
    v_mfma_f32_32x32x16_bf16 v[112:127], v[156:159], v[188:191], v[112:127]
    s_waitcnt vmcnt(4) lgkmcnt(0)
    s_barrier
    v_mfma_f32_32x32x16_bf16 v[64:79], v[192:195], v[224:227], v[64:79]
    s_add_u32 m0, s33, 49152
    s_nop 0
    ds_read_b128 v[128:131], v10 offset:16384
    ds_read_b128 v[132:135], v10 offset:20480
    buffer_load_dwordx4 v1, s[8:11], s27 offen offset:0  lds
    v_mfma_f32_32x32x16_bf16 v[80:95], v[192:195], v[228:231], v[80:95]
    ds_read_b128 v[136:139], v11 offset:16384
    ds_read_b128 v[140:143], v11 offset:20480
    buffer_load_dwordx4 v2, s[8:11], s27 offen offset:1024  lds
    v_mfma_f32_32x32x16_bf16 v[96:111], v[196:199], v[224:227], v[96:111]
    ds_read_b128 v[144:147], v12 offset:16384
    ds_read_b128 v[148:151], v12 offset:20480
    buffer_load_dwordx4 v3, s[8:11], s27 offen offset:2048  lds
    v_mfma_f32_32x32x16_bf16 v[112:127], v[196:199], v[228:231], v[112:127]
    ds_read_b128 v[152:155], v13 offset:16384
    ds_read_b128 v[156:159], v13 offset:20480
    buffer_load_dwordx4 v4, s[8:11], s27 offen offset:3072  lds
    s_add_u32 s27, s27, 128
    s_cmp_eq_u32 s27, s29
    s_cselect_b32 s27, s28, s27
    v_mfma_f32_32x32x16_bf16 v[64:79], v[200:203], v[232:235], v[64:79]
    v_mfma_f32_32x32x16_bf16 v[80:95], v[200:203], v[236:239], v[80:95]
    v_mfma_f32_32x32x16_bf16 v[96:111], v[204:207], v[232:235], v[96:111]
    v_mfma_f32_32x32x16_bf16 v[112:127], v[204:207], v[236:239], v[112:127]
    s_waitcnt vmcnt(4) lgkmcnt(0)
    s_barrier
    v_mfma_f32_32x32x16_bf16 v[64:79], v[208:211], v[240:243], v[64:79]
    s_add_u32 m0, s33, 65536
    s_nop 0
    ds_read_b128 v[160:163], v18 offset:32768
    ds_read_b128 v[164:167], v18 offset:40960
    buffer_load_dwordx4 v5, s[12:15], s30 offen offset:0  lds
    v_mfma_f32_32x32x16_bf16 v[80:95], v[208:211], v[244:247], v[80:95]
    ds_read_b128 v[168:171], v19 offset:32768
    ds_read_b128 v[172:175], v19 offset:40960
    buffer_load_dwordx4 v6, s[12:15], s30 offen offset:1024  lds
    v_mfma_f32_32x32x16_bf16 v[96:111], v[212:215], v[240:243], v[96:111]
    ds_read_b128 v[176:179], v20 offset:32768
    ds_read_b128 v[180:183], v20 offset:40960
    buffer_load_dwordx4 v7, s[12:15], s30 offen offset:2048  lds
    v_mfma_f32_32x32x16_bf16 v[112:127], v[212:215], v[244:247], v[112:127]
    ds_read_b128 v[184:187], v21 offset:32768
    ds_read_b128 v[188:191], v21 offset:40960
    buffer_load_dwordx4 v8, s[12:15], s30 offen offset:3072  lds
    s_add_u32 s30, s30, 128
    s_cmp_eq_u32 s30, s32
    s_cselect_b32 s30, s31, s30
    v_mfma_f32_32x32x16_bf16 v[64:79], v[216:219], v[248:251], v[64:79]
    v_mfma_f32_32x32x16_bf16 v[80:95], v[216:219], v[252:255], v[80:95]
    v_mfma_f32_32x32x16_bf16 v[96:111], v[220:223], v[248:251], v[96:111]
    v_mfma_f32_32x32x16_bf16 v[112:127], v[220:223], v[252:255], v[112:127]
    s_waitcnt vmcnt(4) lgkmcnt(0)
    s_barrier
    v_mfma_f32_32x32x16_bf16 v[64:79], v[128:131], v[160:163], v[64:79]
    ds_read_b128 v[192:195], v10 offset:49152
    ds_read_b128 v[196:199], v10 offset:53248
    v_mfma_f32_32x32x16_bf16 v[80:95], v[128:131], v[164:167], v[80:95]
    ds_read_b128 v[200:203], v11 offset:49152
    ds_read_b128 v[204:207], v11 offset:53248
    v_mfma_f32_32x32x16_bf16 v[96:111], v[132:135], v[160:163], v[96:111]
    ds_read_b128 v[208:211], v12 offset:49152
    ds_read_b128 v[212:215], v12 offset:53248
    v_mfma_f32_32x32x16_bf16 v[112:127], v[132:135], v[164:167], v[112:127]
    ds_read_b128 v[216:219], v13 offset:49152
    ds_read_b128 v[220:223], v13 offset:53248
    v_mfma_f32_32x32x16_bf16 v[64:79], v[136:139], v[168:171], v[64:79]
    v_mfma_f32_32x32x16_bf16 v[80:95], v[136:139], v[172:175], v[80:95]
    v_mfma_f32_32x32x16_bf16 v[96:111], v[140:143], v[168:171], v[96:111]
    v_mfma_f32_32x32x16_bf16 v[112:127], v[140:143], v[172:175], v[112:127]
    s_waitcnt vmcnt(0) lgkmcnt(0)
    s_barrier
    v_mfma_f32_32x32x16_bf16 v[64:79], v[144:147], v[176:179], v[64:79]
    ds_read_b128 v[224:227], v22 offset:0
    ds_read_b128 v[228:231], v22 offset:8192
    v_mfma_f32_32x32x16_bf16 v[80:95], v[144:147], v[180:183], v[80:95]
    ds_read_b128 v[232:235], v23 offset:0
    ds_read_b128 v[236:239], v23 offset:8192
    v_mfma_f32_32x32x16_bf16 v[96:111], v[148:151], v[176:179], v[96:111]
    ds_read_b128 v[240:243], v24 offset:0
    ds_read_b128 v[244:247], v24 offset:8192
    v_mfma_f32_32x32x16_bf16 v[112:127], v[148:151], v[180:183], v[112:127]
    ds_read_b128 v[248:251], v25 offset:0
    ds_read_b128 v[252:255], v25 offset:8192
    v_mfma_f32_32x32x16_bf16 v[64:79], v[152:155], v[184:187], v[64:79]
    v_mfma_f32_32x32x16_bf16 v[80:95], v[152:155], v[188:191], v[80:95]
    v_mfma_f32_32x32x16_bf16 v[96:111], v[156:159], v[184:187], v[96:111]
    v_mfma_f32_32x32x16_bf16 v[112:127], v[156:159], v[188:191], v[112:127]
    s_waitcnt lgkmcnt(0)
    v_mfma_f32_32x32x16_bf16 v[64:79], v[192:195], v[224:227], v[64:79]
    v_mfma_f32_32x32x16_bf16 v[80:95], v[192:195], v[228:231], v[80:95]
    v_mfma_f32_32x32x16_bf16 v[96:111], v[196:199], v[224:227], v[96:111]
    v_mfma_f32_32x32x16_bf16 v[112:127], v[196:199], v[228:231], v[112:127]
    v_mfma_f32_32x32x16_bf16 v[64:79], v[200:203], v[232:235], v[64:79]
    v_mfma_f32_32x32x16_bf16 v[80:95], v[200:203], v[236:239], v[80:95]
    v_mfma_f32_32x32x16_bf16 v[96:111], v[204:207], v[232:235], v[96:111]
    v_mfma_f32_32x32x16_bf16 v[112:127], v[204:207], v[236:239], v[112:127]
    v_mfma_f32_32x32x16_bf16 v[64:79], v[208:211], v[240:243], v[64:79]
    v_mfma_f32_32x32x16_bf16 v[80:95], v[208:211], v[244:247], v[80:95]
    v_mfma_f32_32x32x16_bf16 v[96:111], v[212:215], v[240:243], v[96:111]
    v_mfma_f32_32x32x16_bf16 v[112:127], v[212:215], v[244:247], v[112:127]
    v_mfma_f32_32x32x16_bf16 v[64:79], v[216:219], v[248:251], v[64:79]
    v_mfma_f32_32x32x16_bf16 v[80:95], v[216:219], v[252:255], v[80:95]
    v_mfma_f32_32x32x16_bf16 v[96:111], v[220:223], v[248:251], v[96:111]
    v_mfma_f32_32x32x16_bf16 v[112:127], v[220:223], v[252:255], v[112:127]
    s_setprio 2
    v_and_b32 v54, 63, v27
    v_lshlrev_b32 v54, 4, v54
    s_lshl_b32 s34, s36, 3
    v_add_u32 v55, s34, v54
    v_xor_b32 v56, 8, v55
    v_lshrrev_b32 v57, 5, v26
    v_cmp_eq_u32 s[40:41], 1, v57
    s_lshl_b32 s34, s36, 1
    v_add_u32 v57, s34, v57
    v_lshlrev_b32 v57, 2, v57
    v_lshlrev_b32 v58, 4, v27
    s_mul_i32 s27, s25, 10240
    s_add_u32 s27, s27, 17104896
    v_pk_fma_f32 v[66:67], v[28:29], v[64:65], v[66:67] op_sel_hi:[0,1,1]
    v_pk_fma_f32 v[82:83], v[28:29], v[80:81], v[82:83] op_sel_hi:[0,1,1]
    v_pk_fma_f32 v[98:99], v[28:29], v[96:97], v[98:99] op_sel_hi:[0,1,1]
    v_pk_fma_f32 v[114:115], v[28:29], v[112:113], v[114:115] op_sel_hi:[0,1,1]
    v_pk_fma_f32 v[66:67], v[28:29], v[80:81], v[66:67] op_sel:[1,0,0] op_sel_hi:[1,1,1] neg_lo:[1,0,0] neg_hi:[1,0,0]
    v_pk_fma_f32 v[82:83], v[28:29], v[64:65], v[82:83] op_sel:[1,0,0] op_sel_hi:[1,1,1]
    v_pk_fma_f32 v[98:99], v[28:29], v[112:113], v[98:99] op_sel:[1,0,0] op_sel_hi:[1,1,1] neg_lo:[1,0,0] neg_hi:[1,0,0]
    v_pk_fma_f32 v[114:115], v[28:29], v[96:97], v[114:115] op_sel:[1,0,0] op_sel_hi:[1,1,1]
    v_pk_fma_f32 v[68:69], v[28:29], v[66:67], v[68:69] op_sel_hi:[0,1,1]
    v_pk_fma_f32 v[84:85], v[28:29], v[82:83], v[84:85] op_sel_hi:[0,1,1]
    v_pk_fma_f32 v[100:101], v[28:29], v[98:99], v[100:101] op_sel_hi:[0,1,1]
    v_pk_fma_f32 v[116:117], v[28:29], v[114:115], v[116:117] op_sel_hi:[0,1,1]
    v_pk_fma_f32 v[68:69], v[28:29], v[82:83], v[68:69] op_sel:[1,0,0] op_sel_hi:[1,1,1] neg_lo:[1,0,0] neg_hi:[1,0,0]
    v_pk_fma_f32 v[84:85], v[28:29], v[66:67], v[84:85] op_sel:[1,0,0] op_sel_hi:[1,1,1]
    v_pk_fma_f32 v[100:101], v[28:29], v[114:115], v[100:101] op_sel:[1,0,0] op_sel_hi:[1,1,1] neg_lo:[1,0,0] neg_hi:[1,0,0]
    v_pk_fma_f32 v[116:117], v[28:29], v[98:99], v[116:117] op_sel:[1,0,0] op_sel_hi:[1,1,1]
    v_pk_fma_f32 v[70:71], v[28:29], v[68:69], v[70:71] op_sel_hi:[0,1,1]
    v_pk_fma_f32 v[86:87], v[28:29], v[84:85], v[86:87] op_sel_hi:[0,1,1]
    v_pk_fma_f32 v[102:103], v[28:29], v[100:101], v[102:103] op_sel_hi:[0,1,1]
    v_pk_fma_f32 v[118:119], v[28:29], v[116:117], v[118:119] op_sel_hi:[0,1,1]
    v_pk_fma_f32 v[70:71], v[28:29], v[84:85], v[70:71] op_sel:[1,0,0] op_sel_hi:[1,1,1] neg_lo:[1,0,0] neg_hi:[1,0,0]
    v_pk_fma_f32 v[86:87], v[28:29], v[68:69], v[86:87] op_sel:[1,0,0] op_sel_hi:[1,1,1]
    v_pk_fma_f32 v[102:103], v[28:29], v[116:117], v[102:103] op_sel:[1,0,0] op_sel_hi:[1,1,1] neg_lo:[1,0,0] neg_hi:[1,0,0]
    v_pk_fma_f32 v[118:119], v[28:29], v[100:101], v[118:119] op_sel:[1,0,0] op_sel_hi:[1,1,1]
    v_pk_fma_f32 v[72:73], v[28:29], v[70:71], v[72:73] op_sel_hi:[0,1,1]
    v_pk_fma_f32 v[88:89], v[28:29], v[86:87], v[88:89] op_sel_hi:[0,1,1]
    v_pk_fma_f32 v[104:105], v[28:29], v[102:103], v[104:105] op_sel_hi:[0,1,1]
    v_pk_fma_f32 v[120:121], v[28:29], v[118:119], v[120:121] op_sel_hi:[0,1,1]
    v_pk_fma_f32 v[72:73], v[28:29], v[86:87], v[72:73] op_sel:[1,0,0] op_sel_hi:[1,1,1] neg_lo:[1,0,0] neg_hi:[1,0,0]
    v_pk_fma_f32 v[88:89], v[28:29], v[70:71], v[88:89] op_sel:[1,0,0] op_sel_hi:[1,1,1]
    v_pk_fma_f32 v[104:105], v[28:29], v[118:119], v[104:105] op_sel:[1,0,0] op_sel_hi:[1,1,1] neg_lo:[1,0,0] neg_hi:[1,0,0]
    v_pk_fma_f32 v[120:121], v[28:29], v[102:103], v[120:121] op_sel:[1,0,0] op_sel_hi:[1,1,1]
    v_pk_fma_f32 v[74:75], v[28:29], v[72:73], v[74:75] op_sel_hi:[0,1,1]
    v_pk_fma_f32 v[90:91], v[28:29], v[88:89], v[90:91] op_sel_hi:[0,1,1]
    v_pk_fma_f32 v[106:107], v[28:29], v[104:105], v[106:107] op_sel_hi:[0,1,1]
    v_pk_fma_f32 v[122:123], v[28:29], v[120:121], v[122:123] op_sel_hi:[0,1,1]
    v_pk_fma_f32 v[74:75], v[28:29], v[88:89], v[74:75] op_sel:[1,0,0] op_sel_hi:[1,1,1] neg_lo:[1,0,0] neg_hi:[1,0,0]
    v_pk_fma_f32 v[90:91], v[28:29], v[72:73], v[90:91] op_sel:[1,0,0] op_sel_hi:[1,1,1]
    v_pk_fma_f32 v[106:107], v[28:29], v[120:121], v[106:107] op_sel:[1,0,0] op_sel_hi:[1,1,1] neg_lo:[1,0,0] neg_hi:[1,0,0]
    v_pk_fma_f32 v[122:123], v[28:29], v[104:105], v[122:123] op_sel:[1,0,0] op_sel_hi:[1,1,1]
    v_pk_fma_f32 v[76:77], v[28:29], v[74:75], v[76:77] op_sel_hi:[0,1,1]
    v_pk_fma_f32 v[92:93], v[28:29], v[90:91], v[92:93] op_sel_hi:[0,1,1]
    v_pk_fma_f32 v[108:109], v[28:29], v[106:107], v[108:109] op_sel_hi:[0,1,1]
    v_pk_fma_f32 v[124:125], v[28:29], v[122:123], v[124:125] op_sel_hi:[0,1,1]
    v_pk_fma_f32 v[76:77], v[28:29], v[90:91], v[76:77] op_sel:[1,0,0] op_sel_hi:[1,1,1] neg_lo:[1,0,0] neg_hi:[1,0,0]
    v_pk_fma_f32 v[92:93], v[28:29], v[74:75], v[92:93] op_sel:[1,0,0] op_sel_hi:[1,1,1]
    v_pk_fma_f32 v[108:109], v[28:29], v[122:123], v[108:109] op_sel:[1,0,0] op_sel_hi:[1,1,1] neg_lo:[1,0,0] neg_hi:[1,0,0]
    v_pk_fma_f32 v[124:125], v[28:29], v[106:107], v[124:125] op_sel:[1,0,0] op_sel_hi:[1,1,1]
    v_pk_fma_f32 v[78:79], v[28:29], v[76:77], v[78:79] op_sel_hi:[0,1,1]
    v_pk_fma_f32 v[94:95], v[28:29], v[92:93], v[94:95] op_sel_hi:[0,1,1]
    v_pk_fma_f32 v[110:111], v[28:29], v[108:109], v[110:111] op_sel_hi:[0,1,1]
    v_pk_fma_f32 v[126:127], v[28:29], v[124:125], v[126:127] op_sel_hi:[0,1,1]
    v_pk_fma_f32 v[78:79], v[28:29], v[92:93], v[78:79] op_sel:[1,0,0] op_sel_hi:[1,1,1] neg_lo:[1,0,0] neg_hi:[1,0,0]
    v_pk_fma_f32 v[94:95], v[28:29], v[76:77], v[94:95] op_sel:[1,0,0] op_sel_hi:[1,1,1]
    v_pk_fma_f32 v[110:111], v[28:29], v[124:125], v[110:111] op_sel:[1,0,0] op_sel_hi:[1,1,1] neg_lo:[1,0,0] neg_hi:[1,0,0]
    v_pk_fma_f32 v[126:127], v[28:29], v[108:109], v[126:127] op_sel:[1,0,0] op_sel_hi:[1,1,1]
    v_fma_f32 v128, v42, v78, v79
    v_fma_f32 v129, v42, v94, v95
    v_fma_f32 v128, -v43, v94, v128
    v_fma_f32 v129, v43, v78, v129
    v_fma_f32 v132, v42, v110, v111
    v_fma_f32 v133, v42, v126, v127
    v_fma_f32 v132, -v43, v126, v132
    v_fma_f32 v133, v43, v110, v133
    v_mov_b32 v130, v128
    v_mov_b32 v131, v129
    v_mov_b32 v134, v132
    v_mov_b32 v135, v133
    s_nop 0
    v_permlane32_swap_b32 v128, v130
    v_permlane32_swap_b32 v129, v131
    v_permlane32_swap_b32 v132, v134
    v_permlane32_swap_b32 v133, v135
    s_barrier
    v_fma_f32 v136, v46, v128, v130
    v_fma_f32 v137, v46, v129, v131
    v_fma_f32 v136, -v47, v129, v136
    v_fma_f32 v137, v47, v128, v137
    v_fma_f32 v138, v46, v132, v134
    v_fma_f32 v139, v46, v133, v135
    v_fma_f32 v138, -v47, v133, v138
    v_fma_f32 v139, v47, v132, v139
    v_fma_f32 v140, v48, v136, v138
    v_fma_f32 v141, v48, v137, v139
    v_fma_f32 v140, -v49, v137, v140
    v_fma_f32 v141, v49, v136, v141
    ds_write_b64 v55, v[140:141]
    s_waitcnt lgkmcnt(0)
    s_barrier
    s_cmp_eq_u32 s36, 0
    s_cbranch_scc1 g1_nopub
    ds_read_b64 v[142:143], v56
    v_mov_b32 v145, s65
    v_mov_b32 v147, s65
    s_waitcnt lgkmcnt(0)
    v_fma_f32 v144, v50, v142, v140
    v_fma_f32 v146, v50, v143, v141
    v_fma_f32 v144, -v51, v143, v144
    v_fma_f32 v146, v51, v142, v146
    buffer_store_dwordx4 v[144:147], v58, s[16:19], s27 offen sc1
g1_nopub:
    v_mov_b32 v152, 0x70000000
    v_sub_u32 v57, s25, v57
    v_subrev_u32 v153, 1, v57
    v_cmp_le_i32 s[44:45], 0, v153
    v_mul_u32_u24 v153, 10240, v153
    v_add_u32 v153, v153, v58
    v_cndmask_b32 v148, v152, v153, s[44:45]
    v_subrev_u32 v153, 2, v57
    v_cmp_le_i32 s[46:47], 0, v153
    v_mul_u32_u24 v153, 10240, v153
    v_add_u32 v153, v153, v58
    v_cndmask_b32 v149, v152, v153, s[46:47]
    v_subrev_u32 v153, 3, v57
    v_cmp_le_i32 s[48:49], 0, v153
    v_mul_u32_u24 v153, 10240, v153
    v_add_u32 v153, v153, v58
    v_cndmask_b32 v150, v152, v153, s[48:49]
    v_subrev_u32 v153, 4, v57
    v_cmp_le_i32 s[50:51], 0, v153
    v_mul_u32_u24 v153, 10240, v153
    v_add_u32 v153, v153, v58
    v_cndmask_b32 v151, v152, v153, s[50:51]
    s_mov_b32 s35, 17104896
    buffer_load_dwordx4 v[160:163], v148, s[16:19], s35 offen sc1
    buffer_load_dwordx4 v[164:167], v149, s[16:19], s35 offen sc1
    buffer_load_dwordx4 v[168:171], v150, s[16:19], s35 offen sc1
    buffer_load_dwordx4 v[172:175], v151, s[16:19], s35 offen sc1
    v_mul_f32 v158, v53, v53
    v_fma_f32 v158, v52, v52, -v158
    v_mul_f32 v159, v52, v53
    v_fma_f32 v155, v53, v52, v159
    v_mov_b32 v154, v158
    v_mul_f32 v158, v155, v155
    v_fma_f32 v158, v154, v154, -v158
    v_mul_f32 v159, v154, v155
    v_fma_f32 v155, v155, v154, v159
    v_mov_b32 v154, v158
    v_mul_f32 v158, v155, v155
    v_fma_f32 v158, v154, v154, -v158
    v_mul_f32 v159, v154, v155
    v_fma_f32 v157, v155, v154, v159
    v_mov_b32 v156, v158
    v_pk_mul_f32 v[176:177], v[44:45], v[80:81] op_sel:[1,0] op_sel_hi:[1,1]
    v_pk_mul_f32 v[80:81], v[44:45], v[80:81] op_sel_hi:[0,1]
    v_pk_fma_f32 v[80:81], v[44:45], v[64:65], v[80:81] op_sel:[1,0,0] op_sel_hi:[1,1,1]
    v_pk_fma_f32 v[64:65], v[44:45], v[64:65], v[176:177] op_sel_hi:[0,1,1] neg_lo:[0,0,1] neg_hi:[0,0,1]
    v_pk_mul_f32 v[178:179], v[44:45], v[112:113] op_sel:[1,0] op_sel_hi:[1,1]
    v_pk_mul_f32 v[112:113], v[44:45], v[112:113] op_sel_hi:[0,1]
    v_pk_fma_f32 v[112:113], v[44:45], v[96:97], v[112:113] op_sel:[1,0,0] op_sel_hi:[1,1,1]
    v_pk_fma_f32 v[96:97], v[44:45], v[96:97], v[178:179] op_sel_hi:[0,1,1] neg_lo:[0,0,1] neg_hi:[0,0,1]
    v_pk_mul_f32 v[176:177], v[44:45], v[82:83] op_sel:[1,0] op_sel_hi:[1,1]
    v_pk_mul_f32 v[82:83], v[44:45], v[82:83] op_sel_hi:[0,1]
    v_pk_fma_f32 v[82:83], v[44:45], v[66:67], v[82:83] op_sel:[1,0,0] op_sel_hi:[1,1,1]
    v_pk_fma_f32 v[66:67], v[44:45], v[66:67], v[176:177] op_sel_hi:[0,1,1] neg_lo:[0,0,1] neg_hi:[0,0,1]
    v_pk_mul_f32 v[178:179], v[44:45], v[114:115] op_sel:[1,0] op_sel_hi:[1,1]
    v_pk_mul_f32 v[114:115], v[44:45], v[114:115] op_sel_hi:[0,1]
    v_pk_fma_f32 v[114:115], v[44:45], v[98:99], v[114:115] op_sel:[1,0,0] op_sel_hi:[1,1,1]
    v_pk_fma_f32 v[98:99], v[44:45], v[98:99], v[178:179] op_sel_hi:[0,1,1] neg_lo:[0,0,1] neg_hi:[0,0,1]
    v_pk_mul_f32 v[176:177], v[44:45], v[84:85] op_sel:[1,0] op_sel_hi:[1,1]
    v_pk_mul_f32 v[84:85], v[44:45], v[84:85] op_sel_hi:[0,1]
    v_pk_fma_f32 v[84:85], v[44:45], v[68:69], v[84:85] op_sel:[1,0,0] op_sel_hi:[1,1,1]
    v_pk_fma_f32 v[68:69], v[44:45], v[68:69], v[176:177] op_sel_hi:[0,1,1] neg_lo:[0,0,1] neg_hi:[0,0,1]
    v_pk_mul_f32 v[178:179], v[44:45], v[116:117] op_sel:[1,0] op_sel_hi:[1,1]
    v_pk_mul_f32 v[116:117], v[44:45], v[116:117] op_sel_hi:[0,1]
    v_pk_fma_f32 v[116:117], v[44:45], v[100:101], v[116:117] op_sel:[1,0,0] op_sel_hi:[1,1,1]
    v_pk_fma_f32 v[100:101], v[44:45], v[100:101], v[178:179] op_sel_hi:[0,1,1] neg_lo:[0,0,1] neg_hi:[0,0,1]
    v_pk_mul_f32 v[176:177], v[44:45], v[86:87] op_sel:[1,0] op_sel_hi:[1,1]
    v_pk_mul_f32 v[86:87], v[44:45], v[86:87] op_sel_hi:[0,1]
    v_pk_fma_f32 v[86:87], v[44:45], v[70:71], v[86:87] op_sel:[1,0,0] op_sel_hi:[1,1,1]
    v_pk_fma_f32 v[70:71], v[44:45], v[70:71], v[176:177] op_sel_hi:[0,1,1] neg_lo:[0,0,1] neg_hi:[0,0,1]
    v_pk_mul_f32 v[178:179], v[44:45], v[118:119] op_sel:[1,0] op_sel_hi:[1,1]
    v_pk_mul_f32 v[118:119], v[44:45], v[118:119] op_sel_hi:[0,1]
    v_pk_fma_f32 v[118:119], v[44:45], v[102:103], v[118:119] op_sel:[1,0,0] op_sel_hi:[1,1,1]
    v_pk_fma_f32 v[102:103], v[44:45], v[102:103], v[178:179] op_sel_hi:[0,1,1] neg_lo:[0,0,1] neg_hi:[0,0,1]
    v_pk_mul_f32 v[176:177], v[44:45], v[88:89] op_sel:[1,0] op_sel_hi:[1,1]
    v_pk_mul_f32 v[88:89], v[44:45], v[88:89] op_sel_hi:[0,1]
    v_pk_fma_f32 v[88:89], v[44:45], v[72:73], v[88:89] op_sel:[1,0,0] op_sel_hi:[1,1,1]
    v_pk_fma_f32 v[72:73], v[44:45], v[72:73], v[176:177] op_sel_hi:[0,1,1] neg_lo:[0,0,1] neg_hi:[0,0,1]
    v_pk_mul_f32 v[178:179], v[44:45], v[120:121] op_sel:[1,0] op_sel_hi:[1,1]
    v_pk_mul_f32 v[120:121], v[44:45], v[120:121] op_sel_hi:[0,1]
    v_pk_fma_f32 v[120:121], v[44:45], v[104:105], v[120:121] op_sel:[1,0,0] op_sel_hi:[1,1,1]
    v_pk_fma_f32 v[104:105], v[44:45], v[104:105], v[178:179] op_sel_hi:[0,1,1] neg_lo:[0,0,1] neg_hi:[0,0,1]
    v_pk_mul_f32 v[176:177], v[44:45], v[90:91] op_sel:[1,0] op_sel_hi:[1,1]
    v_pk_mul_f32 v[90:91], v[44:45], v[90:91] op_sel_hi:[0,1]
    v_pk_fma_f32 v[90:91], v[44:45], v[74:75], v[90:91] op_sel:[1,0,0] op_sel_hi:[1,1,1]
    v_pk_fma_f32 v[74:75], v[44:45], v[74:75], v[176:177] op_sel_hi:[0,1,1] neg_lo:[0,0,1] neg_hi:[0,0,1]
    v_pk_mul_f32 v[178:179], v[44:45], v[122:123] op_sel:[1,0] op_sel_hi:[1,1]
    v_pk_mul_f32 v[122:123], v[44:45], v[122:123] op_sel_hi:[0,1]
    v_pk_fma_f32 v[122:123], v[44:45], v[106:107], v[122:123] op_sel:[1,0,0] op_sel_hi:[1,1,1]
    v_pk_fma_f32 v[106:107], v[44:45], v[106:107], v[178:179] op_sel_hi:[0,1,1] neg_lo:[0,0,1] neg_hi:[0,0,1]
    v_pk_mul_f32 v[176:177], v[44:45], v[92:93] op_sel:[1,0] op_sel_hi:[1,1]
    v_pk_mul_f32 v[92:93], v[44:45], v[92:93] op_sel_hi:[0,1]
    v_pk_fma_f32 v[92:93], v[44:45], v[76:77], v[92:93] op_sel:[1,0,0] op_sel_hi:[1,1,1]
    v_pk_fma_f32 v[76:77], v[44:45], v[76:77], v[176:177] op_sel_hi:[0,1,1] neg_lo:[0,0,1] neg_hi:[0,0,1]
    v_pk_mul_f32 v[178:179], v[44:45], v[124:125] op_sel:[1,0] op_sel_hi:[1,1]
    v_pk_mul_f32 v[124:125], v[44:45], v[124:125] op_sel_hi:[0,1]
    v_pk_fma_f32 v[124:125], v[44:45], v[108:109], v[124:125] op_sel:[1,0,0] op_sel_hi:[1,1,1]
    v_pk_fma_f32 v[108:109], v[44:45], v[108:109], v[178:179] op_sel_hi:[0,1,1] neg_lo:[0,0,1] neg_hi:[0,0,1]
    s_mov_b32 s67, 20000
g1_lb:
    s_waitcnt vmcnt(0)
    s_mov_b64 s[42:43], 0
    v_cmp_ne_u32 vcc, s65, v161
    v_cmp_ne_u32 s[58:59], s65, v163
    s_or_b64 vcc, vcc, s[58:59]
    s_and_b64 vcc, vcc, s[44:45]
    s_or_b64 s[42:43], s[42:43], vcc
    v_cmp_ne_u32 vcc, s65, v165
    v_cmp_ne_u32 s[58:59], s65, v167
    s_or_b64 vcc, vcc, s[58:59]
    s_and_b64 vcc, vcc, s[46:47]
    s_or_b64 s[42:43], s[42:43], vcc
    v_cmp_ne_u32 vcc, s65, v169
    v_cmp_ne_u32 s[58:59], s65, v171
    s_or_b64 vcc, vcc, s[58:59]
    s_and_b64 vcc, vcc, s[48:49]
    s_or_b64 s[42:43], s[42:43], vcc
    v_cmp_ne_u32 vcc, s65, v173
    v_cmp_ne_u32 s[58:59], s65, v175
    s_or_b64 vcc, vcc, s[58:59]
    s_and_b64 vcc, vcc, s[50:51]
    s_or_b64 s[42:43], s[42:43], vcc
    s_cmp_eq_u64 s[42:43], 0
    s_cbranch_scc1 g1_lb_ok
    s_sleep 2
    buffer_load_dwordx4 v[160:163], v148, s[16:19], s35 offen sc1
    buffer_load_dwordx4 v[164:167], v149, s[16:19], s35 offen sc1
    buffer_load_dwordx4 v[168:171], v150, s[16:19], s35 offen sc1
    buffer_load_dwordx4 v[172:175], v151, s[16:19], s35 offen sc1
    s_sub_u32 s67, s67, 1
    s_cmp_lg_u32 s67, 0
    s_cbranch_scc1 g1_lb
    s_waitcnt vmcnt(0)
g1_lb_ok:
    v_fma_f32 v168, v52, v172, v168
    v_fma_f32 v170, v52, v174, v170
    v_fma_f32 v168, -v53, v174, v168
    v_fma_f32 v170, v53, v172, v170
    v_fma_f32 v164, v52, v168, v164
    v_fma_f32 v166, v52, v170, v166
    v_fma_f32 v164, -v53, v170, v164
    v_fma_f32 v166, v53, v168, v166
    v_fma_f32 v160, v52, v164, v160
    v_fma_f32 v162, v52, v166, v162
    v_fma_f32 v160, -v53, v166, v160
    v_fma_f32 v162, v53, v164, v162
    v_mov_b32 v148, v160
    v_mov_b32 v150, v160
    v_mov_b32 v149, v162
    v_mov_b32 v151, v162
    s_nop 0
    v_permlane32_swap_b32 v148, v150
    v_permlane32_swap_b32 v149, v151
    s_nop 0
    v_fma_f32 v148, v154, v150, v148
    v_fma_f32 v149, v154, v151, v149
    v_fma_f32 v148, -v155, v151, v148
    v_fma_f32 v149, v155, v150, v149
    ds_write_b64 v55, v[148:149] offset:1024
    v_mov_b32 v168, v78
    v_mov_b32 v169, v94
    v_mov_b32 v170, v110
    v_mov_b32 v171, v126
    v_pk_mul_f32 v[176:177], v[44:45], v[94:95] op_sel:[1,0] op_sel_hi:[1,1]
    v_pk_mul_f32 v[94:95], v[44:45], v[94:95] op_sel_hi:[0,1]
    v_pk_fma_f32 v[94:95], v[44:45], v[78:79], v[94:95] op_sel:[1,0,0] op_sel_hi:[1,1,1]
    v_pk_fma_f32 v[78:79], v[44:45], v[78:79], v[176:177] op_sel_hi:[0,1,1] neg_lo:[0,0,1] neg_hi:[0,0,1]
    v_pk_mul_f32 v[178:179], v[44:45], v[126:127] op_sel:[1,0] op_sel_hi:[1,1]
    v_pk_mul_f32 v[126:127], v[44:45], v[126:127] op_sel_hi:[0,1]
    v_pk_fma_f32 v[126:127], v[44:45], v[110:111], v[126:127] op_sel:[1,0,0] op_sel_hi:[1,1,1]
    v_pk_fma_f32 v[110:111], v[44:45], v[110:111], v[178:179] op_sel_hi:[0,1,1] neg_lo:[0,0,1] neg_hi:[0,0,1]
    s_waitcnt lgkmcnt(0)
    s_barrier
    ds_read_b128 v[172:175], v54 offset:1024
    s_waitcnt lgkmcnt(0)
    v_fma_f32 v172, v156, v174, v172
    v_fma_f32 v173, v156, v175, v173
    v_fma_f32 v172, -v157, v175, v172
    v_fma_f32 v173, v157, v174, v173
    s_cmp_eq_u32 s36, 0
    s_cbranch_scc1 g1_w0
    v_fma_f32 v142, v50, v172, v142
    v_fma_f32 v143, v50, v173, v143
    v_fma_f32 v142, -v51, v173, v142
    v_fma_f32 v143, v51, v172, v143
    v_mov_b32 v172, v142
    v_mov_b32 v173, v143
g1_w0:
    v_fma_f32 v136, v48, v172, v136
    v_fma_f32 v137, v48, v173, v137
    v_fma_f32 v136, -v49, v173, v136
    v_fma_f32 v137, v49, v172, v137
    v_fma_f32 v128, v46, v172, v128
    v_fma_f32 v129, v46, v173, v129
    v_fma_f32 v128, -v47, v173, v128
    v_fma_f32 v129, v47, v172, v129
    v_cndmask_b32 v130, v172, v128, s[40:41]
    v_cndmask_b32 v131, v173, v129, s[40:41]
    v_fma_f32 v168, v42, v130, v168
    v_fma_f32 v169, v42, v131, v169
    v_fma_f32 v168, -v43, v131, v168
    v_fma_f32 v169, v43, v130, v169
    v_fma_f32 v132, v46, v136, v132
    v_fma_f32 v133, v46, v137, v133
    v_fma_f32 v132, -v47, v137, v132
    v_fma_f32 v133, v47, v136, v133
    v_cndmask_b32 v134, v136, v132, s[40:41]
    v_cndmask_b32 v135, v137, v133, s[40:41]
    v_fma_f32 v170, v42, v134, v170
    v_fma_f32 v171, v42, v135, v171
    v_fma_f32 v170, -v43, v135, v170
    v_fma_f32 v171, v43, v134, v171
    v_mul_f32 v180, v44, v130
    v_mul_f32 v182, v44, v131
    v_fma_f32 v180, -v45, v131, v180
    v_fma_f32 v182, v45, v130, v182
    v_mul_f32 v181, v44, v168
    v_mul_f32 v183, v44, v169
    v_fma_f32 v181, -v45, v169, v181
    v_fma_f32 v183, v45, v168, v183
    v_mul_f32 v184, v44, v134
    v_mul_f32 v186, v44, v135
    v_fma_f32 v184, -v45, v135, v184
    v_fma_f32 v186, v45, v134, v186
    v_mul_f32 v185, v44, v170
    v_mul_f32 v187, v44, v171
    v_fma_f32 v185, -v45, v171, v185
    v_fma_f32 v187, v45, v170, v187
    v_lshrrev_b32 v54, 2, v27
    v_lshlrev_b32 v54, 8, v54
    v_and_b32 v55, 3, v27
    v_lshl_add_u32 v54, v55, 4, v54
    v_lshrrev_b32 v55, 5, v26
    v_lshl_add_u32 v54, v55, 6, v54
    v_add_u32 v55, 40960, v54
    s_lshl_b32 s34, s25, 2
    s_lshl_b32 s35, s36, 1
    s_add_u32 s34, s34, s35
    s_mul_i32 s34, s34, 81920
    s_add_u32 s34, s34, 11534336
    s_add_u32 s35, s34, 81920
    v_pk_fma_f32 v[64:65], v[28:29], v[180:181], v[64:65] op_sel_hi:[0,1,1]
    v_pk_fma_f32 v[66:67], v[30:31], v[180:181], v[66:67] op_sel_hi:[0,1,1]
    v_pk_fma_f32 v[68:69], v[32:33], v[180:181], v[68:69] op_sel_hi:[0,1,1]
    v_pk_fma_f32 v[70:71], v[34:35], v[180:181], v[70:71] op_sel_hi:[0,1,1]
    v_pk_fma_f32 v[72:73], v[36:37], v[180:181], v[72:73] op_sel_hi:[0,1,1]
    v_pk_fma_f32 v[74:75], v[38:39], v[180:181], v[74:75] op_sel_hi:[0,1,1]
    v_pk_fma_f32 v[76:77], v[40:41], v[180:181], v[76:77] op_sel_hi:[0,1,1]
    v_pk_fma_f32 v[78:79], v[42:43], v[180:181], v[78:79] op_sel_hi:[0,1,1]
    v_pk_fma_f32 v[64:65], v[28:29], v[182:183], v[64:65] op_sel:[1,0,0] op_sel_hi:[1,1,1] neg_lo:[1,0,0] neg_hi:[1,0,0]
    v_pk_fma_f32 v[66:67], v[30:31], v[182:183], v[66:67] op_sel:[1,0,0] op_sel_hi:[1,1,1] neg_lo:[1,0,0] neg_hi:[1,0,0]
    v_pk_fma_f32 v[68:69], v[32:33], v[182:183], v[68:69] op_sel:[1,0,0] op_sel_hi:[1,1,1] neg_lo:[1,0,0] neg_hi:[1,0,0]
    v_pk_fma_f32 v[70:71], v[34:35], v[182:183], v[70:71] op_sel:[1,0,0] op_sel_hi:[1,1,1] neg_lo:[1,0,0] neg_hi:[1,0,0]
    v_pk_fma_f32 v[72:73], v[36:37], v[182:183], v[72:73] op_sel:[1,0,0] op_sel_hi:[1,1,1] neg_lo:[1,0,0] neg_hi:[1,0,0]
    v_pk_fma_f32 v[74:75], v[38:39], v[182:183], v[74:75] op_sel:[1,0,0] op_sel_hi:[1,1,1] neg_lo:[1,0,0] neg_hi:[1,0,0]
    v_pk_fma_f32 v[76:77], v[40:41], v[182:183], v[76:77] op_sel:[1,0,0] op_sel_hi:[1,1,1] neg_lo:[1,0,0] neg_hi:[1,0,0]
    v_pk_fma_f32 v[78:79], v[42:43], v[182:183], v[78:79] op_sel:[1,0,0] op_sel_hi:[1,1,1] neg_lo:[1,0,0] neg_hi:[1,0,0]
    v_cvt_pk_bf16_f32 v192, v64, v66
    v_cvt_pk_bf16_f32 v193, v68, v70
    v_cvt_pk_bf16_f32 v194, v72, v74
    v_cvt_pk_bf16_f32 v195, v76, v78
    buffer_store_dwordx4 v[192:195], v54, s[16:19], s34 offen offset:0 sc1
    v_cvt_pk_bf16_f32 v200, v65, v67
    v_cvt_pk_bf16_f32 v201, v69, v71
    v_cvt_pk_bf16_f32 v202, v73, v75
    v_cvt_pk_bf16_f32 v203, v77, v79
    buffer_store_dwordx4 v[200:203], v54, s[16:19], s34 offen offset:128 sc1
    v_pk_fma_f32 v[96:97], v[28:29], v[184:185], v[96:97] op_sel_hi:[0,1,1]
    v_pk_fma_f32 v[98:99], v[30:31], v[184:185], v[98:99] op_sel_hi:[0,1,1]
    v_pk_fma_f32 v[100:101], v[32:33], v[184:185], v[100:101] op_sel_hi:[0,1,1]
    v_pk_fma_f32 v[102:103], v[34:35], v[184:185], v[102:103] op_sel_hi:[0,1,1]
    v_pk_fma_f32 v[104:105], v[36:37], v[184:185], v[104:105] op_sel_hi:[0,1,1]
    v_pk_fma_f32 v[106:107], v[38:39], v[184:185], v[106:107] op_sel_hi:[0,1,1]
    v_pk_fma_f32 v[108:109], v[40:41], v[184:185], v[108:109] op_sel_hi:[0,1,1]
    v_pk_fma_f32 v[110:111], v[42:43], v[184:185], v[110:111] op_sel_hi:[0,1,1]
    v_pk_fma_f32 v[96:97], v[28:29], v[186:187], v[96:97] op_sel:[1,0,0] op_sel_hi:[1,1,1] neg_lo:[1,0,0] neg_hi:[1,0,0]
    v_pk_fma_f32 v[98:99], v[30:31], v[186:187], v[98:99] op_sel:[1,0,0] op_sel_hi:[1,1,1] neg_lo:[1,0,0] neg_hi:[1,0,0]
    v_pk_fma_f32 v[100:101], v[32:33], v[186:187], v[100:101] op_sel:[1,0,0] op_sel_hi:[1,1,1] neg_lo:[1,0,0] neg_hi:[1,0,0]
    v_pk_fma_f32 v[102:103], v[34:35], v[186:187], v[102:103] op_sel:[1,0,0] op_sel_hi:[1,1,1] neg_lo:[1,0,0] neg_hi:[1,0,0]
    v_pk_fma_f32 v[104:105], v[36:37], v[186:187], v[104:105] op_sel:[1,0,0] op_sel_hi:[1,1,1] neg_lo:[1,0,0] neg_hi:[1,0,0]
    v_pk_fma_f32 v[106:107], v[38:39], v[186:187], v[106:107] op_sel:[1,0,0] op_sel_hi:[1,1,1] neg_lo:[1,0,0] neg_hi:[1,0,0]
    v_pk_fma_f32 v[108:109], v[40:41], v[186:187], v[108:109] op_sel:[1,0,0] op_sel_hi:[1,1,1] neg_lo:[1,0,0] neg_hi:[1,0,0]
    v_pk_fma_f32 v[110:111], v[42:43], v[186:187], v[110:111] op_sel:[1,0,0] op_sel_hi:[1,1,1] neg_lo:[1,0,0] neg_hi:[1,0,0]
    v_cvt_pk_bf16_f32 v208, v96, v98
    v_cvt_pk_bf16_f32 v209, v100, v102
    v_cvt_pk_bf16_f32 v210, v104, v106
    v_cvt_pk_bf16_f32 v211, v108, v110
    buffer_store_dwordx4 v[208:211], v54, s[16:19], s35 offen offset:0 sc1
    v_cvt_pk_bf16_f32 v216, v97, v99
    v_cvt_pk_bf16_f32 v217, v101, v103
    v_cvt_pk_bf16_f32 v218, v105, v107
    v_cvt_pk_bf16_f32 v219, v109, v111
    buffer_store_dwordx4 v[216:219], v54, s[16:19], s35 offen offset:128 sc1
    s_lshl_b32 s27, s25, 11
    s_lshl_b32 s28, s26, 7
    s_add_u32 s27, s27, s28
    s_add_u32 s27, s27, 17563648
    v_pk_fma_f32 v[80:81], v[28:29], v[182:183], v[80:81] op_sel_hi:[0,1,1]
    v_pk_fma_f32 v[82:83], v[30:31], v[182:183], v[82:83] op_sel_hi:[0,1,1]
    v_pk_fma_f32 v[84:85], v[32:33], v[182:183], v[84:85] op_sel_hi:[0,1,1]
    v_pk_fma_f32 v[86:87], v[34:35], v[182:183], v[86:87] op_sel_hi:[0,1,1]
    v_pk_fma_f32 v[88:89], v[36:37], v[182:183], v[88:89] op_sel_hi:[0,1,1]
    v_pk_fma_f32 v[90:91], v[38:39], v[182:183], v[90:91] op_sel_hi:[0,1,1]
    v_pk_fma_f32 v[92:93], v[40:41], v[182:183], v[92:93] op_sel_hi:[0,1,1]
    v_pk_fma_f32 v[94:95], v[42:43], v[182:183], v[94:95] op_sel_hi:[0,1,1]
    v_pk_fma_f32 v[80:81], v[28:29], v[180:181], v[80:81] op_sel:[1,0,0] op_sel_hi:[1,1,1]
    v_pk_fma_f32 v[82:83], v[30:31], v[180:181], v[82:83] op_sel:[1,0,0] op_sel_hi:[1,1,1]
    v_pk_fma_f32 v[84:85], v[32:33], v[180:181], v[84:85] op_sel:[1,0,0] op_sel_hi:[1,1,1]
    v_pk_fma_f32 v[86:87], v[34:35], v[180:181], v[86:87] op_sel:[1,0,0] op_sel_hi:[1,1,1]
    v_pk_fma_f32 v[88:89], v[36:37], v[180:181], v[88:89] op_sel:[1,0,0] op_sel_hi:[1,1,1]
    v_pk_fma_f32 v[90:91], v[38:39], v[180:181], v[90:91] op_sel:[1,0,0] op_sel_hi:[1,1,1]
    v_pk_fma_f32 v[92:93], v[40:41], v[180:181], v[92:93] op_sel:[1,0,0] op_sel_hi:[1,1,1]
    v_pk_fma_f32 v[94:95], v[42:43], v[180:181], v[94:95] op_sel:[1,0,0] op_sel_hi:[1,1,1]
    v_pk_fma_f32 v[112:113], v[28:29], v[186:187], v[112:113] op_sel_hi:[0,1,1]
    v_pk_fma_f32 v[114:115], v[30:31], v[186:187], v[114:115] op_sel_hi:[0,1,1]
    v_pk_fma_f32 v[116:117], v[32:33], v[186:187], v[116:117] op_sel_hi:[0,1,1]
    v_pk_fma_f32 v[118:119], v[34:35], v[186:187], v[118:119] op_sel_hi:[0,1,1]
    v_pk_fma_f32 v[120:121], v[36:37], v[186:187], v[120:121] op_sel_hi:[0,1,1]
    v_pk_fma_f32 v[122:123], v[38:39], v[186:187], v[122:123] op_sel_hi:[0,1,1]
    v_pk_fma_f32 v[124:125], v[40:41], v[186:187], v[124:125] op_sel_hi:[0,1,1]
    v_pk_fma_f32 v[126:127], v[42:43], v[186:187], v[126:127] op_sel_hi:[0,1,1]
    v_pk_fma_f32 v[112:113], v[28:29], v[184:185], v[112:113] op_sel:[1,0,0] op_sel_hi:[1,1,1]
    v_pk_fma_f32 v[114:115], v[30:31], v[184:185], v[114:115] op_sel:[1,0,0] op_sel_hi:[1,1,1]
    v_pk_fma_f32 v[116:117], v[32:33], v[184:185], v[116:117] op_sel:[1,0,0] op_sel_hi:[1,1,1]
    v_pk_fma_f32 v[118:119], v[34:35], v[184:185], v[118:119] op_sel:[1,0,0] op_sel_hi:[1,1,1]
    v_pk_fma_f32 v[120:121], v[36:37], v[184:185], v[120:121] op_sel:[1,0,0] op_sel_hi:[1,1,1]
    v_pk_fma_f32 v[122:123], v[38:39], v[184:185], v[122:123] op_sel:[1,0,0] op_sel_hi:[1,1,1]
    v_pk_fma_f32 v[124:125], v[40:41], v[184:185], v[124:125] op_sel:[1,0,0] op_sel_hi:[1,1,1]
    v_pk_fma_f32 v[126:127], v[42:43], v[184:185], v[126:127] op_sel:[1,0,0] op_sel_hi:[1,1,1]
    s_waitcnt vmcnt(0)
    s_barrier
    s_cmp_lg_u32 s64, 0
    s_cbranch_scc1 g1_h1
    v_mbcnt_lo_u32_b32 v56, -1, 0
    v_lshl_add_u32 v56, v56, 2, s27
    v_mov_b32 v57, s65
    s_mov_b32 exec_hi, 0
    buffer_store_dword v57, v56, s[16:19], 0 offen sc1
    s_mov_b64 exec, -1
g1_h1:
    v_cvt_pk_bf16_f32 v196, -v80, -v82
    v_cvt_pk_bf16_f32 v197, -v84, -v86
    v_cvt_pk_bf16_f32 v198, -v88, -v90
    v_cvt_pk_bf16_f32 v199, -v92, -v94
    buffer_store_dwordx4 v[196:199], v55, s[16:19], s34 offen offset:0 sc1
    v_cvt_pk_bf16_f32 v204, -v81, -v83
    v_cvt_pk_bf16_f32 v205, -v85, -v87
    v_cvt_pk_bf16_f32 v206, -v89, -v91
    v_cvt_pk_bf16_f32 v207, -v93, -v95
    buffer_store_dwordx4 v[204:207], v55, s[16:19], s34 offen offset:128 sc1
    v_cvt_pk_bf16_f32 v212, -v112, -v114
    v_cvt_pk_bf16_f32 v213, -v116, -v118
    v_cvt_pk_bf16_f32 v214, -v120, -v122
    v_cvt_pk_bf16_f32 v215, -v124, -v126
    buffer_store_dwordx4 v[212:215], v55, s[16:19], s35 offen offset:0 sc1
    v_cvt_pk_bf16_f32 v220, -v113, -v115
    v_cvt_pk_bf16_f32 v221, -v117, -v119
    v_cvt_pk_bf16_f32 v222, -v121, -v123
    v_cvt_pk_bf16_f32 v223, -v125, -v127
    buffer_store_dwordx4 v[220:223], v55, s[16:19], s35 offen offset:128 sc1
    s_lshl_b32 s34, s25, 11
    s_lshl_b32 s35, s26, 7
    s_add_u32 s34, s34, s35
    s_add_u32 s34, s34, 17563648
    s_add_u32 s34, s34, 98304
    s_waitcnt vmcnt(0)
    s_barrier
    s_cmp_lg_u32 s64, 0
    s_cbranch_scc1 g1_end
    v_mbcnt_lo_u32_b32 v54, -1, 0
    v_lshl_add_u32 v54, v54, 2, s34
    v_mov_b32 v55, s65
    s_mov_b32 exec_hi, 0
    buffer_store_dword v55, v54, s[16:19], 0 offen sc1
    s_mov_b64 exec, -1
g1_end:
    s_branch L_a_g4
L_a_g2:
    s_cmp_ge_u32 s60, 10
    s_cbranch_scc1 L_a_end
    s_load_dwordx2 s[40:41], s[0:1], 0
    s_load_dwordx4 s[44:47], s[0:1], 40
    s_load_dwordx2 s[48:49], s[0:1], 96
    s_load_dwordx2 s[54:55], s[0:1], 64
    s_load_dwordx2 s[62:63], s[0:1], 112
    v_mbcnt_lo_u32_b32 v26, -1, 0
    v_mbcnt_hi_u32_b32 v26, -1, v26
    s_and_b32 s31, s66, 7
    s_and_b32 s25, s60, 1
    s_lshr_b32 s26, s60, 1
    s_lshl_b32 s31, s31, 1
    s_add_u32 s25, s25, s31
    s_lshr_b32 s33, s64, 1
    s_and_b32 s34, s64, 1
    v_and_b32 v52, 31, v26
    s_lshl_b32 s31, s26, 7
    s_lshl_b32 s32, s34, 6
    s_add_u32 s31, s31, s32
    v_add_u32 v27, s31, v52
    v_lshlrev_b32 v53, 1, v27
    v_lshlrev_b32 v9, 4, v26
    s_lshl_b32 s31, s25, 2
    s_add_u32 s31, s31, s64
    s_mul_i32 s27, s31, 81920
    s_add_u32 s27, s27, 11534336
    s_mul_i32 s29, s26, 163840
    s_and_b32 s35, s25, 1
    s_mul_i32 s35, s35, 5
    s_lshl_b32 s31, s26, 1
    s_add_u32 s35, s35, s31
    s_cmp_ge_u32 s35, 10
    s_cselect_b32 s31, 10, 0
    s_sub_u32 s35, s35, s31
    s_mov_b32 s36, s35
    s_lshl_b32 s31, s35, 12
    s_add_u32 s27, s27, s31
    s_lshl_b32 s31, s35, 7
    s_add_u32 s29, s29, s31
    s_lshl_b32 s30, s64, 12
    s_mul_i32 s28, s25, 163840
    s_lshl_b32 s31, s26, 8
    s_add_u32 s28, s28, s31
    s_mul_i32 s31, s64, 40960
    v_lshrrev_b32 v48, 3, v26
    v_mul_u32_u24 v48, 1280, v48
    v_add_u32 v48, s31, v48
    v_lshrrev_b32 v49, 4, v26
    v_xor_b32 v49, v49, v26
    v_and_b32 v49, 7, v49
    v_lshlrev_b32 v49, 4, v49
    v_add_u32 v1, v48, v49
    v_xor_b32 v2, 64, v49
    v_add_u32 v2, v48, v2
    v_add_u32 v2, 9216, v2
    v_add_u32 v3, v48, v49
    v_add_u32 v3, 18432, v3
    v_xor_b32 v4, 64, v49
    v_add_u32 v4, v48, v4
    v_add_u32 v4, 27648, v4
    s_waitcnt lgkmcnt(0)
    global_load_ushort v54, v53, s[54:55]
    global_load_ushort v55, v53, s[54:55] offset:64
    s_mov_b32 s8, s40
    s_mov_b32 s9, s41
    s_mov_b32 s10, 2621440
    s_mov_b32 s11, 0x00020000
    s_mov_b32 s12, s44
    s_mov_b32 s13, s45
    s_mov_b32 s14, 819200
    s_mov_b32 s15, 0x00020000
    s_mov_b32 s20, s46
    s_mov_b32 s21, s47
    s_mov_b32 s22, 819200
    s_mov_b32 s23, 0x00020000
    s_mov_b32 s16, s62
    s_mov_b32 s17, s63
    s_mov_b32 s18, 18022400
    s_mov_b32 s19, 0x00020000
    s_lshl_b32 s31, s33, 6
    v_add_u32 v49, s31, v52
    v_lshrrev_b32 v50, 5, v26
    v_lshrrev_b32 v51, 1, v49
    v_xor_b32 v51, v51, v50
    v_and_b32 v51, 7, v51
    v_lshlrev_b32 v51, 4, v51
    v_lshl_add_u32 v10, v49, 7, v51
    v_xor_b32 v11, 32, v10
    v_xor_b32 v12, 64, v10
    v_xor_b32 v13, 96, v10
    v_add_u32 v14, 65536, v10
    v_add_u32 v15, 65536, v11
    v_add_u32 v16, 65536, v12
    v_add_u32 v17, 65536, v13
    s_lshl_b32 s31, s34, 14
    v_add_u32 v10, s31, v10
    v_add_u32 v11, s31, v11
    v_add_u32 v12, s31, v12
    v_add_u32 v13, s31, v13
    v_add_u32 v49, s32, v52
    v_lshrrev_b32 v51, 1, v49
    v_xor_b32 v51, v51, v50
    v_and_b32 v51, 7, v51
    v_lshlrev_b32 v51, 4, v51
    v_lshl_add_u32 v18, v49, 7, v51
    v_xor_b32 v19, 32, v18
    v_xor_b32 v20, 64, v18
    v_xor_b32 v21, 96, v18
    v_add_u32 v22, 65536, v18
    v_add_u32 v23, 65536, v19
    v_add_u32 v24, 65536, v20
    v_add_u32 v25, 65536, v21
    v_lshlrev_b32 v49, 9, v50
    v_bfe_u32 v51, v26, 1, 1
    v_lshl_add_u32 v49, v51, 7, v49
    v_bfe_u32 v51, v26, 4, 1
    v_lshl_add_u32 v49, v51, 6, v49
    v_bfe_u32 v51, v26, 2, 2
    v_lshl_add_u32 v49, v51, 4, v49
    v_and_b32 v51, 1, v26
    v_lshl_add_u32 v49, v51, 3, v49
    s_lshl_b32 s31, s33, 13
    v_add_u32 v44, s31, v49
    v_add_u32 v45, 65536, v44
    v_and_b32 v51, 1, v52
    v_lshlrev_b32 v51, 4, v51
    v_lshrrev_b32 v49, 1, v52
    v_lshlrev_b32 v50, 2, v50
    v_sub_u32 v49, v49, v50
    s_waitcnt vmcnt(0)
    v_lshlrev_b32 v54, v51, v54
    v_lshlrev_b32 v55, v51, v55
    v_cmp_eq_u32 s[40:41], 0, v49
    v_cmp_eq_u32 s[42:43], 1, v49
    v_cmp_eq_u32 s[44:45], 2, v49
    v_cmp_eq_u32 s[46:47], 3, v49
    v_cndmask_b32 v28, 0, v54, s[40:41]
    v_cndmask_b32 v29, 0, v54, s[42:43]
    v_cndmask_b32 v30, 0, v54, s[44:45]
    v_cndmask_b32 v31, 0, v54, s[46:47]
    v_cndmask_b32 v36, 0, v55, s[40:41]
    v_cndmask_b32 v37, 0, v55, s[42:43]
    v_cndmask_b32 v38, 0, v55, s[44:45]
    v_cndmask_b32 v39, 0, v55, s[46:47]
    v_cmp_eq_u32 s[40:41], 8, v49
    v_cmp_eq_u32 s[42:43], 9, v49
    v_cmp_eq_u32 s[44:45], 10, v49
    v_cmp_eq_u32 s[46:47], 11, v49
    v_cndmask_b32 v32, 0, v54, s[40:41]
    v_cndmask_b32 v33, 0, v54, s[42:43]
    v_cndmask_b32 v34, 0, v54, s[44:45]
    v_cndmask_b32 v35, 0, v54, s[46:47]
    v_cndmask_b32 v40, 0, v55, s[40:41]
    v_cndmask_b32 v41, 0, v55, s[42:43]
    v_cndmask_b32 v42, 0, v55, s[44:45]
    v_cndmask_b32 v43, 0, v55, s[46:47]
    v_lshrrev_b32 v48, 5, v26
    v_mul_u32_u24 v48, 20480, v48
    v_lshl_add_u32 v48, v27, 2, v48
    v_add_u32 v49, 5120, v48
    v_add_u32 v50, 10240, v48
    v_add_u32 v51, 15360, v48
    s_mov_b32 s38, 128
    s_add_u32 m0, s30, 0
    s_add_u32 s37, s28, 0
    buffer_load_dwordx4 v1, s[8:11], s37 offen offset:0 lds
    buffer_load_dwordx4 v2, s[8:11], s37 offen offset:1024 lds
    buffer_load_dwordx4 v3, s[8:11], s37 offen offset:2048 lds
    buffer_load_dwordx4 v4, s[8:11], s37 offen offset:3072 lds
    s_add_u32 m0, s30, 16384
    s_add_u32 s37, s28, 128
    buffer_load_dwordx4 v1, s[8:11], s37 offen offset:0 lds
    buffer_load_dwordx4 v2, s[8:11], s37 offen offset:1024 lds
    buffer_load_dwordx4 v3, s[8:11], s37 offen offset:2048 lds
    buffer_load_dwordx4 v4, s[8:11], s37 offen offset:3072 lds
    s_add_u32 m0, s30, 49152
    s_nop 0
    buffer_load_dwordx4 v1, s[12:15], s29 offen offset:0 lds
    buffer_load_dwordx4 v2, s[12:15], s29 offen offset:1024 lds
    buffer_load_dwordx4 v3, s[12:15], s29 offen offset:2048 lds
    buffer_load_dwordx4 v4, s[12:15], s29 offen offset:3072 lds
    s_add_u32 s36, s36, 1
    s_cmp_eq_u32 s36, 10
    s_cselect_b32 s36, 0, s36
    s_cselect_b32 s37, -1152, s38
    s_add_u32 s29, s29, s37
    s_lshl_b32 s31, s25, 11
    s_add_u32 s31, s31, 17563648
    v_min_u32 v56, 9, v26
    v_lshlrev_b32 v56, 7, v56
    v_add_u32 v56, s31, v56
    s_cmp_lg_u32 s64, 0
    s_cbranch_scc1 g2_wait
    v_subrev_u32 v58, s35, v26
    v_add_u32 v59, 10, v58
    v_min_u32 v58, v58, v59
    v_cmp_gt_u32 s[58:59], 3, v58
    s_and_b32 s58, s58, 0x3ff
    s_mov_b32 s59, 0
    s_mov_b32 s67, 20000
g2h_poll:
    buffer_load_dword v57, v56, s[16:19], 0 offen sc1
    s_waitcnt vmcnt(0)
    v_cmp_ne_u32 vcc, s65, v57
    s_and_b64 vcc, vcc, s[58:59]
    s_cbranch_vccz g2h_poll_ok
    s_sleep 2
    s_sub_u32 s67, s67, 1
    s_cmp_lg_u32 s67, 0
    s_cbranch_scc1 g2h_poll
g2h_poll_ok:
g2_wait:
    s_waitcnt vmcnt(0)
    s_barrier
    s_setprio 0
    s_add_u32 m0, s30, 32768
    s_nop 0
    buffer_load_dwordx4 v9, s[16:19], s27 offen offset:0 sc1 lds
    buffer_load_dwordx4 v9, s[16:19], s27 offen offset:1024 sc1 lds
    buffer_load_dwordx4 v9, s[16:19], s27 offen offset:2048 sc1 lds
    buffer_load_dwordx4 v9, s[16:19], s27 offen offset:3072 sc1 lds
    s_add_u32 s35, s35, 1
    s_cmp_eq_u32 s35, 10
    s_cselect_b32 s35, 0, s35
    s_cselect_b32 s37, -1152, s38
    s_lshl_b32 s37, s37, 5
    s_add_u32 s27, s27, s37
    s_add_u32 m0, s30, 65536
    s_nop 0
    buffer_load_dwordx4 v9, s[16:19], s27 offen offset:0 sc1 lds
    buffer_load_dwordx4 v9, s[16:19], s27 offen offset:1024 sc1 lds
    buffer_load_dwordx4 v9, s[16:19], s27 offen offset:2048 sc1 lds
    buffer_load_dwordx4 v9, s[16:19], s27 offen offset:3072 sc1 lds
    s_add_u32 s35, s35, 1
    s_cmp_eq_u32 s35, 10
    s_cselect_b32 s35, 0, s35
    s_cselect_b32 s37, -1152, s38
    s_lshl_b32 s37, s37, 5
    s_add_u32 s27, s27, s37
    s_waitcnt vmcnt(16)
    s_barrier
    ds_read_b128 v[128:131], v10 offset:0
    ds_read_b128 v[132:135], v10 offset:4096
    ds_read_b128 v[136:139], v11 offset:0
    ds_read_b128 v[140:143], v11 offset:4096
    ds_read_b128 v[144:147], v12 offset:0
    ds_read_b128 v[148:151], v12 offset:4096
    ds_read_b128 v[152:155], v13 offset:0
    ds_read_b128 v[156:159], v13 offset:4096
    s_waitcnt vmcnt(12) lgkmcnt(0)
    s_barrier
    s_add_u32 m0, s30, 0
    s_nop 0
    buffer_load_dwordx4 v1, s[12:15], s29 offen offset:0 lds
    buffer_load_dwordx4 v2, s[12:15], s29 offen offset:1024 lds
    buffer_load_dwordx4 v3, s[12:15], s29 offen offset:2048 lds
    buffer_load_dwordx4 v4, s[12:15], s29 offen offset:3072 lds
    s_add_u32 s36, s36, 1
    s_cmp_eq_u32 s36, 10
    s_cselect_b32 s36, 0, s36
    s_cselect_b32 s37, -1152, s38
    s_add_u32 s29, s29, s37
    s_cmp_lg_u32 s64, 0
    s_cbranch_scc1 g2_p0
    buffer_load_dword v57, v56, s[16:19], 0 offen sc1
g2_p0:
    s_waitcnt vmcnt(8) lgkmcnt(0)
    s_barrier
    v_mfma_f32_32x32x16_bf16 v[64:79], v[128:131], v[28:31], 0
    s_add_u32 m0, s30, 16384
    s_nop 0
    ds_read_b64_tr_b16 v[192:193], v44 offset:32768
    ds_read_b64_tr_b16 v[194:195], v44 offset:33024
    ds_read_b64_tr_b16 v[196:197], v44 offset:36864
    ds_read_b64_tr_b16 v[198:199], v44 offset:37120
    ds_read_b64_tr_b16 v[200:201], v44 offset:33792
    ds_read_b64_tr_b16 v[202:203], v44 offset:34048
    ds_read_b64_tr_b16 v[204:205], v44 offset:37888
    ds_read_b64_tr_b16 v[206:207], v44 offset:38144
    buffer_load_dwordx4 v9, s[16:19], s27 offen offset:0 sc1 lds
    v_mfma_f32_32x32x16_bf16 v[96:111], v[132:135], v[28:31], 0
    ds_read_b64_tr_b16 v[208:209], v44 offset:34816
    ds_read_b64_tr_b16 v[210:211], v44 offset:35072
    ds_read_b64_tr_b16 v[212:213], v44 offset:38912
    ds_read_b64_tr_b16 v[214:215], v44 offset:39168
    ds_read_b64_tr_b16 v[216:217], v44 offset:35840
    ds_read_b64_tr_b16 v[218:219], v44 offset:36096
    ds_read_b64_tr_b16 v[220:221], v44 offset:39936
    ds_read_b64_tr_b16 v[222:223], v44 offset:40192
    buffer_load_dwordx4 v9, s[16:19], s27 offen offset:1024 sc1 lds
    v_mfma_f32_32x32x16_bf16 v[64:79], v[136:139], v[32:35], v[64:79]
    buffer_load_dwordx4 v9, s[16:19], s27 offen offset:2048 sc1 lds
    v_mfma_f32_32x32x16_bf16 v[96:111], v[140:143], v[32:35], v[96:111]
    buffer_load_dwordx4 v9, s[16:19], s27 offen offset:3072 sc1 lds
    s_add_u32 s35, s35, 1
    s_cmp_eq_u32 s35, 10
    s_cselect_b32 s35, 0, s35
    s_cselect_b32 s37, -1152, s38
    s_lshl_b32 s37, s37, 5
    s_add_u32 s27, s27, s37
    s_waitcnt vmcnt(16) lgkmcnt(0)
    s_barrier
    v_mfma_f32_32x32x16_bf16 v[80:95], v[144:147], v[36:39], 0
    s_add_u32 m0, s30, 32768
    s_nop 0
    ds_read_b128 v[224:227], v18 offset:49152
    ds_read_b128 v[228:231], v18 offset:53248
    ds_read_b128 v[232:235], v19 offset:49152
    ds_read_b128 v[236:239], v19 offset:53248
    buffer_load_dwordx4 v1, s[12:15], s29 offen offset:0 lds
    v_mfma_f32_32x32x16_bf16 v[112:127], v[148:151], v[36:39], 0
    ds_read_b128 v[240:243], v20 offset:49152
    ds_read_b128 v[244:247], v20 offset:53248
    ds_read_b128 v[248:251], v21 offset:49152
    ds_read_b128 v[252:255], v21 offset:53248
    buffer_load_dwordx4 v2, s[12:15], s29 offen offset:1024 lds
    v_mfma_f32_32x32x16_bf16 v[80:95], v[152:155], v[40:43], v[80:95]
    buffer_load_dwordx4 v3, s[12:15], s29 offen offset:2048 lds
    v_mfma_f32_32x32x16_bf16 v[112:127], v[156:159], v[40:43], v[112:127]
    buffer_load_dwordx4 v4, s[12:15], s29 offen offset:3072 lds
    s_add_u32 s36, s36, 1
    s_cmp_eq_u32 s36, 10
    s_cselect_b32 s36, 0, s36
    s_cselect_b32 s37, -1152, s38
    s_add_u32 s29, s29, s37
    s_cmp_lg_u32 s64, 0
    s_cbranch_scc1 g2_p1
    s_waitcnt vmcnt(8)
    v_cmp_ne_u32 vcc, s65, v57
    s_nop 4
    s_cbranch_vccz g2_p1
    s_mov_b32 s67, 20000
g2p_poll:
    buffer_load_dword v57, v56, s[16:19], 0 offen sc1
    s_waitcnt vmcnt(0)
    v_cmp_ne_u32 vcc, s65, v57
    s_nop 4
    s_cbranch_vccz g2p_poll_ok
    s_sleep 1
    s_sub_u32 s67, s67, 1
    s_cmp_lg_u32 s67, 0
    s_cbranch_scc1 g2p_poll
g2p_poll_ok:
g2_p1:
    s_waitcnt vmcnt(12) lgkmcnt(0)
    s_barrier
    v_mfma_f32_32x32x16_bf16 v[64:79], v[192:195], v[224:227], v[64:79]
    s_add_u32 m0, s30, 49152
    s_nop 0
    ds_read_b64_tr_b16 v[128:129], v45 offset:0
    ds_read_b64_tr_b16 v[130:131], v45 offset:256
    ds_read_b64_tr_b16 v[132:133], v45 offset:4096
    buffer_load_dwordx4 v9, s[16:19], s27 offen offset:0 sc1 lds
    v_mfma_f32_32x32x16_bf16 v[80:95], v[192:195], v[228:231], v[80:95]
    ds_read_b64_tr_b16 v[134:135], v45 offset:4352
    ds_read_b64_tr_b16 v[136:137], v45 offset:1024
    ds_read_b64_tr_b16 v[138:139], v45 offset:1280
    buffer_load_dwordx4 v9, s[16:19], s27 offen offset:1024 sc1 lds
    v_mfma_f32_32x32x16_bf16 v[96:111], v[196:199], v[224:227], v[96:111]
    ds_read_b64_tr_b16 v[140:141], v45 offset:5120
    ds_read_b64_tr_b16 v[142:143], v45 offset:5376
    ds_read_b64_tr_b16 v[144:145], v45 offset:2048
    buffer_load_dwordx4 v9, s[16:19], s27 offen offset:2048 sc1 lds
    v_mfma_f32_32x32x16_bf16 v[112:127], v[196:199], v[228:231], v[112:127]
    ds_read_b64_tr_b16 v[146:147], v45 offset:2304
    ds_read_b64_tr_b16 v[148:149], v45 offset:6144
    ds_read_b64_tr_b16 v[150:151], v45 offset:6400
    buffer_load_dwordx4 v9, s[16:19], s27 offen offset:3072 sc1 lds
    s_add_u32 s35, s35, 1
    s_cmp_eq_u32 s35, 10
    s_cselect_b32 s35, 0, s35
    s_cselect_b32 s37, -1152, s38
    s_lshl_b32 s37, s37, 5
    s_add_u32 s27, s27, s37
    v_mfma_f32_32x32x16_bf16 v[64:79], v[200:203], v[232:235], v[64:79]
    ds_read_b64_tr_b16 v[152:153], v45 offset:3072
    ds_read_b64_tr_b16 v[154:155], v45 offset:3328
    ds_read_b64_tr_b16 v[156:157], v45 offset:7168
    v_mfma_f32_32x32x16_bf16 v[80:95], v[200:203], v[236:239], v[80:95]
    ds_read_b64_tr_b16 v[158:159], v45 offset:7424
    v_mfma_f32_32x32x16_bf16 v[96:111], v[204:207], v[232:235], v[96:111]
    v_mfma_f32_32x32x16_bf16 v[112:127], v[204:207], v[236:239], v[112:127]
    s_waitcnt vmcnt(12) lgkmcnt(0)
    s_barrier
    v_mfma_f32_32x32x16_bf16 v[64:79], v[208:211], v[240:243], v[64:79]
    s_add_u32 m0, s30, 65536
    s_nop 0
    ds_read_b128 v[160:163], v18 offset:0
    ds_read_b128 v[164:167], v18 offset:4096
    buffer_load_dwordx4 v1, s[12:15], s29 offen offset:0 lds
    v_mfma_f32_32x32x16_bf16 v[80:95], v[208:211], v[244:247], v[80:95]
    ds_read_b128 v[168:171], v19 offset:0
    ds_read_b128 v[172:175], v19 offset:4096
    buffer_load_dwordx4 v2, s[12:15], s29 offen offset:1024 lds
    v_mfma_f32_32x32x16_bf16 v[96:111], v[212:215], v[240:243], v[96:111]
    ds_read_b128 v[176:179], v20 offset:0
    ds_read_b128 v[180:183], v20 offset:4096
    buffer_load_dwordx4 v3, s[12:15], s29 offen offset:2048 lds
    v_mfma_f32_32x32x16_bf16 v[112:127], v[212:215], v[244:247], v[112:127]
    ds_read_b128 v[184:187], v21 offset:0
    ds_read_b128 v[188:191], v21 offset:4096
    buffer_load_dwordx4 v4, s[12:15], s29 offen offset:3072 lds
    s_add_u32 s36, s36, 1
    s_cmp_eq_u32 s36, 10
    s_cselect_b32 s36, 0, s36
    s_cselect_b32 s37, -1152, s38
    s_add_u32 s29, s29, s37
    v_mfma_f32_32x32x16_bf16 v[64:79], v[216:219], v[248:251], v[64:79]
    v_mfma_f32_32x32x16_bf16 v[80:95], v[216:219], v[252:255], v[80:95]
    v_mfma_f32_32x32x16_bf16 v[96:111], v[220:223], v[248:251], v[96:111]
    v_mfma_f32_32x32x16_bf16 v[112:127], v[220:223], v[252:255], v[112:127]
    s_waitcnt vmcnt(12) lgkmcnt(0)
    s_barrier
    v_mfma_f32_32x32x16_bf16 v[64:79], v[128:131], v[160:163], v[64:79]
    s_add_u32 m0, s30, 0
    s_nop 0
    ds_read_b64_tr_b16 v[192:193], v44 offset:16384
    ds_read_b64_tr_b16 v[194:195], v44 offset:16640
    ds_read_b64_tr_b16 v[196:197], v44 offset:20480
    buffer_load_dwordx4 v9, s[16:19], s27 offen offset:0 sc1 lds
    v_mfma_f32_32x32x16_bf16 v[80:95], v[128:131], v[164:167], v[80:95]
    ds_read_b64_tr_b16 v[198:199], v44 offset:20736
    ds_read_b64_tr_b16 v[200:201], v44 offset:17408
    ds_read_b64_tr_b16 v[202:203], v44 offset:17664
    buffer_load_dwordx4 v9, s[16:19], s27 offen offset:1024 sc1 lds
    v_mfma_f32_32x32x16_bf16 v[96:111], v[132:135], v[160:163], v[96:111]
    ds_read_b64_tr_b16 v[204:205], v44 offset:21504
    ds_read_b64_tr_b16 v[206:207], v44 offset:21760
    ds_read_b64_tr_b16 v[208:209], v44 offset:18432
    buffer_load_dwordx4 v9, s[16:19], s27 offen offset:2048 sc1 lds
    v_mfma_f32_32x32x16_bf16 v[112:127], v[132:135], v[164:167], v[112:127]
    ds_read_b64_tr_b16 v[210:211], v44 offset:18688
    ds_read_b64_tr_b16 v[212:213], v44 offset:22528
    ds_read_b64_tr_b16 v[214:215], v44 offset:22784
    buffer_load_dwordx4 v9, s[16:19], s27 offen offset:3072 sc1 lds
    s_add_u32 s35, s35, 1
    s_cmp_eq_u32 s35, 10
    s_cselect_b32 s35, 0, s35
    s_cselect_b32 s37, -1152, s38
    s_lshl_b32 s37, s37, 5
    s_add_u32 s27, s27, s37
    v_mfma_f32_32x32x16_bf16 v[64:79], v[136:139], v[168:171], v[64:79]
    ds_read_b64_tr_b16 v[216:217], v44 offset:19456
    ds_read_b64_tr_b16 v[218:219], v44 offset:19712
    ds_read_b64_tr_b16 v[220:221], v44 offset:23552
    v_mfma_f32_32x32x16_bf16 v[80:95], v[136:139], v[172:175], v[80:95]
    ds_read_b64_tr_b16 v[222:223], v44 offset:23808
    v_mfma_f32_32x32x16_bf16 v[96:111], v[140:143], v[168:171], v[96:111]
    v_mfma_f32_32x32x16_bf16 v[112:127], v[140:143], v[172:175], v[112:127]
    s_waitcnt vmcnt(12) lgkmcnt(0)
    s_barrier
    v_mfma_f32_32x32x16_bf16 v[64:79], v[144:147], v[176:179], v[64:79]
    s_add_u32 m0, s30, 16384
    s_nop 0
    ds_read_b128 v[224:227], v18 offset:32768
    ds_read_b128 v[228:231], v18 offset:36864
    buffer_load_dwordx4 v1, s[12:15], s29 offen offset:0 lds
    v_mfma_f32_32x32x16_bf16 v[80:95], v[144:147], v[180:183], v[80:95]
    ds_read_b128 v[232:235], v19 offset:32768
    ds_read_b128 v[236:239], v19 offset:36864
    buffer_load_dwordx4 v2, s[12:15], s29 offen offset:1024 lds
    v_mfma_f32_32x32x16_bf16 v[96:111], v[148:151], v[176:179], v[96:111]
    ds_read_b128 v[240:243], v20 offset:32768
    ds_read_b128 v[244:247], v20 offset:36864
    buffer_load_dwordx4 v3, s[12:15], s29 offen offset:2048 lds
    v_mfma_f32_32x32x16_bf16 v[112:127], v[148:151], v[180:183], v[112:127]
    ds_read_b128 v[248:251], v21 offset:32768
    ds_read_b128 v[252:255], v21 offset:36864
    buffer_load_dwordx4 v4, s[12:15], s29 offen offset:3072 lds
    s_add_u32 s36, s36, 1
    s_cmp_eq_u32 s36, 10
    s_cselect_b32 s36, 0, s36
    s_cselect_b32 s37, -1152, s38
    s_add_u32 s29, s29, s37
    v_mfma_f32_32x32x16_bf16 v[64:79], v[152:155], v[184:187], v[64:79]
    v_mfma_f32_32x32x16_bf16 v[80:95], v[152:155], v[188:191], v[80:95]
    v_mfma_f32_32x32x16_bf16 v[96:111], v[156:159], v[184:187], v[96:111]
    v_mfma_f32_32x32x16_bf16 v[112:127], v[156:159], v[188:191], v[112:127]
    s_waitcnt vmcnt(12) lgkmcnt(0)
    s_barrier
    v_mfma_f32_32x32x16_bf16 v[64:79], v[192:195], v[224:227], v[64:79]
    s_add_u32 m0, s30, 32768
    s_nop 0
    ds_read_b64_tr_b16 v[128:129], v44 offset:49152
    ds_read_b64_tr_b16 v[130:131], v44 offset:49408
    ds_read_b64_tr_b16 v[132:133], v44 offset:53248
    buffer_load_dwordx4 v9, s[16:19], s27 offen offset:0 sc1 lds
    v_mfma_f32_32x32x16_bf16 v[80:95], v[192:195], v[228:231], v[80:95]
    ds_read_b64_tr_b16 v[134:135], v44 offset:53504
    ds_read_b64_tr_b16 v[136:137], v44 offset:50176
    ds_read_b64_tr_b16 v[138:139], v44 offset:50432
    buffer_load_dwordx4 v9, s[16:19], s27 offen offset:1024 sc1 lds
    v_mfma_f32_32x32x16_bf16 v[96:111], v[196:199], v[224:227], v[96:111]
    ds_read_b64_tr_b16 v[140:141], v44 offset:54272
    ds_read_b64_tr_b16 v[142:143], v44 offset:54528
    ds_read_b64_tr_b16 v[144:145], v44 offset:51200
    buffer_load_dwordx4 v9, s[16:19], s27 offen offset:2048 sc1 lds
    v_mfma_f32_32x32x16_bf16 v[112:127], v[196:199], v[228:231], v[112:127]
    ds_read_b64_tr_b16 v[146:147], v44 offset:51456
    ds_read_b64_tr_b16 v[148:149], v44 offset:55296
    ds_read_b64_tr_b16 v[150:151], v44 offset:55552
    buffer_load_dwordx4 v9, s[16:19], s27 offen offset:3072 sc1 lds
    s_add_u32 s35, s35, 1
    s_cmp_eq_u32 s35, 10
    s_cselect_b32 s35, 0, s35
    s_cselect_b32 s37, -1152, s38
    s_lshl_b32 s37, s37, 5
    s_add_u32 s27, s27, s37
    v_mfma_f32_32x32x16_bf16 v[64:79], v[200:203], v[232:235], v[64:79]
    ds_read_b64_tr_b16 v[152:153], v44 offset:52224
    ds_read_b64_tr_b16 v[154:155], v44 offset:52480
    ds_read_b64_tr_b16 v[156:157], v44 offset:56320
    v_mfma_f32_32x32x16_bf16 v[80:95], v[200:203], v[236:239], v[80:95]
    ds_read_b64_tr_b16 v[158:159], v44 offset:56576
    v_mfma_f32_32x32x16_bf16 v[96:111], v[204:207], v[232:235], v[96:111]
    v_mfma_f32_32x32x16_bf16 v[112:127], v[204:207], v[236:239], v[112:127]
    s_waitcnt vmcnt(12) lgkmcnt(0)
    s_barrier
    v_mfma_f32_32x32x16_bf16 v[64:79], v[208:211], v[240:243], v[64:79]
    s_add_u32 m0, s30, 49152
    s_nop 0
    ds_read_b128 v[160:163], v22 offset:0
    ds_read_b128 v[164:167], v22 offset:4096
    buffer_load_dwordx4 v1, s[12:15], s29 offen offset:0 lds
    v_mfma_f32_32x32x16_bf16 v[80:95], v[208:211], v[244:247], v[80:95]
    ds_read_b128 v[168:171], v23 offset:0
    ds_read_b128 v[172:175], v23 offset:4096
    buffer_load_dwordx4 v2, s[12:15], s29 offen offset:1024 lds
    v_mfma_f32_32x32x16_bf16 v[96:111], v[212:215], v[240:243], v[96:111]
    ds_read_b128 v[176:179], v24 offset:0
    ds_read_b128 v[180:183], v24 offset:4096
    buffer_load_dwordx4 v3, s[12:15], s29 offen offset:2048 lds
    v_mfma_f32_32x32x16_bf16 v[112:127], v[212:215], v[244:247], v[112:127]
    ds_read_b128 v[184:187], v25 offset:0
    ds_read_b128 v[188:191], v25 offset:4096
    buffer_load_dwordx4 v4, s[12:15], s29 offen offset:3072 lds
    s_add_u32 s36, s36, 1
    s_cmp_eq_u32 s36, 10
    s_cselect_b32 s36, 0, s36
    s_cselect_b32 s37, -1152, s38
    s_add_u32 s29, s29, s37
    v_mfma_f32_32x32x16_bf16 v[64:79], v[216:219], v[248:251], v[64:79]
    v_mfma_f32_32x32x16_bf16 v[80:95], v[216:219], v[252:255], v[80:95]
    v_mfma_f32_32x32x16_bf16 v[96:111], v[220:223], v[248:251], v[96:111]
    v_mfma_f32_32x32x16_bf16 v[112:127], v[220:223], v[252:255], v[112:127]
    s_waitcnt vmcnt(12) lgkmcnt(0)
    s_barrier
    v_mfma_f32_32x32x16_bf16 v[64:79], v[128:131], v[160:163], v[64:79]
    s_add_u32 m0, s30, 65536
    s_nop 0
    ds_read_b64_tr_b16 v[192:193], v44 offset:0
    ds_read_b64_tr_b16 v[194:195], v44 offset:256
    ds_read_b64_tr_b16 v[196:197], v44 offset:4096
    buffer_load_dwordx4 v9, s[16:19], s27 offen offset:0 sc1 lds
    v_mfma_f32_32x32x16_bf16 v[80:95], v[128:131], v[164:167], v[80:95]
    ds_read_b64_tr_b16 v[198:199], v44 offset:4352
    ds_read_b64_tr_b16 v[200:201], v44 offset:1024
    ds_read_b64_tr_b16 v[202:203], v44 offset:1280
    buffer_load_dwordx4 v9, s[16:19], s27 offen offset:1024 sc1 lds
    v_mfma_f32_32x32x16_bf16 v[96:111], v[132:135], v[160:163], v[96:111]
    ds_read_b64_tr_b16 v[204:205], v44 offset:5120
    ds_read_b64_tr_b16 v[206:207], v44 offset:5376
    ds_read_b64_tr_b16 v[208:209], v44 offset:2048
    buffer_load_dwordx4 v9, s[16:19], s27 offen offset:2048 sc1 lds
    v_mfma_f32_32x32x16_bf16 v[112:127], v[132:135], v[164:167], v[112:127]
    ds_read_b64_tr_b16 v[210:211], v44 offset:2304
    ds_read_b64_tr_b16 v[212:213], v44 offset:6144
    ds_read_b64_tr_b16 v[214:215], v44 offset:6400
    buffer_load_dwordx4 v9, s[16:19], s27 offen offset:3072 sc1 lds
    s_add_u32 s35, s35, 1
    s_cmp_eq_u32 s35, 10
    s_cselect_b32 s35, 0, s35
    s_cselect_b32 s37, -1152, s38
    s_lshl_b32 s37, s37, 5
    s_add_u32 s27, s27, s37
    v_mfma_f32_32x32x16_bf16 v[64:79], v[136:139], v[168:171], v[64:79]
    ds_read_b64_tr_b16 v[216:217], v44 offset:3072
    ds_read_b64_tr_b16 v[218:219], v44 offset:3328
    ds_read_b64_tr_b16 v[220:221], v44 offset:7168
    v_mfma_f32_32x32x16_bf16 v[80:95], v[136:139], v[172:175], v[80:95]
    ds_read_b64_tr_b16 v[222:223], v44 offset:7424
    v_mfma_f32_32x32x16_bf16 v[96:111], v[140:143], v[168:171], v[96:111]
    v_mfma_f32_32x32x16_bf16 v[112:127], v[140:143], v[172:175], v[112:127]
    s_waitcnt vmcnt(12) lgkmcnt(0)
    s_barrier
    v_mfma_f32_32x32x16_bf16 v[64:79], v[144:147], v[176:179], v[64:79]
    s_add_u32 m0, s30, 0
    s_nop 0
    ds_read_b128 v[224:227], v18 offset:16384
    ds_read_b128 v[228:231], v18 offset:20480
    buffer_load_dwordx4 v1, s[12:15], s29 offen offset:0 lds
    v_mfma_f32_32x32x16_bf16 v[80:95], v[144:147], v[180:183], v[80:95]
    ds_read_b128 v[232:235], v19 offset:16384
    ds_read_b128 v[236:239], v19 offset:20480
    buffer_load_dwordx4 v2, s[12:15], s29 offen offset:1024 lds
    v_mfma_f32_32x32x16_bf16 v[96:111], v[148:151], v[176:179], v[96:111]
    ds_read_b128 v[240:243], v20 offset:16384
    ds_read_b128 v[244:247], v20 offset:20480
    buffer_load_dwordx4 v3, s[12:15], s29 offen offset:2048 lds
    v_mfma_f32_32x32x16_bf16 v[112:127], v[148:151], v[180:183], v[112:127]
    ds_read_b128 v[248:251], v21 offset:16384
    ds_read_b128 v[252:255], v21 offset:20480
    buffer_load_dwordx4 v4, s[12:15], s29 offen offset:3072 lds
    s_add_u32 s36, s36, 1
    s_cmp_eq_u32 s36, 10
    s_cselect_b32 s36, 0, s36
    s_cselect_b32 s37, -1152, s38
    s_add_u32 s29, s29, s37
    v_mfma_f32_32x32x16_bf16 v[64:79], v[152:155], v[184:187], v[64:79]
    v_mfma_f32_32x32x16_bf16 v[80:95], v[152:155], v[188:191], v[80:95]
    v_mfma_f32_32x32x16_bf16 v[96:111], v[156:159], v[184:187], v[96:111]
    v_mfma_f32_32x32x16_bf16 v[112:127], v[156:159], v[188:191], v[112:127]
    s_cmp_lg_u32 s64, 0
    s_cbranch_scc1 g2_i0
    v_add_u32 v56, 98304, v56
    buffer_load_dword v57, v56, s[16:19], 0 offen sc1
g2_i0:
    s_waitcnt vmcnt(12) lgkmcnt(0)
    s_barrier
    v_mfma_f32_32x32x16_bf16 v[64:79], v[192:195], v[224:227], v[64:79]
    s_add_u32 m0, s30, 16384
    s_nop 0
    ds_read_b64_tr_b16 v[128:129], v44 offset:32768
    ds_read_b64_tr_b16 v[130:131], v44 offset:33024
    ds_read_b64_tr_b16 v[132:133], v44 offset:36864
    buffer_load_dwordx4 v9, s[16:19], s27 offen offset:0 sc1 lds
    v_mfma_f32_32x32x16_bf16 v[80:95], v[192:195], v[228:231], v[80:95]
    ds_read_b64_tr_b16 v[134:135], v44 offset:37120
    ds_read_b64_tr_b16 v[136:137], v44 offset:33792
    ds_read_b64_tr_b16 v[138:139], v44 offset:34048
    buffer_load_dwordx4 v9, s[16:19], s27 offen offset:1024 sc1 lds
    v_mfma_f32_32x32x16_bf16 v[96:111], v[196:199], v[224:227], v[96:111]
    ds_read_b64_tr_b16 v[140:141], v44 offset:37888
    ds_read_b64_tr_b16 v[142:143], v44 offset:38144
    ds_read_b64_tr_b16 v[144:145], v44 offset:34816
    buffer_load_dwordx4 v9, s[16:19], s27 offen offset:2048 sc1 lds
    v_mfma_f32_32x32x16_bf16 v[112:127], v[196:199], v[228:231], v[112:127]
    ds_read_b64_tr_b16 v[146:147], v44 offset:35072
    ds_read_b64_tr_b16 v[148:149], v44 offset:38912
    ds_read_b64_tr_b16 v[150:151], v44 offset:39168
    buffer_load_dwordx4 v9, s[16:19], s27 offen offset:3072 sc1 lds
    s_add_u32 s35, s35, 1
    s_cmp_eq_u32 s35, 10
    s_cselect_b32 s35, 0, s35
    s_cselect_b32 s37, -1152, s38
    s_lshl_b32 s37, s37, 5
    s_add_u32 s27, s27, s37
    v_mfma_f32_32x32x16_bf16 v[64:79], v[200:203], v[232:235], v[64:79]
    ds_read_b64_tr_b16 v[152:153], v44 offset:35840
    ds_read_b64_tr_b16 v[154:155], v44 offset:36096
    ds_read_b64_tr_b16 v[156:157], v44 offset:39936
    v_mfma_f32_32x32x16_bf16 v[80:95], v[200:203], v[236:239], v[80:95]
    ds_read_b64_tr_b16 v[158:159], v44 offset:40192
    v_mfma_f32_32x32x16_bf16 v[96:111], v[204:207], v[232:235], v[96:111]
    v_mfma_f32_32x32x16_bf16 v[112:127], v[204:207], v[236:239], v[112:127]
    s_waitcnt vmcnt(12) lgkmcnt(0)
    s_barrier
    v_mfma_f32_32x32x16_bf16 v[64:79], v[208:211], v[240:243], v[64:79]
    s_add_u32 m0, s30, 32768
    s_nop 0
    ds_read_b128 v[160:163], v18 offset:49152
    ds_read_b128 v[164:167], v18 offset:53248
    buffer_load_dwordx4 v1, s[12:15], s29 offen offset:0 lds
    v_mfma_f32_32x32x16_bf16 v[80:95], v[208:211], v[244:247], v[80:95]
    ds_read_b128 v[168:171], v19 offset:49152
    ds_read_b128 v[172:175], v19 offset:53248
    buffer_load_dwordx4 v2, s[12:15], s29 offen offset:1024 lds
    v_mfma_f32_32x32x16_bf16 v[96:111], v[212:215], v[240:243], v[96:111]
    ds_read_b128 v[176:179], v20 offset:49152
    ds_read_b128 v[180:183], v20 offset:53248
    buffer_load_dwordx4 v3, s[12:15], s29 offen offset:2048 lds
    v_mfma_f32_32x32x16_bf16 v[112:127], v[212:215], v[244:247], v[112:127]
    ds_read_b128 v[184:187], v21 offset:49152
    ds_read_b128 v[188:191], v21 offset:53248
    buffer_load_dwordx4 v4, s[12:15], s29 offen offset:3072 lds
    s_add_u32 s36, s36, 1
    s_cmp_eq_u32 s36, 10
    s_cselect_b32 s36, 0, s36
    s_cselect_b32 s37, -1152, s38
    s_add_u32 s29, s29, s37
    v_mfma_f32_32x32x16_bf16 v[64:79], v[216:219], v[248:251], v[64:79]
    v_mfma_f32_32x32x16_bf16 v[80:95], v[216:219], v[252:255], v[80:95]
    v_mfma_f32_32x32x16_bf16 v[96:111], v[220:223], v[248:251], v[96:111]
    v_mfma_f32_32x32x16_bf16 v[112:127], v[220:223], v[252:255], v[112:127]
    s_waitcnt vmcnt(12) lgkmcnt(0)
    s_barrier
    v_mfma_f32_32x32x16_bf16 v[64:79], v[128:131], v[160:163], v[64:79]
    s_add_u32 m0, s30, 49152
    s_nop 0
    ds_read_b64_tr_b16 v[192:193], v45 offset:0
    ds_read_b64_tr_b16 v[194:195], v45 offset:256
    ds_read_b64_tr_b16 v[196:197], v45 offset:4096
    buffer_load_dwordx4 v9, s[16:19], s27 offen offset:0 sc1 lds
    v_mfma_f32_32x32x16_bf16 v[80:95], v[128:131], v[164:167], v[80:95]
    ds_read_b64_tr_b16 v[198:199], v45 offset:4352
    ds_read_b64_tr_b16 v[200:201], v45 offset:1024
    ds_read_b64_tr_b16 v[202:203], v45 offset:1280
    buffer_load_dwordx4 v9, s[16:19], s27 offen offset:1024 sc1 lds
    v_mfma_f32_32x32x16_bf16 v[96:111], v[132:135], v[160:163], v[96:111]
    ds_read_b64_tr_b16 v[204:205], v45 offset:5120
    ds_read_b64_tr_b16 v[206:207], v45 offset:5376
    ds_read_b64_tr_b16 v[208:209], v45 offset:2048
    buffer_load_dwordx4 v9, s[16:19], s27 offen offset:2048 sc1 lds
    v_mfma_f32_32x32x16_bf16 v[112:127], v[132:135], v[164:167], v[112:127]
    ds_read_b64_tr_b16 v[210:211], v45 offset:2304
    ds_read_b64_tr_b16 v[212:213], v45 offset:6144
    ds_read_b64_tr_b16 v[214:215], v45 offset:6400
    buffer_load_dwordx4 v9, s[16:19], s27 offen offset:3072 sc1 lds
    s_add_u32 s35, s35, 1
    s_cmp_eq_u32 s35, 10
    s_cselect_b32 s35, 0, s35
    s_cselect_b32 s37, -1152, s38
    s_lshl_b32 s37, s37, 5
    s_add_u32 s27, s27, s37
    v_mfma_f32_32x32x16_bf16 v[64:79], v[136:139], v[168:171], v[64:79]
    ds_read_b64_tr_b16 v[216:217], v45 offset:3072
    ds_read_b64_tr_b16 v[218:219], v45 offset:3328
    ds_read_b64_tr_b16 v[220:221], v45 offset:7168
    v_mfma_f32_32x32x16_bf16 v[80:95], v[136:139], v[172:175], v[80:95]
    ds_read_b64_tr_b16 v[222:223], v45 offset:7424
    v_mfma_f32_32x32x16_bf16 v[96:111], v[140:143], v[168:171], v[96:111]
    v_mfma_f32_32x32x16_bf16 v[112:127], v[140:143], v[172:175], v[112:127]
    s_waitcnt vmcnt(12) lgkmcnt(0)
    s_barrier
    v_mfma_f32_32x32x16_bf16 v[64:79], v[144:147], v[176:179], v[64:79]
    s_add_u32 m0, s30, 65536
    s_nop 0
    ds_read_b128 v[224:227], v18 offset:0
    ds_read_b128 v[228:231], v18 offset:4096
    buffer_load_dwordx4 v1, s[12:15], s29 offen offset:0 lds
    v_mfma_f32_32x32x16_bf16 v[80:95], v[144:147], v[180:183], v[80:95]
    ds_read_b128 v[232:235], v19 offset:0
    ds_read_b128 v[236:239], v19 offset:4096
    buffer_load_dwordx4 v2, s[12:15], s29 offen offset:1024 lds
    v_mfma_f32_32x32x16_bf16 v[96:111], v[148:151], v[176:179], v[96:111]
    ds_read_b128 v[240:243], v20 offset:0
    ds_read_b128 v[244:247], v20 offset:4096
    buffer_load_dwordx4 v3, s[12:15], s29 offen offset:2048 lds
    v_mfma_f32_32x32x16_bf16 v[112:127], v[148:151], v[180:183], v[112:127]
    ds_read_b128 v[248:251], v21 offset:0
    ds_read_b128 v[252:255], v21 offset:4096
    buffer_load_dwordx4 v4, s[12:15], s29 offen offset:3072 lds
    s_add_u32 s36, s36, 1
    s_cmp_eq_u32 s36, 10
    s_cselect_b32 s36, 0, s36
    s_cselect_b32 s37, -1152, s38
    s_add_u32 s29, s29, s37
    v_mfma_f32_32x32x16_bf16 v[64:79], v[152:155], v[184:187], v[64:79]
    v_mfma_f32_32x32x16_bf16 v[80:95], v[152:155], v[188:191], v[80:95]
    v_mfma_f32_32x32x16_bf16 v[96:111], v[156:159], v[184:187], v[96:111]
    v_mfma_f32_32x32x16_bf16 v[112:127], v[156:159], v[188:191], v[112:127]
    s_waitcnt vmcnt(12) lgkmcnt(0)
    s_barrier
    v_mfma_f32_32x32x16_bf16 v[64:79], v[192:195], v[224:227], v[64:79]
    s_add_u32 m0, s30, 0
    s_nop 0
    ds_read_b64_tr_b16 v[128:129], v44 offset:16384
    ds_read_b64_tr_b16 v[130:131], v44 offset:16640
    ds_read_b64_tr_b16 v[132:133], v44 offset:20480
    buffer_load_dwordx4 v9, s[16:19], s27 offen offset:0 sc1 lds
    v_mfma_f32_32x32x16_bf16 v[80:95], v[192:195], v[228:231], v[80:95]
    ds_read_b64_tr_b16 v[134:135], v44 offset:20736
    ds_read_b64_tr_b16 v[136:137], v44 offset:17408
    ds_read_b64_tr_b16 v[138:139], v44 offset:17664
    buffer_load_dwordx4 v9, s[16:19], s27 offen offset:1024 sc1 lds
    v_mfma_f32_32x32x16_bf16 v[96:111], v[196:199], v[224:227], v[96:111]
    ds_read_b64_tr_b16 v[140:141], v44 offset:21504
    ds_read_b64_tr_b16 v[142:143], v44 offset:21760
    ds_read_b64_tr_b16 v[144:145], v44 offset:18432
    buffer_load_dwordx4 v9, s[16:19], s27 offen offset:2048 sc1 lds
    v_mfma_f32_32x32x16_bf16 v[112:127], v[196:199], v[228:231], v[112:127]
    ds_read_b64_tr_b16 v[146:147], v44 offset:18688
    ds_read_b64_tr_b16 v[148:149], v44 offset:22528
    ds_read_b64_tr_b16 v[150:151], v44 offset:22784
    buffer_load_dwordx4 v9, s[16:19], s27 offen offset:3072 sc1 lds
    s_add_u32 s35, s35, 1
    s_cmp_eq_u32 s35, 10
    s_cselect_b32 s35, 0, s35
    s_cselect_b32 s37, -1152, s38
    s_lshl_b32 s37, s37, 5
    s_add_u32 s27, s27, s37
    s_add_u32 s27, s27, 40960
    v_mfma_f32_32x32x16_bf16 v[64:79], v[200:203], v[232:235], v[64:79]
    ds_read_b64_tr_b16 v[152:153], v44 offset:19456
    ds_read_b64_tr_b16 v[154:155], v44 offset:19712
    ds_read_b64_tr_b16 v[156:157], v44 offset:23552
    v_mfma_f32_32x32x16_bf16 v[80:95], v[200:203], v[236:239], v[80:95]
    ds_read_b64_tr_b16 v[158:159], v44 offset:23808
    v_mfma_f32_32x32x16_bf16 v[96:111], v[204:207], v[232:235], v[96:111]
    v_mfma_f32_32x32x16_bf16 v[112:127], v[204:207], v[236:239], v[112:127]
    s_waitcnt vmcnt(12) lgkmcnt(0)
    s_barrier
    v_mfma_f32_32x32x16_bf16 v[64:79], v[208:211], v[240:243], v[64:79]
    s_add_u32 m0, s30, 16384
    s_nop 0
    ds_read_b128 v[160:163], v18 offset:32768
    ds_read_b128 v[164:167], v18 offset:36864
    buffer_load_dwordx4 v1, s[12:15], s29 offen offset:0 lds
    v_mfma_f32_32x32x16_bf16 v[80:95], v[208:211], v[244:247], v[80:95]
    ds_read_b128 v[168:171], v19 offset:32768
    ds_read_b128 v[172:175], v19 offset:36864
    buffer_load_dwordx4 v2, s[12:15], s29 offen offset:1024 lds
    v_mfma_f32_32x32x16_bf16 v[96:111], v[212:215], v[240:243], v[96:111]
    ds_read_b128 v[176:179], v20 offset:32768
    ds_read_b128 v[180:183], v20 offset:36864
    buffer_load_dwordx4 v3, s[12:15], s29 offen offset:2048 lds
    v_mfma_f32_32x32x16_bf16 v[112:127], v[212:215], v[244:247], v[112:127]
    ds_read_b128 v[184:187], v21 offset:32768
    ds_read_b128 v[188:191], v21 offset:36864
    buffer_load_dwordx4 v4, s[12:15], s29 offen offset:3072 lds
    s_add_u32 s36, s36, 1
    s_cmp_eq_u32 s36, 10
    s_cselect_b32 s36, 0, s36
    s_cselect_b32 s37, -1152, s38
    s_add_u32 s29, s29, s37
    v_mfma_f32_32x32x16_bf16 v[64:79], v[216:219], v[248:251], v[64:79]
    v_mfma_f32_32x32x16_bf16 v[80:95], v[216:219], v[252:255], v[80:95]
    v_mfma_f32_32x32x16_bf16 v[96:111], v[220:223], v[248:251], v[96:111]
    v_mfma_f32_32x32x16_bf16 v[112:127], v[220:223], v[252:255], v[112:127]
    s_cmp_lg_u32 s64, 0
    s_cbranch_scc1 g2_i1
    v_cmp_ne_u32 vcc, s65, v57
    s_nop 4
    s_cbranch_vccz g2_i1
    s_mov_b32 s67, 20000
g2i_poll:
    buffer_load_dword v57, v56, s[16:19], 0 offen sc1
    s_waitcnt vmcnt(0)
    v_cmp_ne_u32 vcc, s65, v57
    s_nop 4
    s_cbranch_vccz g2i_poll_ok
    s_sleep 2
    s_sub_u32 s67, s67, 1
    s_cmp_lg_u32 s67, 0
    s_cbranch_scc1 g2i_poll
g2i_poll_ok:
g2_i1:
    s_waitcnt vmcnt(12) lgkmcnt(0)
    s_barrier
    v_mfma_f32_32x32x16_bf16 v[64:79], v[128:131], v[160:163], v[64:79]
    s_add_u32 m0, s30, 32768
    s_nop 0
    ds_read_b64_tr_b16 v[192:193], v44 offset:49152
    ds_read_b64_tr_b16 v[194:195], v44 offset:49408
    ds_read_b64_tr_b16 v[196:197], v44 offset:53248
    buffer_load_dwordx4 v9, s[16:19], s27 offen offset:0 sc1 lds
    v_mfma_f32_32x32x16_bf16 v[80:95], v[128:131], v[164:167], v[80:95]
    ds_read_b64_tr_b16 v[198:199], v44 offset:53504
    ds_read_b64_tr_b16 v[200:201], v44 offset:50176
    ds_read_b64_tr_b16 v[202:203], v44 offset:50432
    buffer_load_dwordx4 v9, s[16:19], s27 offen offset:1024 sc1 lds
    v_mfma_f32_32x32x16_bf16 v[96:111], v[132:135], v[160:163], v[96:111]
    ds_read_b64_tr_b16 v[204:205], v44 offset:54272
    ds_read_b64_tr_b16 v[206:207], v44 offset:54528
    ds_read_b64_tr_b16 v[208:209], v44 offset:51200
    buffer_load_dwordx4 v9, s[16:19], s27 offen offset:2048 sc1 lds
    v_mfma_f32_32x32x16_bf16 v[112:127], v[132:135], v[164:167], v[112:127]
    ds_read_b64_tr_b16 v[210:211], v44 offset:51456
    ds_read_b64_tr_b16 v[212:213], v44 offset:55296
    ds_read_b64_tr_b16 v[214:215], v44 offset:55552
    buffer_load_dwordx4 v9, s[16:19], s27 offen offset:3072 sc1 lds
    s_add_u32 s35, s35, 1
    s_cmp_eq_u32 s35, 10
    s_cselect_b32 s35, 0, s35
    s_cselect_b32 s37, -1152, s38
    s_lshl_b32 s37, s37, 5
    s_add_u32 s27, s27, s37
    v_mfma_f32_32x32x16_bf16 v[64:79], v[136:139], v[168:171], v[64:79]
    ds_read_b64_tr_b16 v[216:217], v44 offset:52224
    ds_read_b64_tr_b16 v[218:219], v44 offset:52480
    ds_read_b64_tr_b16 v[220:221], v44 offset:56320
    v_mfma_f32_32x32x16_bf16 v[80:95], v[136:139], v[172:175], v[80:95]
    ds_read_b64_tr_b16 v[222:223], v44 offset:56576
    v_mfma_f32_32x32x16_bf16 v[96:111], v[140:143], v[168:171], v[96:111]
    v_mfma_f32_32x32x16_bf16 v[112:127], v[140:143], v[172:175], v[112:127]
    s_waitcnt vmcnt(12) lgkmcnt(0)
    s_barrier
    v_mfma_f32_32x32x16_bf16 v[64:79], v[144:147], v[176:179], v[64:79]
    s_add_u32 m0, s30, 49152
    s_nop 0
    ds_read_b128 v[224:227], v22 offset:0
    ds_read_b128 v[228:231], v22 offset:4096
    buffer_load_dwordx4 v1, s[20:23], s29 offen offset:0 lds
    v_mfma_f32_32x32x16_bf16 v[80:95], v[144:147], v[180:183], v[80:95]
    ds_read_b128 v[232:235], v23 offset:0
    ds_read_b128 v[236:239], v23 offset:4096
    buffer_load_dwordx4 v2, s[20:23], s29 offen offset:1024 lds
    v_mfma_f32_32x32x16_bf16 v[96:111], v[148:151], v[176:179], v[96:111]
    ds_read_b128 v[240:243], v24 offset:0
    ds_read_b128 v[244:247], v24 offset:4096
    buffer_load_dwordx4 v3, s[20:23], s29 offen offset:2048 lds
    v_mfma_f32_32x32x16_bf16 v[112:127], v[148:151], v[180:183], v[112:127]
    ds_read_b128 v[248:251], v25 offset:0
    ds_read_b128 v[252:255], v25 offset:4096
    buffer_load_dwordx4 v4, s[20:23], s29 offen offset:3072 lds
    s_add_u32 s36, s36, 1
    s_cmp_eq_u32 s36, 10
    s_cselect_b32 s36, 0, s36
    s_cselect_b32 s37, -1152, s38
    s_add_u32 s29, s29, s37
    v_mfma_f32_32x32x16_bf16 v[64:79], v[152:155], v[184:187], v[64:79]
    v_mfma_f32_32x32x16_bf16 v[80:95], v[152:155], v[188:191], v[80:95]
    v_mfma_f32_32x32x16_bf16 v[96:111], v[156:159], v[184:187], v[96:111]
    v_mfma_f32_32x32x16_bf16 v[112:127], v[156:159], v[188:191], v[112:127]
    s_waitcnt vmcnt(12) lgkmcnt(0)
    s_barrier
    v_mfma_f32_32x32x16_bf16 v[64:79], v[192:195], v[224:227], v[64:79]
    s_add_u32 m0, s30, 65536
    s_nop 0
    ds_read_b64_tr_b16 v[128:129], v44 offset:0
    ds_read_b64_tr_b16 v[130:131], v44 offset:256
    ds_read_b64_tr_b16 v[132:133], v44 offset:4096
    buffer_load_dwordx4 v9, s[16:19], s27 offen offset:0 sc1 lds
    v_mfma_f32_32x32x16_bf16 v[80:95], v[192:195], v[228:231], v[80:95]
    ds_read_b64_tr_b16 v[134:135], v44 offset:4352
    ds_read_b64_tr_b16 v[136:137], v44 offset:1024
    ds_read_b64_tr_b16 v[138:139], v44 offset:1280
    buffer_load_dwordx4 v9, s[16:19], s27 offen offset:1024 sc1 lds
    v_mfma_f32_32x32x16_bf16 v[96:111], v[196:199], v[224:227], v[96:111]
    ds_read_b64_tr_b16 v[140:141], v44 offset:5120
    ds_read_b64_tr_b16 v[142:143], v44 offset:5376
    ds_read_b64_tr_b16 v[144:145], v44 offset:2048
    buffer_load_dwordx4 v9, s[16:19], s27 offen offset:2048 sc1 lds
    v_mfma_f32_32x32x16_bf16 v[112:127], v[196:199], v[228:231], v[112:127]
    ds_read_b64_tr_b16 v[146:147], v44 offset:2304
    ds_read_b64_tr_b16 v[148:149], v44 offset:6144
    ds_read_b64_tr_b16 v[150:151], v44 offset:6400
    buffer_load_dwordx4 v9, s[16:19], s27 offen offset:3072 sc1 lds
    s_add_u32 s35, s35, 1
    s_cmp_eq_u32 s35, 10
    s_cselect_b32 s35, 0, s35
    s_cselect_b32 s37, -1152, s38
    s_lshl_b32 s37, s37, 5
    s_add_u32 s27, s27, s37
    v_mfma_f32_32x32x16_bf16 v[64:79], v[200:203], v[232:235], v[64:79]
    ds_read_b64_tr_b16 v[152:153], v44 offset:3072
    ds_read_b64_tr_b16 v[154:155], v44 offset:3328
    ds_read_b64_tr_b16 v[156:157], v44 offset:7168
    v_mfma_f32_32x32x16_bf16 v[80:95], v[200:203], v[236:239], v[80:95]
    ds_read_b64_tr_b16 v[158:159], v44 offset:7424
    v_mfma_f32_32x32x16_bf16 v[96:111], v[204:207], v[232:235], v[96:111]
    v_mfma_f32_32x32x16_bf16 v[112:127], v[204:207], v[236:239], v[112:127]
    s_waitcnt vmcnt(12) lgkmcnt(0)
    s_barrier
    v_mfma_f32_32x32x16_bf16 v[64:79], v[208:211], v[240:243], v[64:79]
    s_add_u32 m0, s30, 0
    s_nop 0
    ds_read_b128 v[160:163], v18 offset:16384
    ds_read_b128 v[164:167], v18 offset:20480
    buffer_load_dwordx4 v1, s[20:23], s29 offen offset:0 lds
    v_mfma_f32_32x32x16_bf16 v[80:95], v[208:211], v[244:247], v[80:95]
    ds_read_b128 v[168:171], v19 offset:16384
    ds_read_b128 v[172:175], v19 offset:20480
    buffer_load_dwordx4 v2, s[20:23], s29 offen offset:1024 lds
    v_mfma_f32_32x32x16_bf16 v[96:111], v[212:215], v[240:243], v[96:111]
    ds_read_b128 v[176:179], v20 offset:16384
    ds_read_b128 v[180:183], v20 offset:20480
    buffer_load_dwordx4 v3, s[20:23], s29 offen offset:2048 lds
    v_mfma_f32_32x32x16_bf16 v[112:127], v[212:215], v[244:247], v[112:127]
    ds_read_b128 v[184:187], v21 offset:16384
    ds_read_b128 v[188:191], v21 offset:20480
    buffer_load_dwordx4 v4, s[20:23], s29 offen offset:3072 lds
    s_add_u32 s36, s36, 1
    s_cmp_eq_u32 s36, 10
    s_cselect_b32 s36, 0, s36
    s_cselect_b32 s37, -1152, s38
    s_add_u32 s29, s29, s37
    v_mfma_f32_32x32x16_bf16 v[64:79], v[216:219], v[248:251], v[64:79]
    v_mfma_f32_32x32x16_bf16 v[80:95], v[216:219], v[252:255], v[80:95]
    v_mfma_f32_32x32x16_bf16 v[96:111], v[220:223], v[248:251], v[96:111]
    v_mfma_f32_32x32x16_bf16 v[112:127], v[220:223], v[252:255], v[112:127]
    s_waitcnt vmcnt(12) lgkmcnt(0)
    s_barrier
    v_mfma_f32_32x32x16_bf16 v[64:79], v[128:131], v[160:163], v[64:79]
    s_add_u32 m0, s30, 16384
    s_nop 0
    ds_read_b64_tr_b16 v[192:193], v44 offset:32768
    ds_read_b64_tr_b16 v[194:195], v44 offset:33024
    ds_read_b64_tr_b16 v[196:197], v44 offset:36864
    buffer_load_dwordx4 v9, s[16:19], s27 offen offset:0 sc1 lds
    v_mfma_f32_32x32x16_bf16 v[80:95], v[128:131], v[164:167], v[80:95]
    ds_read_b64_tr_b16 v[198:199], v44 offset:37120
    ds_read_b64_tr_b16 v[200:201], v44 offset:33792
    ds_read_b64_tr_b16 v[202:203], v44 offset:34048
    buffer_load_dwordx4 v9, s[16:19], s27 offen offset:1024 sc1 lds
    v_mfma_f32_32x32x16_bf16 v[96:111], v[132:135], v[160:163], v[96:111]
    ds_read_b64_tr_b16 v[204:205], v44 offset:37888
    ds_read_b64_tr_b16 v[206:207], v44 offset:38144
    ds_read_b64_tr_b16 v[208:209], v44 offset:34816
    buffer_load_dwordx4 v9, s[16:19], s27 offen offset:2048 sc1 lds
    v_mfma_f32_32x32x16_bf16 v[112:127], v[132:135], v[164:167], v[112:127]
    ds_read_b64_tr_b16 v[210:211], v44 offset:35072
    ds_read_b64_tr_b16 v[212:213], v44 offset:38912
    ds_read_b64_tr_b16 v[214:215], v44 offset:39168
    buffer_load_dwordx4 v9, s[16:19], s27 offen offset:3072 sc1 lds
    s_add_u32 s35, s35, 1
    s_cmp_eq_u32 s35, 10
    s_cselect_b32 s35, 0, s35
    s_cselect_b32 s37, -1152, s38
    s_lshl_b32 s37, s37, 5
    s_add_u32 s27, s27, s37
    v_mfma_f32_32x32x16_bf16 v[64:79], v[136:139], v[168:171], v[64:79]
    ds_read_b64_tr_b16 v[216:217], v44 offset:35840
    ds_read_b64_tr_b16 v[218:219], v44 offset:36096
    ds_read_b64_tr_b16 v[220:221], v44 offset:39936
    v_mfma_f32_32x32x16_bf16 v[80:95], v[136:139], v[172:175], v[80:95]
    ds_read_b64_tr_b16 v[222:223], v44 offset:40192
    v_mfma_f32_32x32x16_bf16 v[96:111], v[140:143], v[168:171], v[96:111]
    v_mfma_f32_32x32x16_bf16 v[112:127], v[140:143], v[172:175], v[112:127]
    s_waitcnt vmcnt(12) lgkmcnt(0)
    s_barrier
    v_mfma_f32_32x32x16_bf16 v[64:79], v[144:147], v[176:179], v[64:79]
    s_add_u32 m0, s30, 32768
    s_nop 0
    ds_read_b128 v[224:227], v18 offset:49152
    ds_read_b128 v[228:231], v18 offset:53248
    buffer_load_dwordx4 v1, s[20:23], s29 offen offset:0 lds
    v_mfma_f32_32x32x16_bf16 v[80:95], v[144:147], v[180:183], v[80:95]
    ds_read_b128 v[232:235], v19 offset:49152
    ds_read_b128 v[236:239], v19 offset:53248
    buffer_load_dwordx4 v2, s[20:23], s29 offen offset:1024 lds
    v_mfma_f32_32x32x16_bf16 v[96:111], v[148:151], v[176:179], v[96:111]
    ds_read_b128 v[240:243], v20 offset:49152
    ds_read_b128 v[244:247], v20 offset:53248
    buffer_load_dwordx4 v3, s[20:23], s29 offen offset:2048 lds
    v_mfma_f32_32x32x16_bf16 v[112:127], v[148:151], v[180:183], v[112:127]
    ds_read_b128 v[248:251], v21 offset:49152
    ds_read_b128 v[252:255], v21 offset:53248
    buffer_load_dwordx4 v4, s[20:23], s29 offen offset:3072 lds
    s_add_u32 s36, s36, 1
    s_cmp_eq_u32 s36, 10
    s_cselect_b32 s36, 0, s36
    s_cselect_b32 s37, -1152, s38
    s_add_u32 s29, s29, s37
    v_mfma_f32_32x32x16_bf16 v[64:79], v[152:155], v[184:187], v[64:79]
    v_mfma_f32_32x32x16_bf16 v[80:95], v[152:155], v[188:191], v[80:95]
    v_mfma_f32_32x32x16_bf16 v[96:111], v[156:159], v[184:187], v[96:111]
    v_mfma_f32_32x32x16_bf16 v[112:127], v[156:159], v[188:191], v[112:127]
    s_waitcnt vmcnt(12) lgkmcnt(0)
    s_barrier
    v_mfma_f32_32x32x16_bf16 v[64:79], v[192:195], v[224:227], v[64:79]
    s_add_u32 m0, s30, 49152
    s_nop 0
    ds_read_b64_tr_b16 v[128:129], v45 offset:0
    ds_read_b64_tr_b16 v[130:131], v45 offset:256
    ds_read_b64_tr_b16 v[132:133], v45 offset:4096
    buffer_load_dwordx4 v9, s[16:19], s27 offen offset:0 sc1 lds
    v_mfma_f32_32x32x16_bf16 v[80:95], v[192:195], v[228:231], v[80:95]
    ds_read_b64_tr_b16 v[134:135], v45 offset:4352
    ds_read_b64_tr_b16 v[136:137], v45 offset:1024
    ds_read_b64_tr_b16 v[138:139], v45 offset:1280
    buffer_load_dwordx4 v9, s[16:19], s27 offen offset:1024 sc1 lds
    v_mfma_f32_32x32x16_bf16 v[96:111], v[196:199], v[224:227], v[96:111]
    ds_read_b64_tr_b16 v[140:141], v45 offset:5120
    ds_read_b64_tr_b16 v[142:143], v45 offset:5376
    ds_read_b64_tr_b16 v[144:145], v45 offset:2048
    buffer_load_dwordx4 v9, s[16:19], s27 offen offset:2048 sc1 lds
    v_mfma_f32_32x32x16_bf16 v[112:127], v[196:199], v[228:231], v[112:127]
    ds_read_b64_tr_b16 v[146:147], v45 offset:2304
    ds_read_b64_tr_b16 v[148:149], v45 offset:6144
    ds_read_b64_tr_b16 v[150:151], v45 offset:6400
    buffer_load_dwordx4 v9, s[16:19], s27 offen offset:3072 sc1 lds
    s_add_u32 s35, s35, 1
    s_cmp_eq_u32 s35, 10
    s_cselect_b32 s35, 0, s35
    s_cselect_b32 s37, -1152, s38
    s_lshl_b32 s37, s37, 5
    s_add_u32 s27, s27, s37
    v_mfma_f32_32x32x16_bf16 v[64:79], v[200:203], v[232:235], v[64:79]
    ds_read_b64_tr_b16 v[152:153], v45 offset:3072
    ds_read_b64_tr_b16 v[154:155], v45 offset:3328
    ds_read_b64_tr_b16 v[156:157], v45 offset:7168
    v_mfma_f32_32x32x16_bf16 v[80:95], v[200:203], v[236:239], v[80:95]
    ds_read_b64_tr_b16 v[158:159], v45 offset:7424
    v_mfma_f32_32x32x16_bf16 v[96:111], v[204:207], v[232:235], v[96:111]
    v_mfma_f32_32x32x16_bf16 v[112:127], v[204:207], v[236:239], v[112:127]
    s_waitcnt vmcnt(12) lgkmcnt(0)
    s_barrier
    v_mfma_f32_32x32x16_bf16 v[64:79], v[208:211], v[240:243], v[64:79]
    s_add_u32 m0, s30, 65536
    s_nop 0
    ds_read_b128 v[160:163], v18 offset:0
    ds_read_b128 v[164:167], v18 offset:4096
    buffer_load_dwordx4 v1, s[20:23], s29 offen offset:0 lds
    v_mfma_f32_32x32x16_bf16 v[80:95], v[208:211], v[244:247], v[80:95]
    ds_read_b128 v[168:171], v19 offset:0
    ds_read_b128 v[172:175], v19 offset:4096
    buffer_load_dwordx4 v2, s[20:23], s29 offen offset:1024 lds
    v_mfma_f32_32x32x16_bf16 v[96:111], v[212:215], v[240:243], v[96:111]
    ds_read_b128 v[176:179], v20 offset:0
    ds_read_b128 v[180:183], v20 offset:4096
    buffer_load_dwordx4 v3, s[20:23], s29 offen offset:2048 lds
    v_mfma_f32_32x32x16_bf16 v[112:127], v[212:215], v[244:247], v[112:127]
    ds_read_b128 v[184:187], v21 offset:0
    ds_read_b128 v[188:191], v21 offset:4096
    buffer_load_dwordx4 v4, s[20:23], s29 offen offset:3072 lds
    s_add_u32 s36, s36, 1
    s_cmp_eq_u32 s36, 10
    s_cselect_b32 s36, 0, s36
    s_cselect_b32 s37, -1152, s38
    s_add_u32 s29, s29, s37
    v_mfma_f32_32x32x16_bf16 v[64:79], v[216:219], v[248:251], v[64:79]
    v_mfma_f32_32x32x16_bf16 v[80:95], v[216:219], v[252:255], v[80:95]
    v_mfma_f32_32x32x16_bf16 v[96:111], v[220:223], v[248:251], v[96:111]
    v_mfma_f32_32x32x16_bf16 v[112:127], v[220:223], v[252:255], v[112:127]
    s_waitcnt vmcnt(12) lgkmcnt(0)
    s_barrier
    v_mfma_f32_32x32x16_bf16 v[64:79], v[128:131], v[160:163], v[64:79]
    s_add_u32 m0, s30, 0
    s_nop 0
    ds_read_b64_tr_b16 v[192:193], v44 offset:16384
    ds_read_b64_tr_b16 v[194:195], v44 offset:16640
    ds_read_b64_tr_b16 v[196:197], v44 offset:20480
    buffer_load_dwordx4 v9, s[16:19], s27 offen offset:0 sc1 lds
    v_mfma_f32_32x32x16_bf16 v[80:95], v[128:131], v[164:167], v[80:95]
    ds_read_b64_tr_b16 v[198:199], v44 offset:20736
    ds_read_b64_tr_b16 v[200:201], v44 offset:17408
    ds_read_b64_tr_b16 v[202:203], v44 offset:17664
    buffer_load_dwordx4 v9, s[16:19], s27 offen offset:1024 sc1 lds
    v_mfma_f32_32x32x16_bf16 v[96:111], v[132:135], v[160:163], v[96:111]
    ds_read_b64_tr_b16 v[204:205], v44 offset:21504
    ds_read_b64_tr_b16 v[206:207], v44 offset:21760
    ds_read_b64_tr_b16 v[208:209], v44 offset:18432
    buffer_load_dwordx4 v9, s[16:19], s27 offen offset:2048 sc1 lds
    v_mfma_f32_32x32x16_bf16 v[112:127], v[132:135], v[164:167], v[112:127]
    ds_read_b64_tr_b16 v[210:211], v44 offset:18688
    ds_read_b64_tr_b16 v[212:213], v44 offset:22528
    ds_read_b64_tr_b16 v[214:215], v44 offset:22784
    buffer_load_dwordx4 v9, s[16:19], s27 offen offset:3072 sc1 lds
    s_add_u32 s35, s35, 1
    s_cmp_eq_u32 s35, 10
    s_cselect_b32 s35, 0, s35
    s_cselect_b32 s37, -1152, s38
    s_lshl_b32 s37, s37, 5
    s_add_u32 s27, s27, s37
    v_mfma_f32_32x32x16_bf16 v[64:79], v[136:139], v[168:171], v[64:79]
    ds_read_b64_tr_b16 v[216:217], v44 offset:19456
    ds_read_b64_tr_b16 v[218:219], v44 offset:19712
    ds_read_b64_tr_b16 v[220:221], v44 offset:23552
    v_mfma_f32_32x32x16_bf16 v[80:95], v[136:139], v[172:175], v[80:95]
    ds_read_b64_tr_b16 v[222:223], v44 offset:23808
    v_mfma_f32_32x32x16_bf16 v[96:111], v[140:143], v[168:171], v[96:111]
    v_mfma_f32_32x32x16_bf16 v[112:127], v[140:143], v[172:175], v[112:127]
    s_waitcnt vmcnt(12) lgkmcnt(0)
    s_barrier
    v_mfma_f32_32x32x16_bf16 v[64:79], v[144:147], v[176:179], v[64:79]
    s_add_u32 m0, s30, 16384
    s_nop 0
    ds_read_b128 v[224:227], v18 offset:32768
    ds_read_b128 v[228:231], v18 offset:36864
    buffer_load_dwordx4 v1, s[20:23], s29 offen offset:0 lds
    v_mfma_f32_32x32x16_bf16 v[80:95], v[144:147], v[180:183], v[80:95]
    ds_read_b128 v[232:235], v19 offset:32768
    ds_read_b128 v[236:239], v19 offset:36864
    buffer_load_dwordx4 v2, s[20:23], s29 offen offset:1024 lds
    v_mfma_f32_32x32x16_bf16 v[96:111], v[148:151], v[176:179], v[96:111]
    ds_read_b128 v[240:243], v20 offset:32768
    ds_read_b128 v[244:247], v20 offset:36864
    buffer_load_dwordx4 v3, s[20:23], s29 offen offset:2048 lds
    v_mfma_f32_32x32x16_bf16 v[112:127], v[148:151], v[180:183], v[112:127]
    ds_read_b128 v[248:251], v21 offset:32768
    ds_read_b128 v[252:255], v21 offset:36864
    buffer_load_dwordx4 v4, s[20:23], s29 offen offset:3072 lds
    s_add_u32 s36, s36, 1
    s_cmp_eq_u32 s36, 10
    s_cselect_b32 s36, 0, s36
    s_cselect_b32 s37, -1152, s38
    s_add_u32 s29, s29, s37
    v_mfma_f32_32x32x16_bf16 v[64:79], v[152:155], v[184:187], v[64:79]
    v_mfma_f32_32x32x16_bf16 v[80:95], v[152:155], v[188:191], v[80:95]
    v_mfma_f32_32x32x16_bf16 v[96:111], v[156:159], v[184:187], v[96:111]
    v_mfma_f32_32x32x16_bf16 v[112:127], v[156:159], v[188:191], v[112:127]
    s_waitcnt vmcnt(12) lgkmcnt(0)
    s_barrier
    v_mfma_f32_32x32x16_bf16 v[64:79], v[192:195], v[224:227], v[64:79]
    s_add_u32 m0, s30, 32768
    s_nop 0
    ds_read_b64_tr_b16 v[128:129], v44 offset:49152
    ds_read_b64_tr_b16 v[130:131], v44 offset:49408
    ds_read_b64_tr_b16 v[132:133], v44 offset:53248
    buffer_load_dwordx4 v9, s[16:19], s27 offen offset:0 sc1 lds
    v_mfma_f32_32x32x16_bf16 v[80:95], v[192:195], v[228:231], v[80:95]
    ds_read_b64_tr_b16 v[134:135], v44 offset:53504
    ds_read_b64_tr_b16 v[136:137], v44 offset:50176
    ds_read_b64_tr_b16 v[138:139], v44 offset:50432
    buffer_load_dwordx4 v9, s[16:19], s27 offen offset:1024 sc1 lds
    v_mfma_f32_32x32x16_bf16 v[96:111], v[196:199], v[224:227], v[96:111]
    ds_read_b64_tr_b16 v[140:141], v44 offset:54272
    ds_read_b64_tr_b16 v[142:143], v44 offset:54528
    ds_read_b64_tr_b16 v[144:145], v44 offset:51200
    buffer_load_dwordx4 v9, s[16:19], s27 offen offset:2048 sc1 lds
    v_mfma_f32_32x32x16_bf16 v[112:127], v[196:199], v[228:231], v[112:127]
    ds_read_b64_tr_b16 v[146:147], v44 offset:51456
    ds_read_b64_tr_b16 v[148:149], v44 offset:55296
    ds_read_b64_tr_b16 v[150:151], v44 offset:55552
    buffer_load_dwordx4 v9, s[16:19], s27 offen offset:3072 sc1 lds
    s_add_u32 s35, s35, 1
    s_cmp_eq_u32 s35, 10
    s_cselect_b32 s35, 0, s35
    s_cselect_b32 s37, -1152, s38
    s_lshl_b32 s37, s37, 5
    s_add_u32 s27, s27, s37
    v_mfma_f32_32x32x16_bf16 v[64:79], v[200:203], v[232:235], v[64:79]
    ds_read_b64_tr_b16 v[152:153], v44 offset:52224
    ds_read_b64_tr_b16 v[154:155], v44 offset:52480
    ds_read_b64_tr_b16 v[156:157], v44 offset:56320
    v_mfma_f32_32x32x16_bf16 v[80:95], v[200:203], v[236:239], v[80:95]
    ds_read_b64_tr_b16 v[158:159], v44 offset:56576
    v_mfma_f32_32x32x16_bf16 v[96:111], v[204:207], v[232:235], v[96:111]
    v_mfma_f32_32x32x16_bf16 v[112:127], v[204:207], v[236:239], v[112:127]
    s_waitcnt vmcnt(12) lgkmcnt(0)
    s_barrier
    v_mfma_f32_32x32x16_bf16 v[64:79], v[208:211], v[240:243], v[64:79]
    s_add_u32 m0, s30, 49152
    s_nop 0
    ds_read_b128 v[160:163], v22 offset:0
    ds_read_b128 v[164:167], v22 offset:4096
    buffer_load_dwordx4 v1, s[20:23], s29 offen offset:0 lds
    v_mfma_f32_32x32x16_bf16 v[80:95], v[208:211], v[244:247], v[80:95]
    ds_read_b128 v[168:171], v23 offset:0
    ds_read_b128 v[172:175], v23 offset:4096
    buffer_load_dwordx4 v2, s[20:23], s29 offen offset:1024 lds
    v_mfma_f32_32x32x16_bf16 v[96:111], v[212:215], v[240:243], v[96:111]
    ds_read_b128 v[176:179], v24 offset:0
    ds_read_b128 v[180:183], v24 offset:4096
    buffer_load_dwordx4 v3, s[20:23], s29 offen offset:2048 lds
    v_mfma_f32_32x32x16_bf16 v[112:127], v[212:215], v[244:247], v[112:127]
    ds_read_b128 v[184:187], v25 offset:0
    ds_read_b128 v[188:191], v25 offset:4096
    buffer_load_dwordx4 v4, s[20:23], s29 offen offset:3072 lds
    s_add_u32 s36, s36, 1
    s_cmp_eq_u32 s36, 10
    s_cselect_b32 s36, 0, s36
    s_cselect_b32 s37, -1152, s38
    s_add_u32 s29, s29, s37
    v_mfma_f32_32x32x16_bf16 v[64:79], v[216:219], v[248:251], v[64:79]
    v_mfma_f32_32x32x16_bf16 v[80:95], v[216:219], v[252:255], v[80:95]
    v_mfma_f32_32x32x16_bf16 v[96:111], v[220:223], v[248:251], v[96:111]
    v_mfma_f32_32x32x16_bf16 v[112:127], v[220:223], v[252:255], v[112:127]
    s_waitcnt vmcnt(12) lgkmcnt(0)
    s_barrier
    v_mfma_f32_32x32x16_bf16 v[64:79], v[128:131], v[160:163], v[64:79]
    s_add_u32 m0, s30, 65536
    s_nop 0
    ds_read_b64_tr_b16 v[192:193], v44 offset:0
    ds_read_b64_tr_b16 v[194:195], v44 offset:256
    ds_read_b64_tr_b16 v[196:197], v44 offset:4096
    buffer_load_dwordx4 v9, s[16:19], s27 offen offset:0 sc1 lds
    v_mfma_f32_32x32x16_bf16 v[80:95], v[128:131], v[164:167], v[80:95]
    ds_read_b64_tr_b16 v[198:199], v44 offset:4352
    ds_read_b64_tr_b16 v[200:201], v44 offset:1024
    ds_read_b64_tr_b16 v[202:203], v44 offset:1280
    buffer_load_dwordx4 v9, s[16:19], s27 offen offset:1024 sc1 lds
    v_mfma_f32_32x32x16_bf16 v[96:111], v[132:135], v[160:163], v[96:111]
    ds_read_b64_tr_b16 v[204:205], v44 offset:5120
    ds_read_b64_tr_b16 v[206:207], v44 offset:5376
    ds_read_b64_tr_b16 v[208:209], v44 offset:2048
    buffer_load_dwordx4 v9, s[16:19], s27 offen offset:2048 sc1 lds
    v_mfma_f32_32x32x16_bf16 v[112:127], v[132:135], v[164:167], v[112:127]
    ds_read_b64_tr_b16 v[210:211], v44 offset:2304
    ds_read_b64_tr_b16 v[212:213], v44 offset:6144
    ds_read_b64_tr_b16 v[214:215], v44 offset:6400
    buffer_load_dwordx4 v9, s[16:19], s27 offen offset:3072 sc1 lds
    s_add_u32 s35, s35, 1
    s_cmp_eq_u32 s35, 10
    s_cselect_b32 s35, 0, s35
    s_cselect_b32 s37, -1152, s38
    s_lshl_b32 s37, s37, 5
    s_add_u32 s27, s27, s37
    v_mfma_f32_32x32x16_bf16 v[64:79], v[136:139], v[168:171], v[64:79]
    ds_read_b64_tr_b16 v[216:217], v44 offset:3072
    ds_read_b64_tr_b16 v[218:219], v44 offset:3328
    ds_read_b64_tr_b16 v[220:221], v44 offset:7168
    v_mfma_f32_32x32x16_bf16 v[80:95], v[136:139], v[172:175], v[80:95]
    ds_read_b64_tr_b16 v[222:223], v44 offset:7424
    v_mfma_f32_32x32x16_bf16 v[96:111], v[140:143], v[168:171], v[96:111]
    v_mfma_f32_32x32x16_bf16 v[112:127], v[140:143], v[172:175], v[112:127]
    s_waitcnt vmcnt(12) lgkmcnt(0)
    s_barrier
    v_mfma_f32_32x32x16_bf16 v[64:79], v[144:147], v[176:179], v[64:79]
    s_add_u32 m0, s30, 0
    s_nop 0
    ds_read_b128 v[224:227], v18 offset:16384
    ds_read_b128 v[228:231], v18 offset:20480
    buffer_load_dwordx4 v1, s[20:23], s29 offen offset:0 lds
    v_mfma_f32_32x32x16_bf16 v[80:95], v[144:147], v[180:183], v[80:95]
    ds_read_b128 v[232:235], v19 offset:16384
    ds_read_b128 v[236:239], v19 offset:20480
    buffer_load_dwordx4 v2, s[20:23], s29 offen offset:1024 lds
    v_mfma_f32_32x32x16_bf16 v[96:111], v[148:151], v[176:179], v[96:111]
    ds_read_b128 v[240:243], v20 offset:16384
    ds_read_b128 v[244:247], v20 offset:20480
    buffer_load_dwordx4 v3, s[20:23], s29 offen offset:2048 lds
    v_mfma_f32_32x32x16_bf16 v[112:127], v[148:151], v[180:183], v[112:127]
    ds_read_b128 v[248:251], v21 offset:16384
    ds_read_b128 v[252:255], v21 offset:20480
    buffer_load_dwordx4 v4, s[20:23], s29 offen offset:3072 lds
    s_add_u32 s36, s36, 1
    s_cmp_eq_u32 s36, 10
    s_cselect_b32 s36, 0, s36
    s_cselect_b32 s37, -1152, s38
    s_add_u32 s29, s29, s37
    v_mfma_f32_32x32x16_bf16 v[64:79], v[152:155], v[184:187], v[64:79]
    v_mfma_f32_32x32x16_bf16 v[80:95], v[152:155], v[188:191], v[80:95]
    v_mfma_f32_32x32x16_bf16 v[96:111], v[156:159], v[184:187], v[96:111]
    v_mfma_f32_32x32x16_bf16 v[112:127], v[156:159], v[188:191], v[112:127]
    s_waitcnt vmcnt(12) lgkmcnt(0)
    s_barrier
    v_mfma_f32_32x32x16_bf16 v[64:79], v[192:195], v[224:227], v[64:79]
    s_add_u32 m0, s30, 16384
    s_nop 0
    ds_read_b64_tr_b16 v[128:129], v44 offset:32768
    ds_read_b64_tr_b16 v[130:131], v44 offset:33024
    ds_read_b64_tr_b16 v[132:133], v44 offset:36864
    buffer_load_dwordx4 v9, s[16:19], s27 offen offset:0 sc1 lds
    v_mfma_f32_32x32x16_bf16 v[80:95], v[192:195], v[228:231], v[80:95]
    ds_read_b64_tr_b16 v[134:135], v44 offset:37120
    ds_read_b64_tr_b16 v[136:137], v44 offset:33792
    ds_read_b64_tr_b16 v[138:139], v44 offset:34048
    buffer_load_dwordx4 v9, s[16:19], s27 offen offset:1024 sc1 lds
    v_mfma_f32_32x32x16_bf16 v[96:111], v[196:199], v[224:227], v[96:111]
    ds_read_b64_tr_b16 v[140:141], v44 offset:37888
    ds_read_b64_tr_b16 v[142:143], v44 offset:38144
    ds_read_b64_tr_b16 v[144:145], v44 offset:34816
    buffer_load_dwordx4 v9, s[16:19], s27 offen offset:2048 sc1 lds
    v_mfma_f32_32x32x16_bf16 v[112:127], v[196:199], v[228:231], v[112:127]
    ds_read_b64_tr_b16 v[146:147], v44 offset:35072
    ds_read_b64_tr_b16 v[148:149], v44 offset:38912
    ds_read_b64_tr_b16 v[150:151], v44 offset:39168
    buffer_load_dwordx4 v9, s[16:19], s27 offen offset:3072 sc1 lds
    s_add_u32 s35, s35, 1
    s_cmp_eq_u32 s35, 10
    s_cselect_b32 s35, 0, s35
    s_cselect_b32 s37, -1152, s38
    s_lshl_b32 s37, s37, 5
    s_add_u32 s27, s27, s37
    v_mfma_f32_32x32x16_bf16 v[64:79], v[200:203], v[232:235], v[64:79]
    ds_read_b64_tr_b16 v[152:153], v44 offset:35840
    ds_read_b64_tr_b16 v[154:155], v44 offset:36096
    ds_read_b64_tr_b16 v[156:157], v44 offset:39936
    v_mfma_f32_32x32x16_bf16 v[80:95], v[200:203], v[236:239], v[80:95]
    ds_read_b64_tr_b16 v[158:159], v44 offset:40192
    v_mfma_f32_32x32x16_bf16 v[96:111], v[204:207], v[232:235], v[96:111]
    v_mfma_f32_32x32x16_bf16 v[112:127], v[204:207], v[236:239], v[112:127]
    s_waitcnt vmcnt(12) lgkmcnt(0)
    s_barrier
    v_mfma_f32_32x32x16_bf16 v[64:79], v[208:211], v[240:243], v[64:79]
    s_add_u32 m0, s30, 32768
    s_nop 0
    ds_read_b128 v[160:163], v18 offset:49152
    ds_read_b128 v[164:167], v18 offset:53248
    buffer_load_dwordx4 v1, s[20:23], s29 offen offset:0 lds
    v_mfma_f32_32x32x16_bf16 v[80:95], v[208:211], v[244:247], v[80:95]
    ds_read_b128 v[168:171], v19 offset:49152
    ds_read_b128 v[172:175], v19 offset:53248
    buffer_load_dwordx4 v2, s[20:23], s29 offen offset:1024 lds
    v_mfma_f32_32x32x16_bf16 v[96:111], v[212:215], v[240:243], v[96:111]
    ds_read_b128 v[176:179], v20 offset:49152
    ds_read_b128 v[180:183], v20 offset:53248
    buffer_load_dwordx4 v3, s[20:23], s29 offen offset:2048 lds
    v_mfma_f32_32x32x16_bf16 v[112:127], v[212:215], v[244:247], v[112:127]
    ds_read_b128 v[184:187], v21 offset:49152
    ds_read_b128 v[188:191], v21 offset:53248
    buffer_load_dwordx4 v4, s[20:23], s29 offen offset:3072 lds
    s_add_u32 s36, s36, 1
    s_cmp_eq_u32 s36, 10
    s_cselect_b32 s36, 0, s36
    s_cselect_b32 s37, -1152, s38
    s_add_u32 s29, s29, s37
    v_mfma_f32_32x32x16_bf16 v[64:79], v[216:219], v[248:251], v[64:79]
    v_mfma_f32_32x32x16_bf16 v[80:95], v[216:219], v[252:255], v[80:95]
    v_mfma_f32_32x32x16_bf16 v[96:111], v[220:223], v[248:251], v[96:111]
    v_mfma_f32_32x32x16_bf16 v[112:127], v[220:223], v[252:255], v[112:127]
    s_waitcnt vmcnt(12) lgkmcnt(0)
    s_barrier
    v_mfma_f32_32x32x16_bf16 v[64:79], v[128:131], v[160:163], v[64:79]
    s_add_u32 m0, s30, 49152
    s_nop 0
    ds_read_b64_tr_b16 v[192:193], v45 offset:0
    ds_read_b64_tr_b16 v[194:195], v45 offset:256
    ds_read_b64_tr_b16 v[196:197], v45 offset:4096
    buffer_load_dwordx4 v9, s[16:19], s27 offen offset:0 sc1 lds
    v_mfma_f32_32x32x16_bf16 v[80:95], v[128:131], v[164:167], v[80:95]
    ds_read_b64_tr_b16 v[198:199], v45 offset:4352
    ds_read_b64_tr_b16 v[200:201], v45 offset:1024
    ds_read_b64_tr_b16 v[202:203], v45 offset:1280
    buffer_load_dwordx4 v9, s[16:19], s27 offen offset:1024 sc1 lds
    v_mfma_f32_32x32x16_bf16 v[96:111], v[132:135], v[160:163], v[96:111]
    ds_read_b64_tr_b16 v[204:205], v45 offset:5120
    ds_read_b64_tr_b16 v[206:207], v45 offset:5376
    ds_read_b64_tr_b16 v[208:209], v45 offset:2048
    buffer_load_dwordx4 v9, s[16:19], s27 offen offset:2048 sc1 lds
    v_mfma_f32_32x32x16_bf16 v[112:127], v[132:135], v[164:167], v[112:127]
    ds_read_b64_tr_b16 v[210:211], v45 offset:2304
    ds_read_b64_tr_b16 v[212:213], v45 offset:6144
    ds_read_b64_tr_b16 v[214:215], v45 offset:6400
    buffer_load_dwordx4 v9, s[16:19], s27 offen offset:3072 sc1 lds
    s_add_u32 s35, s35, 1
    s_cmp_eq_u32 s35, 10
    s_cselect_b32 s35, 0, s35
    s_cselect_b32 s37, -1152, s38
    s_lshl_b32 s37, s37, 5
    s_add_u32 s27, s27, s37
    v_mfma_f32_32x32x16_bf16 v[64:79], v[136:139], v[168:171], v[64:79]
    ds_read_b64_tr_b16 v[216:217], v45 offset:3072
    ds_read_b64_tr_b16 v[218:219], v45 offset:3328
    ds_read_b64_tr_b16 v[220:221], v45 offset:7168
    v_mfma_f32_32x32x16_bf16 v[80:95], v[136:139], v[172:175], v[80:95]
    ds_read_b64_tr_b16 v[222:223], v45 offset:7424
    v_mfma_f32_32x32x16_bf16 v[96:111], v[140:143], v[168:171], v[96:111]
    v_mfma_f32_32x32x16_bf16 v[112:127], v[140:143], v[172:175], v[112:127]
    s_waitcnt vmcnt(12) lgkmcnt(0)
    s_barrier
    v_mfma_f32_32x32x16_bf16 v[64:79], v[144:147], v[176:179], v[64:79]
    s_add_u32 m0, s30, 65536
    s_nop 0
    ds_read_b128 v[224:227], v18 offset:0
    ds_read_b128 v[228:231], v18 offset:4096
    buffer_load_dwordx4 v1, s[20:23], s29 offen offset:0 lds
    v_mfma_f32_32x32x16_bf16 v[80:95], v[144:147], v[180:183], v[80:95]
    ds_read_b128 v[232:235], v19 offset:0
    ds_read_b128 v[236:239], v19 offset:4096
    buffer_load_dwordx4 v2, s[20:23], s29 offen offset:1024 lds
    v_mfma_f32_32x32x16_bf16 v[96:111], v[148:151], v[176:179], v[96:111]
    ds_read_b128 v[240:243], v20 offset:0
    ds_read_b128 v[244:247], v20 offset:4096
    buffer_load_dwordx4 v3, s[20:23], s29 offen offset:2048 lds
    v_mfma_f32_32x32x16_bf16 v[112:127], v[148:151], v[180:183], v[112:127]
    ds_read_b128 v[248:251], v21 offset:0
    ds_read_b128 v[252:255], v21 offset:4096
    buffer_load_dwordx4 v4, s[20:23], s29 offen offset:3072 lds
    s_add_u32 s36, s36, 1
    s_cmp_eq_u32 s36, 10
    s_cselect_b32 s36, 0, s36
    s_cselect_b32 s37, -1152, s38
    s_add_u32 s29, s29, s37
    v_mfma_f32_32x32x16_bf16 v[64:79], v[152:155], v[184:187], v[64:79]
    v_mfma_f32_32x32x16_bf16 v[80:95], v[152:155], v[188:191], v[80:95]
    v_mfma_f32_32x32x16_bf16 v[96:111], v[156:159], v[184:187], v[96:111]
    v_mfma_f32_32x32x16_bf16 v[112:127], v[156:159], v[188:191], v[112:127]
    s_waitcnt vmcnt(12) lgkmcnt(0)
    s_barrier
    v_mfma_f32_32x32x16_bf16 v[64:79], v[192:195], v[224:227], v[64:79]
    s_add_u32 m0, s30, 0
    s_nop 0
    ds_read_b64_tr_b16 v[128:129], v44 offset:16384
    ds_read_b64_tr_b16 v[130:131], v44 offset:16640
    ds_read_b64_tr_b16 v[132:133], v44 offset:20480
    buffer_load_dwordx4 v9, s[16:19], s27 offen offset:0 sc1 lds
    v_mfma_f32_32x32x16_bf16 v[80:95], v[192:195], v[228:231], v[80:95]
    ds_read_b64_tr_b16 v[134:135], v44 offset:20736
    ds_read_b64_tr_b16 v[136:137], v44 offset:17408
    ds_read_b64_tr_b16 v[138:139], v44 offset:17664
    buffer_load_dwordx4 v9, s[16:19], s27 offen offset:1024 sc1 lds
    v_mfma_f32_32x32x16_bf16 v[96:111], v[196:199], v[224:227], v[96:111]
    ds_read_b64_tr_b16 v[140:141], v44 offset:21504
    ds_read_b64_tr_b16 v[142:143], v44 offset:21760
    ds_read_b64_tr_b16 v[144:145], v44 offset:18432
    buffer_load_dwordx4 v9, s[16:19], s27 offen offset:2048 sc1 lds
    v_mfma_f32_32x32x16_bf16 v[112:127], v[196:199], v[228:231], v[112:127]
    ds_read_b64_tr_b16 v[146:147], v44 offset:18688
    ds_read_b64_tr_b16 v[148:149], v44 offset:22528
    ds_read_b64_tr_b16 v[150:151], v44 offset:22784
    buffer_load_dwordx4 v9, s[16:19], s27 offen offset:3072 sc1 lds
    s_add_u32 s35, s35, 1
    s_cmp_eq_u32 s35, 10
    s_cselect_b32 s35, 0, s35
    s_cselect_b32 s37, -1152, s38
    s_lshl_b32 s37, s37, 5
    s_add_u32 s27, s27, s37
    v_mfma_f32_32x32x16_bf16 v[64:79], v[200:203], v[232:235], v[64:79]
    ds_read_b64_tr_b16 v[152:153], v44 offset:19456
    ds_read_b64_tr_b16 v[154:155], v44 offset:19712
    ds_read_b64_tr_b16 v[156:157], v44 offset:23552
    v_mfma_f32_32x32x16_bf16 v[80:95], v[200:203], v[236:239], v[80:95]
    ds_read_b64_tr_b16 v[158:159], v44 offset:23808
    v_mfma_f32_32x32x16_bf16 v[96:111], v[204:207], v[232:235], v[96:111]
    v_mfma_f32_32x32x16_bf16 v[112:127], v[204:207], v[236:239], v[112:127]
    s_waitcnt vmcnt(12) lgkmcnt(0)
    s_barrier
    v_mfma_f32_32x32x16_bf16 v[64:79], v[208:211], v[240:243], v[64:79]
    s_add_u32 m0, s30, 16384
    s_nop 0
    ds_read_b128 v[160:163], v18 offset:32768
    ds_read_b128 v[164:167], v18 offset:36864
    buffer_load_dwordx4 v1, s[20:23], s29 offen offset:0 lds
    v_mfma_f32_32x32x16_bf16 v[80:95], v[208:211], v[244:247], v[80:95]
    ds_read_b128 v[168:171], v19 offset:32768
    ds_read_b128 v[172:175], v19 offset:36864
    buffer_load_dwordx4 v2, s[20:23], s29 offen offset:1024 lds
    v_mfma_f32_32x32x16_bf16 v[96:111], v[212:215], v[240:243], v[96:111]
    ds_read_b128 v[176:179], v20 offset:32768
    ds_read_b128 v[180:183], v20 offset:36864
    buffer_load_dwordx4 v3, s[20:23], s29 offen offset:2048 lds
    v_mfma_f32_32x32x16_bf16 v[112:127], v[212:215], v[244:247], v[112:127]
    ds_read_b128 v[184:187], v21 offset:32768
    ds_read_b128 v[188:191], v21 offset:36864
    buffer_load_dwordx4 v4, s[20:23], s29 offen offset:3072 lds
    s_add_u32 s36, s36, 1
    s_cmp_eq_u32 s36, 10
    s_cselect_b32 s36, 0, s36
    s_cselect_b32 s37, -1152, s38
    s_add_u32 s29, s29, s37
    v_mfma_f32_32x32x16_bf16 v[64:79], v[216:219], v[248:251], v[64:79]
    v_mfma_f32_32x32x16_bf16 v[80:95], v[216:219], v[252:255], v[80:95]
    v_mfma_f32_32x32x16_bf16 v[96:111], v[220:223], v[248:251], v[96:111]
    v_mfma_f32_32x32x16_bf16 v[112:127], v[220:223], v[252:255], v[112:127]
    s_waitcnt vmcnt(12) lgkmcnt(0)
    s_barrier
    v_mfma_f32_32x32x16_bf16 v[64:79], v[128:131], v[160:163], v[64:79]
    ds_read_b64_tr_b16 v[192:193], v44 offset:49152
    ds_read_b64_tr_b16 v[194:195], v44 offset:49408
    ds_read_b64_tr_b16 v[196:197], v44 offset:53248
    v_mfma_f32_32x32x16_bf16 v[80:95], v[128:131], v[164:167], v[80:95]
    ds_read_b64_tr_b16 v[198:199], v44 offset:53504
    ds_read_b64_tr_b16 v[200:201], v44 offset:50176
    ds_read_b64_tr_b16 v[202:203], v44 offset:50432
    v_mfma_f32_32x32x16_bf16 v[96:111], v[132:135], v[160:163], v[96:111]
    ds_read_b64_tr_b16 v[204:205], v44 offset:54272
    ds_read_b64_tr_b16 v[206:207], v44 offset:54528
    ds_read_b64_tr_b16 v[208:209], v44 offset:51200
    v_mfma_f32_32x32x16_bf16 v[112:127], v[132:135], v[164:167], v[112:127]
    ds_read_b64_tr_b16 v[210:211], v44 offset:51456
    ds_read_b64_tr_b16 v[212:213], v44 offset:55296
    ds_read_b64_tr_b16 v[214:215], v44 offset:55552
    v_mfma_f32_32x32x16_bf16 v[64:79], v[136:139], v[168:171], v[64:79]
    ds_read_b64_tr_b16 v[216:217], v44 offset:52224
    ds_read_b64_tr_b16 v[218:219], v44 offset:52480
    ds_read_b64_tr_b16 v[220:221], v44 offset:56320
    v_mfma_f32_32x32x16_bf16 v[80:95], v[136:139], v[172:175], v[80:95]
    ds_read_b64_tr_b16 v[222:223], v44 offset:56576
    v_mfma_f32_32x32x16_bf16 v[96:111], v[140:143], v[168:171], v[96:111]
    v_mfma_f32_32x32x16_bf16 v[112:127], v[140:143], v[172:175], v[112:127]
    s_waitcnt vmcnt(8) lgkmcnt(0)
    s_barrier
    v_mfma_f32_32x32x16_bf16 v[64:79], v[144:147], v[176:179], v[64:79]
    ds_read_b128 v[224:227], v22 offset:0
    ds_read_b128 v[228:231], v22 offset:4096
    v_mfma_f32_32x32x16_bf16 v[80:95], v[144:147], v[180:183], v[80:95]
    ds_read_b128 v[232:235], v23 offset:0
    ds_read_b128 v[236:239], v23 offset:4096
    v_mfma_f32_32x32x16_bf16 v[96:111], v[148:151], v[176:179], v[96:111]
    ds_read_b128 v[240:243], v24 offset:0
    ds_read_b128 v[244:247], v24 offset:4096
    v_mfma_f32_32x32x16_bf16 v[112:127], v[148:151], v[180:183], v[112:127]
    ds_read_b128 v[248:251], v25 offset:0
    ds_read_b128 v[252:255], v25 offset:4096
    v_mfma_f32_32x32x16_bf16 v[64:79], v[152:155], v[184:187], v[64:79]
    v_mfma_f32_32x32x16_bf16 v[80:95], v[152:155], v[188:191], v[80:95]
    v_mfma_f32_32x32x16_bf16 v[96:111], v[156:159], v[184:187], v[96:111]
    v_mfma_f32_32x32x16_bf16 v[112:127], v[156:159], v[188:191], v[112:127]
    s_waitcnt vmcnt(4) lgkmcnt(0)
    s_barrier
    v_mfma_f32_32x32x16_bf16 v[64:79], v[192:195], v[224:227], v[64:79]
    ds_read_b64_tr_b16 v[128:129], v44 offset:0
    ds_read_b64_tr_b16 v[130:131], v44 offset:256
    ds_read_b64_tr_b16 v[132:133], v44 offset:4096
    v_mfma_f32_32x32x16_bf16 v[80:95], v[192:195], v[228:231], v[80:95]
    ds_read_b64_tr_b16 v[134:135], v44 offset:4352
    ds_read_b64_tr_b16 v[136:137], v44 offset:1024
    ds_read_b64_tr_b16 v[138:139], v44 offset:1280
    v_mfma_f32_32x32x16_bf16 v[96:111], v[196:199], v[224:227], v[96:111]
    ds_read_b64_tr_b16 v[140:141], v44 offset:5120
    ds_read_b64_tr_b16 v[142:143], v44 offset:5376
    ds_read_b64_tr_b16 v[144:145], v44 offset:2048
    v_mfma_f32_32x32x16_bf16 v[112:127], v[196:199], v[228:231], v[112:127]
    ds_read_b64_tr_b16 v[146:147], v44 offset:2304
    ds_read_b64_tr_b16 v[148:149], v44 offset:6144
    ds_read_b64_tr_b16 v[150:151], v44 offset:6400
    v_mfma_f32_32x32x16_bf16 v[64:79], v[200:203], v[232:235], v[64:79]
    ds_read_b64_tr_b16 v[152:153], v44 offset:3072
    ds_read_b64_tr_b16 v[154:155], v44 offset:3328
    ds_read_b64_tr_b16 v[156:157], v44 offset:7168
    v_mfma_f32_32x32x16_bf16 v[80:95], v[200:203], v[236:239], v[80:95]
    ds_read_b64_tr_b16 v[158:159], v44 offset:7424
    v_mfma_f32_32x32x16_bf16 v[96:111], v[204:207], v[232:235], v[96:111]
    v_mfma_f32_32x32x16_bf16 v[112:127], v[204:207], v[236:239], v[112:127]
    s_waitcnt vmcnt(0) lgkmcnt(0)
    s_barrier
    v_mfma_f32_32x32x16_bf16 v[64:79], v[208:211], v[240:243], v[64:79]
    ds_read_b128 v[160:163], v18 offset:16384
    ds_read_b128 v[164:167], v18 offset:20480
    v_mfma_f32_32x32x16_bf16 v[80:95], v[208:211], v[244:247], v[80:95]
    ds_read_b128 v[168:171], v19 offset:16384
    ds_read_b128 v[172:175], v19 offset:20480
    v_mfma_f32_32x32x16_bf16 v[96:111], v[212:215], v[240:243], v[96:111]
    ds_read_b128 v[176:179], v20 offset:16384
    ds_read_b128 v[180:183], v20 offset:20480
    v_mfma_f32_32x32x16_bf16 v[112:127], v[212:215], v[244:247], v[112:127]
    ds_read_b128 v[184:187], v21 offset:16384
    ds_read_b128 v[188:191], v21 offset:20480
    v_mfma_f32_32x32x16_bf16 v[64:79], v[216:219], v[248:251], v[64:79]
    v_mfma_f32_32x32x16_bf16 v[80:95], v[216:219], v[252:255], v[80:95]
    v_mfma_f32_32x32x16_bf16 v[96:111], v[220:223], v[248:251], v[96:111]
    v_mfma_f32_32x32x16_bf16 v[112:127], v[220:223], v[252:255], v[112:127]
    s_waitcnt lgkmcnt(0)
    s_setprio 3
    s_mov_b32 s8, s48
    s_mov_b32 s9, s49
    s_mov_b32 s10, 10485760
    s_mov_b32 s11, 0x00020000
    s_lshl_b32 s31, s25, 1
    s_add_u32 s31, s31, s33
    s_mul_i32 s40, s31, 327680
    s_add_u32 s41, s40, 40960
    s_add_u32 s42, s41, 40960
    s_add_u32 s43, s42, 40960
    s_add_u32 s44, s43, 40960
    s_add_u32 s45, s44, 40960
    s_add_u32 s46, s45, 40960
    s_add_u32 s47, s46, 40960
    v_mfma_f32_32x32x16_bf16 v[64:79], v[128:131], v[160:163], v[64:79]
    v_mfma_f32_32x32x16_bf16 v[64:79], v[136:139], v[168:171], v[64:79]
    v_mfma_f32_32x32x16_bf16 v[64:79], v[144:147], v[176:179], v[64:79]
    v_mfma_f32_32x32x16_bf16 v[64:79], v[152:155], v[184:187], v[64:79]
    v_mfma_f32_32x32x16_bf16 v[80:95], v[128:131], v[164:167], v[80:95]
    v_mfma_f32_32x32x16_bf16 v[80:95], v[136:139], v[172:175], v[80:95]
    v_mfma_f32_32x32x16_bf16 v[80:95], v[144:147], v[180:183], v[80:95]
    s_nop 8
    buffer_store_dword v64, v48, s[8:11], s40 offen offset:0 nt
    buffer_store_dword v65, v49, s[8:11], s40 offen offset:0 nt
    buffer_store_dword v66, v50, s[8:11], s40 offen offset:0 nt
    buffer_store_dword v67, v51, s[8:11], s40 offen offset:0 nt
    v_mfma_f32_32x32x16_bf16 v[80:95], v[152:155], v[188:191], v[80:95]
    buffer_store_dword v68, v48, s[8:11], s41 offen offset:0 nt
    buffer_store_dword v69, v49, s[8:11], s41 offen offset:0 nt
    buffer_store_dword v70, v50, s[8:11], s41 offen offset:0 nt
    buffer_store_dword v71, v51, s[8:11], s41 offen offset:0 nt
    v_mfma_f32_32x32x16_bf16 v[96:111], v[132:135], v[160:163], v[96:111]
    buffer_store_dword v72, v48, s[8:11], s42 offen offset:0 nt
    buffer_store_dword v73, v49, s[8:11], s42 offen offset:0 nt
    buffer_store_dword v74, v50, s[8:11], s42 offen offset:0 nt
    buffer_store_dword v75, v51, s[8:11], s42 offen offset:0 nt
    v_mfma_f32_32x32x16_bf16 v[96:111], v[140:143], v[168:171], v[96:111]
    buffer_store_dword v76, v48, s[8:11], s43 offen offset:0 nt
    buffer_store_dword v77, v49, s[8:11], s43 offen offset:0 nt
    buffer_store_dword v78, v50, s[8:11], s43 offen offset:0 nt
    buffer_store_dword v79, v51, s[8:11], s43 offen offset:0 nt
    v_mfma_f32_32x32x16_bf16 v[96:111], v[148:151], v[176:179], v[96:111]
    buffer_store_dword v80, v48, s[8:11], s40 offen offset:128 nt
    buffer_store_dword v81, v49, s[8:11], s40 offen offset:128 nt
    buffer_store_dword v82, v50, s[8:11], s40 offen offset:128 nt
    buffer_store_dword v83, v51, s[8:11], s40 offen offset:128 nt
    v_mfma_f32_32x32x16_bf16 v[96:111], v[156:159], v[184:187], v[96:111]
    buffer_store_dword v84, v48, s[8:11], s41 offen offset:128 nt
    buffer_store_dword v85, v49, s[8:11], s41 offen offset:128 nt
    buffer_store_dword v86, v50, s[8:11], s41 offen offset:128 nt
    buffer_store_dword v87, v51, s[8:11], s41 offen offset:128 nt
    v_mfma_f32_32x32x16_bf16 v[112:127], v[132:135], v[164:167], v[112:127]
    buffer_store_dword v88, v48, s[8:11], s42 offen offset:128 nt
    buffer_store_dword v89, v49, s[8:11], s42 offen offset:128 nt
    buffer_store_dword v90, v50, s[8:11], s42 offen offset:128 nt
    buffer_store_dword v91, v51, s[8:11], s42 offen offset:128 nt
    v_mfma_f32_32x32x16_bf16 v[112:127], v[140:143], v[172:175], v[112:127]
    buffer_store_dword v92, v48, s[8:11], s43 offen offset:128 nt
    buffer_store_dword v93, v49, s[8:11], s43 offen offset:128 nt
    buffer_store_dword v94, v50, s[8:11], s43 offen offset:128 nt
    buffer_store_dword v95, v51, s[8:11], s43 offen offset:128 nt
    v_mfma_f32_32x32x16_bf16 v[112:127], v[148:151], v[180:183], v[112:127]
    buffer_store_dword v96, v48, s[8:11], s44 offen offset:0 nt
    buffer_store_dword v97, v49, s[8:11], s44 offen offset:0 nt
    buffer_store_dword v98, v50, s[8:11], s44 offen offset:0 nt
    buffer_store_dword v99, v51, s[8:11], s44 offen offset:0 nt
    buffer_store_dword v100, v48, s[8:11], s45 offen offset:0 nt
    buffer_store_dword v101, v49, s[8:11], s45 offen offset:0 nt
    buffer_store_dword v102, v50, s[8:11], s45 offen offset:0 nt
    buffer_store_dword v103, v51, s[8:11], s45 offen offset:0 nt
    v_mfma_f32_32x32x16_bf16 v[112:127], v[156:159], v[188:191], v[112:127]
    buffer_store_dword v104, v48, s[8:11], s46 offen offset:0 nt
    buffer_store_dword v105, v49, s[8:11], s46 offen offset:0 nt
    buffer_store_dword v106, v50, s[8:11], s46 offen offset:0 nt
    buffer_store_dword v107, v51, s[8:11], s46 offen offset:0 nt
    buffer_store_dword v108, v48, s[8:11], s47 offen offset:0 nt
    buffer_store_dword v109, v49, s[8:11], s47 offen offset:0 nt
    buffer_store_dword v110, v50, s[8:11], s47 offen offset:0 nt
    buffer_store_dword v111, v51, s[8:11], s47 offen offset:0 nt
    s_nop 3
    buffer_store_dword v112, v48, s[8:11], s44 offen offset:128 nt
    buffer_store_dword v113, v49, s[8:11], s44 offen offset:128 nt
    buffer_store_dword v114, v50, s[8:11], s44 offen offset:128 nt
    buffer_store_dword v115, v51, s[8:11], s44 offen offset:128 nt
    buffer_store_dword v116, v48, s[8:11], s45 offen offset:128 nt
    buffer_store_dword v117, v49, s[8:11], s45 offen offset:128 nt
    buffer_store_dword v118, v50, s[8:11], s45 offen offset:128 nt
    buffer_store_dword v119, v51, s[8:11], s45 offen offset:128 nt
    buffer_store_dword v120, v48, s[8:11], s46 offen offset:128 nt
    buffer_store_dword v121, v49, s[8:11], s46 offen offset:128 nt
    buffer_store_dword v122, v50, s[8:11], s46 offen offset:128 nt
    buffer_store_dword v123, v51, s[8:11], s46 offen offset:128 nt
    buffer_store_dword v124, v48, s[8:11], s47 offen offset:128 nt
    buffer_store_dword v125, v49, s[8:11], s47 offen offset:128 nt
    buffer_store_dword v126, v50, s[8:11], s47 offen offset:128 nt
    buffer_store_dword v127, v51, s[8:11], s47 offen offset:128 nt
    s_branch L_a_end
L_a_g4:
    s_mov_b32 s60, s68
    s_setprio 3
    s_load_dwordx2 s[40:41], s[0:1], 88
    s_load_dwordx2 s[42:43], s[0:1], 96
    s_load_dwordx2 s[44:45], s[0:1], 112
    v_mbcnt_lo_u32_b32 v240, -1, 0
    v_mbcnt_hi_u32_b32 v240, -1, v240
    s_and_b32 s27, s66, 7
    s_and_b32 s25, s60, 3
    s_lshr_b32 s26, s60, 2
    s_lshl_b32 s27, s27, 2
    s_add_u32 s25, s25, s27
    v_lshrrev_b32 v224, 4, v240
    v_lshlrev_b32 v225, 2, v224
    v_xor_b32 v225, v225, v240
    v_and_b32 v225, 15, v225
    v_lshlrev_b32 v225, 4, v225
    v_mul_u32_u24 v224, 1280, v224
    s_mul_i32 s27, s64, 20480
    v_add3_u32 v224, v224, v225, s27
    v_add_u32 v225, 4096, v224
    v_add_u32 v226, 8192, v224
    v_add_u32 v227, 12288, v224
    s_lshl_b32 s27, s26, 8
    s_lshl_b32 s28, s64, 12
    v_bfe_u32 v229, v240, 2, 2
    v_lshrrev_b32 v230, 5, v240
    v_lshl_add_u32 v230, v230, 3, v229
    v_lshlrev_b32 v230, 8, v230
    v_xor_b32 v229, s64, v229
    v_lshl_add_u32 v230, v229, 6, v230
    v_and_b32 v229, 3, v240
    v_bfe_u32 v231, v240, 4, 1
    v_lshl_add_u32 v229, v231, 2, v229
    v_lshl_add_u32 v230, v229, 3, v230
    v_add_u32 v231, 65536, v230
    s_add_u32 s30, s27, 819200
    s_mul_i32 s29, s26, 163840
    s_add_u32 s29, s29, s27
    s_waitcnt lgkmcnt(0)
    s_mov_b32 s12, s40
    s_mov_b32 s13, s41
    s_mov_b32 s14, 819200
    s_mov_b32 s15, 0x00020000
    s_add_u32 m0, s28, 0
    s_nop 0
    buffer_load_dwordx4 v224, s[12:15], s29 offen offset:0 lds
    buffer_load_dwordx4 v225, s[12:15], s29 offen offset:1024 lds
    buffer_load_dwordx4 v226, s[12:15], s29 offen offset:2048 lds
    buffer_load_dwordx4 v227, s[12:15], s29 offen offset:3072 lds
    s_add_u32 s29, s29, 81920
    s_cmp_eq_u32 s29, s30
    s_cselect_b32 s29, s27, s29
    s_waitcnt vmcnt(0)
    s_add_u32 m0, s28, 16384
    s_nop 0
    buffer_load_dwordx4 v224, s[12:15], s29 offen offset:0 lds
    buffer_load_dwordx4 v225, s[12:15], s29 offen offset:1024 lds
    buffer_load_dwordx4 v226, s[12:15], s29 offen offset:2048 lds
    buffer_load_dwordx4 v227, s[12:15], s29 offen offset:3072 lds
    s_add_u32 s29, s29, 81920
    s_cmp_eq_u32 s29, s30
    s_cselect_b32 s29, s27, s29
    s_waitcnt vmcnt(0)
    s_add_u32 m0, s28, 32768
    s_nop 0
    buffer_load_dwordx4 v224, s[12:15], s29 offen offset:0 lds
    buffer_load_dwordx4 v225, s[12:15], s29 offen offset:1024 lds
    buffer_load_dwordx4 v226, s[12:15], s29 offen offset:2048 lds
    buffer_load_dwordx4 v227, s[12:15], s29 offen offset:3072 lds
    s_add_u32 s29, s29, 81920
    s_cmp_eq_u32 s29, s30
    s_cselect_b32 s29, s27, s29
    s_waitcnt vmcnt(0)
    s_add_u32 m0, s28, 49152
    s_nop 0
    buffer_load_dwordx4 v224, s[12:15], s29 offen offset:0 lds
    buffer_load_dwordx4 v225, s[12:15], s29 offen offset:1024 lds
    buffer_load_dwordx4 v226, s[12:15], s29 offen offset:2048 lds
    buffer_load_dwordx4 v227, s[12:15], s29 offen offset:3072 lds
    s_add_u32 s29, s29, 81920
    s_cmp_eq_u32 s29, s30
    s_cselect_b32 s29, s27, s29
    s_waitcnt vmcnt(0)
    s_add_u32 m0, s28, 65536
    s_nop 0
    buffer_load_dwordx4 v224, s[12:15], s29 offen offset:0 lds
    buffer_load_dwordx4 v225, s[12:15], s29 offen offset:1024 lds
    buffer_load_dwordx4 v226, s[12:15], s29 offen offset:2048 lds
    buffer_load_dwordx4 v227, s[12:15], s29 offen offset:3072 lds
    s_add_u32 s29, s29, 81920
    s_cmp_eq_u32 s29, s30
    s_cselect_b32 s29, s27, s29
    s_waitcnt vmcnt(0)
    s_barrier
    ds_read_b64_tr_b16 v[64:65], v230 offset:0
    ds_read_b64_tr_b16 v[66:67], v230 offset:1024
    ds_read_b64_tr_b16 v[68:69], v230 offset:4096
    ds_read_b64_tr_b16 v[70:71], v230 offset:5120
    ds_read_b64_tr_b16 v[72:73], v230 offset:8192
    ds_read_b64_tr_b16 v[74:75], v230 offset:9216
    ds_read_b64_tr_b16 v[76:77], v230 offset:12288
    ds_read_b64_tr_b16 v[78:79], v230 offset:13312
    ds_read_b64_tr_b16 v[80:81], v230 offset:16384
    ds_read_b64_tr_b16 v[82:83], v230 offset:17408
    ds_read_b64_tr_b16 v[84:85], v230 offset:20480
    ds_read_b64_tr_b16 v[86:87], v230 offset:21504
    s_waitcnt lgkmcnt(0)
    ds_read_b64_tr_b16 v[88:89], v230 offset:24576
    ds_read_b64_tr_b16 v[90:91], v230 offset:25600
    ds_read_b64_tr_b16 v[92:93], v230 offset:28672
    ds_read_b64_tr_b16 v[94:95], v230 offset:29696
    ds_read_b64_tr_b16 v[96:97], v230 offset:32768
    ds_read_b64_tr_b16 v[98:99], v230 offset:33792
    ds_read_b64_tr_b16 v[100:101], v230 offset:36864
    ds_read_b64_tr_b16 v[102:103], v230 offset:37888
    ds_read_b64_tr_b16 v[104:105], v230 offset:40960
    ds_read_b64_tr_b16 v[106:107], v230 offset:41984
    ds_read_b64_tr_b16 v[108:109], v230 offset:45056
    ds_read_b64_tr_b16 v[110:111], v230 offset:46080
    s_waitcnt lgkmcnt(0)
    ds_read_b64_tr_b16 v[112:113], v230 offset:49152
    ds_read_b64_tr_b16 v[114:115], v230 offset:50176
    ds_read_b64_tr_b16 v[116:117], v230 offset:53248
    ds_read_b64_tr_b16 v[118:119], v230 offset:54272
    ds_read_b64_tr_b16 v[120:121], v230 offset:57344
    ds_read_b64_tr_b16 v[122:123], v230 offset:58368
    ds_read_b64_tr_b16 v[124:125], v230 offset:61440
    ds_read_b64_tr_b16 v[126:127], v230 offset:62464
    ds_read_b64_tr_b16 v[128:129], v231 offset:0
    ds_read_b64_tr_b16 v[130:131], v231 offset:1024
    ds_read_b64_tr_b16 v[132:133], v231 offset:4096
    ds_read_b64_tr_b16 v[134:135], v231 offset:5120
    s_waitcnt lgkmcnt(0)
    ds_read_b64_tr_b16 v[136:137], v231 offset:8192
    ds_read_b64_tr_b16 v[138:139], v231 offset:9216
    ds_read_b64_tr_b16 v[140:141], v231 offset:12288
    ds_read_b64_tr_b16 v[142:143], v231 offset:13312
    s_waitcnt lgkmcnt(0)
    s_barrier
    s_add_u32 m0, s28, 0
    s_nop 0
    buffer_load_dwordx4 v224, s[12:15], s29 offen offset:0 lds
    buffer_load_dwordx4 v225, s[12:15], s29 offen offset:1024 lds
    buffer_load_dwordx4 v226, s[12:15], s29 offen offset:2048 lds
    buffer_load_dwordx4 v227, s[12:15], s29 offen offset:3072 lds
    s_add_u32 s29, s29, 81920
    s_cmp_eq_u32 s29, s30
    s_cselect_b32 s29, s27, s29
    s_waitcnt vmcnt(0)
    s_add_u32 m0, s28, 16384
    s_nop 0
    buffer_load_dwordx4 v224, s[12:15], s29 offen offset:0 lds
    buffer_load_dwordx4 v225, s[12:15], s29 offen offset:1024 lds
    buffer_load_dwordx4 v226, s[12:15], s29 offen offset:2048 lds
    buffer_load_dwordx4 v227, s[12:15], s29 offen offset:3072 lds
    s_add_u32 s29, s29, 81920
    s_cmp_eq_u32 s29, s30
    s_cselect_b32 s29, s27, s29
    s_waitcnt vmcnt(0)
    s_add_u32 m0, s28, 32768
    s_nop 0
    buffer_load_dwordx4 v224, s[12:15], s29 offen offset:0 lds
    buffer_load_dwordx4 v225, s[12:15], s29 offen offset:1024 lds
    buffer_load_dwordx4 v226, s[12:15], s29 offen offset:2048 lds
    buffer_load_dwordx4 v227, s[12:15], s29 offen offset:3072 lds
    s_add_u32 s29, s29, 81920
    s_cmp_eq_u32 s29, s30
    s_cselect_b32 s29, s27, s29
    s_waitcnt vmcnt(0)
    s_add_u32 m0, s28, 49152
    s_nop 0
    buffer_load_dwordx4 v224, s[12:15], s29 offen offset:0 lds
    buffer_load_dwordx4 v225, s[12:15], s29 offen offset:1024 lds
    buffer_load_dwordx4 v226, s[12:15], s29 offen offset:2048 lds
    buffer_load_dwordx4 v227, s[12:15], s29 offen offset:3072 lds
    s_add_u32 s29, s29, 81920
    s_cmp_eq_u32 s29, s30
    s_cselect_b32 s29, s27, s29
    s_waitcnt vmcnt(0)
    s_add_u32 m0, s28, 65536
    s_nop 0
    buffer_load_dwordx4 v224, s[12:15], s29 offen offset:0 lds
    buffer_load_dwordx4 v225, s[12:15], s29 offen offset:1024 lds
    buffer_load_dwordx4 v226, s[12:15], s29 offen offset:2048 lds
    buffer_load_dwordx4 v227, s[12:15], s29 offen offset:3072 lds
    s_add_u32 s29, s29, 81920
    s_cmp_eq_u32 s29, s30
    s_cselect_b32 s29, s27, s29
    s_waitcnt vmcnt(0)
    s_barrier
    ds_read_b64_tr_b16 v[144:145], v230 offset:0
    ds_read_b64_tr_b16 v[146:147], v230 offset:1024
    ds_read_b64_tr_b16 v[148:149], v230 offset:4096
    ds_read_b64_tr_b16 v[150:151], v230 offset:5120
    ds_read_b64_tr_b16 v[152:153], v230 offset:8192
    ds_read_b64_tr_b16 v[154:155], v230 offset:9216
    ds_read_b64_tr_b16 v[156:157], v230 offset:12288
    ds_read_b64_tr_b16 v[158:159], v230 offset:13312
    ds_read_b64_tr_b16 v[160:161], v230 offset:16384
    ds_read_b64_tr_b16 v[162:163], v230 offset:17408
    ds_read_b64_tr_b16 v[164:165], v230 offset:20480
    ds_read_b64_tr_b16 v[166:167], v230 offset:21504
    s_waitcnt lgkmcnt(0)
    ds_read_b64_tr_b16 v[168:169], v230 offset:24576
    ds_read_b64_tr_b16 v[170:171], v230 offset:25600
    ds_read_b64_tr_b16 v[172:173], v230 offset:28672
    ds_read_b64_tr_b16 v[174:175], v230 offset:29696
    ds_read_b64_tr_b16 v[176:177], v230 offset:32768
    ds_read_b64_tr_b16 v[178:179], v230 offset:33792
    ds_read_b64_tr_b16 v[180:181], v230 offset:36864
    ds_read_b64_tr_b16 v[182:183], v230 offset:37888
    ds_read_b64_tr_b16 v[184:185], v230 offset:40960
    ds_read_b64_tr_b16 v[186:187], v230 offset:41984
    ds_read_b64_tr_b16 v[188:189], v230 offset:45056
    ds_read_b64_tr_b16 v[190:191], v230 offset:46080
    s_waitcnt lgkmcnt(0)
    ds_read_b64_tr_b16 v[192:193], v230 offset:49152
    ds_read_b64_tr_b16 v[194:195], v230 offset:50176
    ds_read_b64_tr_b16 v[196:197], v230 offset:53248
    ds_read_b64_tr_b16 v[198:199], v230 offset:54272
    ds_read_b64_tr_b16 v[200:201], v230 offset:57344
    ds_read_b64_tr_b16 v[202:203], v230 offset:58368
    ds_read_b64_tr_b16 v[204:205], v230 offset:61440
    ds_read_b64_tr_b16 v[206:207], v230 offset:62464
    ds_read_b64_tr_b16 v[208:209], v231 offset:0
    ds_read_b64_tr_b16 v[210:211], v231 offset:1024
    ds_read_b64_tr_b16 v[212:213], v231 offset:4096
    ds_read_b64_tr_b16 v[214:215], v231 offset:5120
    s_waitcnt lgkmcnt(0)
    ds_read_b64_tr_b16 v[216:217], v231 offset:8192
    ds_read_b64_tr_b16 v[218:219], v231 offset:9216
    ds_read_b64_tr_b16 v[220:221], v231 offset:12288
    ds_read_b64_tr_b16 v[222:223], v231 offset:13312
    s_waitcnt lgkmcnt(0)
    s_barrier
    s_mov_b32 s8, s44
    s_mov_b32 s9, s45
    s_mov_b32 s10, 18022400
    s_mov_b32 s11, 0x00020000
    s_mov_b32 s16, s42
    s_mov_b32 s17, s43
    s_mov_b32 s18, 10485760
    s_mov_b32 s19, 0x00020000
    s_lshl_b32 s27, s25, 1
    s_mul_i32 s28, s27, 40960
    s_add_u32 s28, s28, 8388608
    s_lshl_b32 s29, s64, 10
    s_add_u32 s28, s28, s29
    s_lshl_b32 s31, s26, 13
    v_lshlrev_b32 v228, 4, v240
    v_add_u32 v233, 40960, v228
    v_lshrrev_b32 v224, 5, v240
    v_mul_u32_u24 v224, 20480, v224
    v_and_b32 v225, 31, v240
    v_lshl_add_u32 v224, v225, 2, v224
    v_add_u32 v225, 5120, v224
    v_add_u32 v226, 10240, v224
    v_add_u32 v227, 15360, v224
    s_mul_i32 s27, s25, 327680
    s_lshl_b32 s33, s26, 9
    s_add_u32 s27, s27, s33
    s_lshl_b32 s33, s64, 7
    s_add_u32 s27, s27, s33
    s_add_u32 s27, s27, 2560
    s_cmp_lg_u32 s64, 0
    s_cbranch_scc1 g4_wait
    s_lshr_b32 s33, s25, 1
    s_lshl_b32 s33, s33, 11
    s_add_u32 s33, s33, 17629184
    v_and_b32 v234, 15, v240
    v_lshlrev_b32 v234, 7, v234
    v_add_u32 v234, s33, v234
    s_and_b32 s33, s68, 15
    s_lshl_b32 s33, s33, 11
    s_and_b32 s34, s66, 7
    s_lshl_b32 s34, s34, 1
    s_lshr_b32 s35, s68, 4
    s_add_u32 s34, s34, s35
    s_lshl_b32 s34, s34, 7
    s_add_u32 s33, s33, s34
    s_add_u32 s33, s33, 17629184
    v_mov_b32 v236, s33
    s_mov_b32 s67, 20000
g4s_poll:
    buffer_load_dword v235, v236, s[8:11], 0 offen sc1
    s_waitcnt vmcnt(0)
    v_cmp_ne_u32 vcc, s65, v235
    s_nop 4
    s_cbranch_vccz g4s_poll_ok
    s_sleep 8
    s_sub_u32 s67, s67, 1
    s_cmp_lg_u32 s67, 0
    s_cbranch_scc1 g4s_poll
g4s_poll_ok:
    s_mov_b32 s67, 20000
g4_poll:
    buffer_load_dword v235, v234, s[8:11], 0 offen sc1
    s_waitcnt vmcnt(0)
    v_cmp_ne_u32 vcc, s65, v235
    s_nop 4
    s_cbranch_vccz g4_poll_ok
    s_sleep 1
    s_sub_u32 s67, s67, 1
    s_cmp_lg_u32 s67, 0
    s_cbranch_scc1 g4_poll
g4_poll_ok:
g4_wait:
    s_barrier
    s_add_u32 m0, s29, 0
    s_add_u32 s32, s28, s31
    buffer_load_dwordx4 v228, s[8:11], s32 offen sc1 lds
    s_add_u32 s31, s31, 4096
    s_cmp_eq_u32 s31, 40960
    s_cselect_b32 s31, 0, s31
    s_add_u32 m0, s29, 4096
    s_add_u32 s32, s28, s31
    buffer_load_dwordx4 v228, s[8:11], s32 offen sc1 lds
    s_add_u32 s31, s31, 4096
    s_cmp_eq_u32 s31, 40960
    s_cselect_b32 s31, 0, s31
    s_add_u32 m0, s29, 8192
    s_add_u32 s32, s28, s31
    buffer_load_dwordx4 v228, s[8:11], s32 offen sc1 lds
    s_add_u32 s31, s31, 4096
    s_cmp_eq_u32 s31, 40960
    s_cselect_b32 s31, 0, s31
    s_add_u32 m0, s29, 12288
    s_add_u32 s32, s28, s31
    buffer_load_dwordx4 v228, s[8:11], s32 offen sc1 lds
    s_add_u32 s31, s31, 4096
    s_cmp_eq_u32 s31, 40960
    s_cselect_b32 s31, 0, s31
    s_add_u32 m0, s29, 16384
    s_add_u32 s32, s28, s31
    buffer_load_dwordx4 v228, s[8:11], s32 offen sc1 lds
    s_add_u32 s31, s31, 4096
    s_cmp_eq_u32 s31, 40960
    s_cselect_b32 s31, 0, s31
    s_add_u32 m0, s29, 20480
    s_add_u32 s32, s28, s31
    buffer_load_dwordx4 v228, s[8:11], s32 offen sc1 lds
    s_add_u32 s31, s31, 4096
    s_cmp_eq_u32 s31, 40960
    s_cselect_b32 s31, 0, s31
    s_add_u32 m0, s29, 24576
    s_add_u32 s32, s28, s31
    buffer_load_dwordx4 v228, s[8:11], s32 offen sc1 lds
    s_add_u32 s31, s31, 4096
    s_cmp_eq_u32 s31, 40960
    s_cselect_b32 s31, 0, s31
    s_add_u32 m0, s29, 28672
    s_add_u32 s32, s28, s31
    buffer_load_dwordx4 v228, s[8:11], s32 offen sc1 lds
    s_add_u32 s31, s31, 4096
    s_cmp_eq_u32 s31, 40960
    s_cselect_b32 s31, 0, s31
    s_add_u32 m0, s29, 32768
    s_add_u32 s32, s28, s31
    buffer_load_dwordx4 v228, s[8:11], s32 offen sc1 lds
    s_add_u32 s31, s31, 4096
    s_cmp_eq_u32 s31, 40960
    s_cselect_b32 s31, 0, s31
    s_add_u32 m0, s29, 36864
    s_add_u32 s32, s28, s31
    buffer_load_dwordx4 v228, s[8:11], s32 offen sc1 lds
    s_add_u32 s31, s31, 4096
    s_cmp_eq_u32 s31, 40960
    s_cselect_b32 s31, 0, s31
    s_add_u32 m0, s29, 40960
    s_add_u32 s32, s28, s31
    buffer_load_dwordx4 v233, s[8:11], s32 offen sc1 lds
    s_add_u32 s31, s31, 4096
    s_cmp_eq_u32 s31, 40960
    s_cselect_b32 s31, 0, s31
    s_add_u32 m0, s29, 45056
    s_add_u32 s32, s28, s31
    buffer_load_dwordx4 v233, s[8:11], s32 offen sc1 lds
    s_add_u32 s31, s31, 4096
    s_cmp_eq_u32 s31, 40960
    s_cselect_b32 s31, 0, s31
    s_add_u32 m0, s29, 49152
    s_add_u32 s32, s28, s31
    buffer_load_dwordx4 v233, s[8:11], s32 offen sc1 lds
    s_add_u32 s31, s31, 4096
    s_cmp_eq_u32 s31, 40960
    s_cselect_b32 s31, 0, s31
    s_add_u32 m0, s29, 53248
    s_add_u32 s32, s28, s31
    buffer_load_dwordx4 v233, s[8:11], s32 offen sc1 lds
    s_add_u32 s31, s31, 4096
    s_cmp_eq_u32 s31, 40960
    s_cselect_b32 s31, 0, s31
    s_add_u32 m0, s29, 57344
    s_add_u32 s32, s28, s31
    buffer_load_dwordx4 v233, s[8:11], s32 offen sc1 lds
    s_add_u32 s31, s31, 4096
    s_cmp_eq_u32 s31, 40960
    s_cselect_b32 s31, 0, s31
    s_add_u32 m0, s29, 61440
    s_add_u32 s32, s28, s31
    buffer_load_dwordx4 v233, s[8:11], s32 offen sc1 lds
    s_add_u32 s31, s31, 4096
    s_cmp_eq_u32 s31, 40960
    s_cselect_b32 s31, 0, s31
    s_add_u32 m0, s29, 65536
    s_add_u32 s32, s28, s31
    buffer_load_dwordx4 v233, s[8:11], s32 offen sc1 lds
    s_add_u32 s31, s31, 4096
    s_cmp_eq_u32 s31, 40960
    s_cselect_b32 s31, 0, s31
    s_add_u32 m0, s29, 69632
    s_add_u32 s32, s28, s31
    buffer_load_dwordx4 v233, s[8:11], s32 offen sc1 lds
    s_add_u32 s31, s31, 4096
    s_cmp_eq_u32 s31, 40960
    s_cselect_b32 s31, 0, s31
    s_add_u32 m0, s29, 73728
    s_add_u32 s32, s28, s31
    buffer_load_dwordx4 v233, s[8:11], s32 offen sc1 lds
    s_add_u32 s31, s31, 4096
    s_cmp_eq_u32 s31, 40960
    s_cselect_b32 s31, 0, s31
    s_add_u32 m0, s29, 77824
    s_add_u32 s32, s28, s31
    buffer_load_dwordx4 v233, s[8:11], s32 offen sc1 lds
    s_add_u32 s31, s31, 4096
    s_cmp_eq_u32 s31, 40960
    s_cselect_b32 s31, 0, s31
    s_waitcnt vmcnt(19) lgkmcnt(0)
    s_barrier
    ds_read_b128 v[32:35], v228 offset:0
    ds_read_b128 v[36:39], v228 offset:1024
    ds_read_b128 v[40:43], v228 offset:2048
    ds_read_b128 v[44:47], v228 offset:3072
    s_waitcnt vmcnt(18) lgkmcnt(0)
    s_barrier
    v_mfma_f32_32x32x16_bf16 v[0:15], v[32:35], v[64:67], 0
    ds_read_b128 v[48:51], v228 offset:4096
    ds_read_b128 v[52:55], v228 offset:5120
    v_mfma_f32_32x32x16_bf16 v[0:15], v[36:39], v[68:71], v[0:15]
    ds_read_b128 v[56:59], v228 offset:6144
    ds_read_b128 v[60:63], v228 offset:7168
    v_mfma_f32_32x32x16_bf16 v[0:15], v[40:43], v[72:75], v[0:15]
    v_mfma_f32_32x32x16_bf16 v[0:15], v[44:47], v[76:79], v[0:15]
    s_waitcnt vmcnt(16) lgkmcnt(0)
    s_barrier
    v_mfma_f32_32x32x16_bf16 v[0:15], v[48:51], v[80:83], v[0:15]
    ds_read_b128 v[32:35], v228 offset:8192
    ds_read_b128 v[36:39], v228 offset:9216
    v_mfma_f32_32x32x16_bf16 v[0:15], v[52:55], v[84:87], v[0:15]
    ds_read_b128 v[40:43], v228 offset:10240
    ds_read_b128 v[44:47], v228 offset:11264
    v_mfma_f32_32x32x16_bf16 v[0:15], v[56:59], v[88:91], v[0:15]
    v_mfma_f32_32x32x16_bf16 v[0:15], v[60:63], v[92:95], v[0:15]
    s_waitcnt lgkmcnt(0)
    v_mfma_f32_32x32x16_bf16 v[0:15], v[32:35], v[96:99], v[0:15]
    ds_read_b128 v[48:51], v228 offset:12288
    ds_read_b128 v[52:55], v228 offset:13312
    v_mfma_f32_32x32x16_bf16 v[0:15], v[36:39], v[100:103], v[0:15]
    ds_read_b128 v[56:59], v228 offset:14336
    ds_read_b128 v[60:63], v228 offset:15360
    v_mfma_f32_32x32x16_bf16 v[0:15], v[40:43], v[104:107], v[0:15]
    v_mfma_f32_32x32x16_bf16 v[0:15], v[44:47], v[108:111], v[0:15]
    s_waitcnt vmcnt(14) lgkmcnt(0)
    s_barrier
    v_mfma_f32_32x32x16_bf16 v[0:15], v[48:51], v[112:115], v[0:15]
    ds_read_b128 v[32:35], v228 offset:16384
    ds_read_b128 v[36:39], v228 offset:17408
    v_mfma_f32_32x32x16_bf16 v[0:15], v[52:55], v[116:119], v[0:15]
    ds_read_b128 v[40:43], v228 offset:18432
    ds_read_b128 v[44:47], v228 offset:19456
    v_mfma_f32_32x32x16_bf16 v[0:15], v[56:59], v[120:123], v[0:15]
    v_mfma_f32_32x32x16_bf16 v[0:15], v[60:63], v[124:127], v[0:15]
    s_waitcnt lgkmcnt(0)
    v_mfma_f32_32x32x16_bf16 v[0:15], v[32:35], v[128:131], v[0:15]
    ds_read_b128 v[48:51], v228 offset:20480
    ds_read_b128 v[52:55], v228 offset:21504
    v_mfma_f32_32x32x16_bf16 v[0:15], v[36:39], v[132:135], v[0:15]
    ds_read_b128 v[56:59], v228 offset:22528
    ds_read_b128 v[60:63], v228 offset:23552
    v_mfma_f32_32x32x16_bf16 v[0:15], v[40:43], v[136:139], v[0:15]
    v_mfma_f32_32x32x16_bf16 v[0:15], v[44:47], v[140:143], v[0:15]
    s_waitcnt vmcnt(12) lgkmcnt(0)
    s_barrier
    v_mfma_f32_32x32x16_bf16 v[0:15], v[48:51], v[144:147], v[0:15]
    ds_read_b128 v[32:35], v228 offset:24576
    ds_read_b128 v[36:39], v228 offset:25600
    v_mfma_f32_32x32x16_bf16 v[0:15], v[52:55], v[148:151], v[0:15]
    ds_read_b128 v[40:43], v228 offset:26624
    ds_read_b128 v[44:47], v228 offset:27648
    v_mfma_f32_32x32x16_bf16 v[0:15], v[56:59], v[152:155], v[0:15]
    v_mfma_f32_32x32x16_bf16 v[0:15], v[60:63], v[156:159], v[0:15]
    s_waitcnt lgkmcnt(0)
    v_mfma_f32_32x32x16_bf16 v[0:15], v[32:35], v[160:163], v[0:15]
    ds_read_b128 v[48:51], v228 offset:28672
    ds_read_b128 v[52:55], v228 offset:29696
    v_mfma_f32_32x32x16_bf16 v[0:15], v[36:39], v[164:167], v[0:15]
    ds_read_b128 v[56:59], v228 offset:30720
    ds_read_b128 v[60:63], v228 offset:31744
    v_mfma_f32_32x32x16_bf16 v[0:15], v[40:43], v[168:171], v[0:15]
    v_mfma_f32_32x32x16_bf16 v[0:15], v[44:47], v[172:175], v[0:15]
    s_waitcnt vmcnt(10) lgkmcnt(0)
    s_barrier
    v_mfma_f32_32x32x16_bf16 v[0:15], v[48:51], v[176:179], v[0:15]
    ds_read_b128 v[32:35], v228 offset:32768
    ds_read_b128 v[36:39], v228 offset:33792
    v_mfma_f32_32x32x16_bf16 v[0:15], v[52:55], v[180:183], v[0:15]
    ds_read_b128 v[40:43], v228 offset:34816
    ds_read_b128 v[44:47], v228 offset:35840
    v_mfma_f32_32x32x16_bf16 v[0:15], v[56:59], v[184:187], v[0:15]
    v_mfma_f32_32x32x16_bf16 v[0:15], v[60:63], v[188:191], v[0:15]
    s_waitcnt lgkmcnt(0)
    v_mfma_f32_32x32x16_bf16 v[0:15], v[32:35], v[192:195], v[0:15]
    ds_read_b128 v[48:51], v228 offset:36864
    ds_read_b128 v[52:55], v228 offset:37888
    v_mfma_f32_32x32x16_bf16 v[0:15], v[36:39], v[196:199], v[0:15]
    ds_read_b128 v[56:59], v228 offset:38912
    ds_read_b128 v[60:63], v228 offset:39936
    v_mfma_f32_32x32x16_bf16 v[0:15], v[40:43], v[200:203], v[0:15]
    v_mfma_f32_32x32x16_bf16 v[0:15], v[44:47], v[204:207], v[0:15]
    s_waitcnt vmcnt(8) lgkmcnt(0)
    s_barrier
    v_mfma_f32_32x32x16_bf16 v[0:15], v[48:51], v[208:211], v[0:15]
    ds_read_b128 v[32:35], v233 offset:0
    ds_read_b128 v[36:39], v233 offset:1024
    v_mfma_f32_32x32x16_bf16 v[0:15], v[52:55], v[212:215], v[0:15]
    ds_read_b128 v[40:43], v233 offset:2048
    ds_read_b128 v[44:47], v233 offset:3072
    v_mfma_f32_32x32x16_bf16 v[0:15], v[56:59], v[216:219], v[0:15]
    v_mfma_f32_32x32x16_bf16 v[0:15], v[60:63], v[220:223], v[0:15]
    s_waitcnt lgkmcnt(0)
    v_mfma_f32_32x32x16_bf16 v[16:31], v[32:35], v[64:67], 0
    ds_read_b128 v[48:51], v233 offset:4096
    ds_read_b128 v[52:55], v233 offset:5120
    v_mfma_f32_32x32x16_bf16 v[16:31], v[36:39], v[68:71], v[16:31]
    ds_read_b128 v[56:59], v233 offset:6144
    ds_read_b128 v[60:63], v233 offset:7168
    v_mfma_f32_32x32x16_bf16 v[16:31], v[40:43], v[72:75], v[16:31]
    v_mfma_f32_32x32x16_bf16 v[16:31], v[44:47], v[76:79], v[16:31]
    s_waitcnt vmcnt(6) lgkmcnt(0)
    s_barrier
    v_mfma_f32_32x32x16_bf16 v[16:31], v[48:51], v[80:83], v[16:31]
    ds_read_b128 v[32:35], v233 offset:8192
    ds_read_b128 v[36:39], v233 offset:9216
    v_mfma_f32_32x32x16_bf16 v[16:31], v[52:55], v[84:87], v[16:31]
    ds_read_b128 v[40:43], v233 offset:10240
    ds_read_b128 v[44:47], v233 offset:11264
    v_mfma_f32_32x32x16_bf16 v[16:31], v[56:59], v[88:91], v[16:31]
    buffer_store_dword v0, v224, s[16:19], s27 offen nt
    v_mfma_f32_32x32x16_bf16 v[16:31], v[60:63], v[92:95], v[16:31]
    buffer_store_dword v1, v225, s[16:19], s27 offen nt
    s_waitcnt lgkmcnt(0)
    v_mfma_f32_32x32x16_bf16 v[16:31], v[32:35], v[96:99], v[16:31]
    ds_read_b128 v[48:51], v233 offset:12288
    ds_read_b128 v[52:55], v233 offset:13312
    v_mfma_f32_32x32x16_bf16 v[16:31], v[36:39], v[100:103], v[16:31]
    ds_read_b128 v[56:59], v233 offset:14336
    ds_read_b128 v[60:63], v233 offset:15360
    v_mfma_f32_32x32x16_bf16 v[16:31], v[40:43], v[104:107], v[16:31]
    buffer_store_dword v2, v226, s[16:19], s27 offen nt
    v_mfma_f32_32x32x16_bf16 v[16:31], v[44:47], v[108:111], v[16:31]
    buffer_store_dword v3, v227, s[16:19], s27 offen nt
    s_add_u32 s27, s27, 40960
    s_waitcnt vmcnt(7) lgkmcnt(0)
    s_barrier
    v_mfma_f32_32x32x16_bf16 v[16:31], v[48:51], v[112:115], v[16:31]
    ds_read_b128 v[32:35], v233 offset:16384
    ds_read_b128 v[36:39], v233 offset:17408
    v_mfma_f32_32x32x16_bf16 v[16:31], v[52:55], v[116:119], v[16:31]
    ds_read_b128 v[40:43], v233 offset:18432
    ds_read_b128 v[44:47], v233 offset:19456
    v_mfma_f32_32x32x16_bf16 v[16:31], v[56:59], v[120:123], v[16:31]
    buffer_store_dword v4, v224, s[16:19], s27 offen nt
    v_mfma_f32_32x32x16_bf16 v[16:31], v[60:63], v[124:127], v[16:31]
    buffer_store_dword v5, v225, s[16:19], s27 offen nt
    s_waitcnt lgkmcnt(0)
    v_mfma_f32_32x32x16_bf16 v[16:31], v[32:35], v[128:131], v[16:31]
    ds_read_b128 v[48:51], v233 offset:20480
    ds_read_b128 v[52:55], v233 offset:21504
    v_mfma_f32_32x32x16_bf16 v[16:31], v[36:39], v[132:135], v[16:31]
    ds_read_b128 v[56:59], v233 offset:22528
    ds_read_b128 v[60:63], v233 offset:23552
    v_mfma_f32_32x32x16_bf16 v[16:31], v[40:43], v[136:139], v[16:31]
    buffer_store_dword v6, v226, s[16:19], s27 offen nt
    v_mfma_f32_32x32x16_bf16 v[16:31], v[44:47], v[140:143], v[16:31]
    buffer_store_dword v7, v227, s[16:19], s27 offen nt
    s_add_u32 s27, s27, 40960
    s_waitcnt lgkmcnt(0)
    v_mfma_f32_32x32x16_bf16 v[16:31], v[48:51], v[144:147], v[16:31]
    ds_read_b128 v[32:35], v233 offset:24576
    ds_read_b128 v[36:39], v233 offset:25600
    v_mfma_f32_32x32x16_bf16 v[16:31], v[52:55], v[148:151], v[16:31]
    ds_read_b128 v[40:43], v233 offset:26624
    ds_read_b128 v[44:47], v233 offset:27648
    v_mfma_f32_32x32x16_bf16 v[16:31], v[56:59], v[152:155], v[16:31]
    buffer_store_dword v8, v224, s[16:19], s27 offen nt
    v_mfma_f32_32x32x16_bf16 v[16:31], v[60:63], v[156:159], v[16:31]
    buffer_store_dword v9, v225, s[16:19], s27 offen nt
    s_waitcnt vmcnt(10) lgkmcnt(0)
    s_barrier
    v_mfma_f32_32x32x16_bf16 v[16:31], v[32:35], v[160:163], v[16:31]
    ds_read_b128 v[48:51], v233 offset:28672
    ds_read_b128 v[52:55], v233 offset:29696
    v_mfma_f32_32x32x16_bf16 v[16:31], v[36:39], v[164:167], v[16:31]
    ds_read_b128 v[56:59], v233 offset:30720
    ds_read_b128 v[60:63], v233 offset:31744
    v_mfma_f32_32x32x16_bf16 v[16:31], v[40:43], v[168:171], v[16:31]
    buffer_store_dword v10, v226, s[16:19], s27 offen nt
    v_mfma_f32_32x32x16_bf16 v[16:31], v[44:47], v[172:175], v[16:31]
    buffer_store_dword v11, v227, s[16:19], s27 offen nt
    s_add_u32 s27, s27, 40960
    s_waitcnt lgkmcnt(0)
    v_mfma_f32_32x32x16_bf16 v[16:31], v[48:51], v[176:179], v[16:31]
    ds_read_b128 v[32:35], v233 offset:32768
    ds_read_b128 v[36:39], v233 offset:33792
    v_mfma_f32_32x32x16_bf16 v[16:31], v[52:55], v[180:183], v[16:31]
    ds_read_b128 v[40:43], v233 offset:34816
    ds_read_b128 v[44:47], v233 offset:35840
    v_mfma_f32_32x32x16_bf16 v[16:31], v[56:59], v[184:187], v[16:31]
    buffer_store_dword v12, v224, s[16:19], s27 offen nt
    v_mfma_f32_32x32x16_bf16 v[16:31], v[60:63], v[188:191], v[16:31]
    buffer_store_dword v13, v225, s[16:19], s27 offen nt
    s_waitcnt lgkmcnt(0)
    v_mfma_f32_32x32x16_bf16 v[16:31], v[32:35], v[192:195], v[16:31]
    ds_read_b128 v[48:51], v233 offset:36864
    ds_read_b128 v[52:55], v233 offset:37888
    v_mfma_f32_32x32x16_bf16 v[16:31], v[36:39], v[196:199], v[16:31]
    ds_read_b128 v[56:59], v233 offset:38912
    ds_read_b128 v[60:63], v233 offset:39936
    v_mfma_f32_32x32x16_bf16 v[16:31], v[40:43], v[200:203], v[16:31]
    buffer_store_dword v14, v226, s[16:19], s27 offen nt
    v_mfma_f32_32x32x16_bf16 v[16:31], v[44:47], v[204:207], v[16:31]
    buffer_store_dword v15, v227, s[16:19], s27 offen nt
    s_add_u32 s27, s27, 40960
    s_waitcnt lgkmcnt(0)
    v_mfma_f32_32x32x16_bf16 v[16:31], v[48:51], v[208:211], v[16:31]
    v_mfma_f32_32x32x16_bf16 v[16:31], v[52:55], v[212:215], v[16:31]
    v_mfma_f32_32x32x16_bf16 v[16:31], v[56:59], v[216:219], v[16:31]
    v_mfma_f32_32x32x16_bf16 v[16:31], v[60:63], v[220:223], v[16:31]
    s_nop 11
    buffer_store_dword v16, v224, s[16:19], s27 offen nt
    buffer_store_dword v17, v225, s[16:19], s27 offen nt
    buffer_store_dword v18, v226, s[16:19], s27 offen nt
    buffer_store_dword v19, v227, s[16:19], s27 offen nt
    s_add_u32 s27, s27, 40960
    buffer_store_dword v20, v224, s[16:19], s27 offen nt
    buffer_store_dword v21, v225, s[16:19], s27 offen nt
    buffer_store_dword v22, v226, s[16:19], s27 offen nt
    buffer_store_dword v23, v227, s[16:19], s27 offen nt
    s_add_u32 s27, s27, 40960
    buffer_store_dword v24, v224, s[16:19], s27 offen nt
    buffer_store_dword v25, v225, s[16:19], s27 offen nt
    buffer_store_dword v26, v226, s[16:19], s27 offen nt
    buffer_store_dword v27, v227, s[16:19], s27 offen nt
    s_add_u32 s27, s27, 40960
    buffer_store_dword v28, v224, s[16:19], s27 offen nt
    buffer_store_dword v29, v225, s[16:19], s27 offen nt
    buffer_store_dword v30, v226, s[16:19], s27 offen nt
    buffer_store_dword v31, v227, s[16:19], s27 offen nt
    s_add_u32 s27, s27, 40960
L_a_end:
L_end:
    s_endpgm
L_code_end:
.section .rodata,"a"
.p2align 6
.amdhsa_kernel concat_heads__ssm_conv_s5__mha_block__prompt_kernel
  .amdhsa_next_free_vgpr 256
  .amdhsa_next_free_sgpr 96
  .amdhsa_accum_offset 256
  .amdhsa_group_segment_fixed_size 0
  .amdhsa_kernarg_size 120
  .amdhsa_user_sgpr_count 2
  .amdhsa_user_sgpr_kernarg_segment_ptr 1
  .amdhsa_system_sgpr_workgroup_id_x 1
.end_amdhsa_kernel
```
